```python
import torch

def _softmax(x, axis=-1):
    return torch.softmax(x, dim=axis)

def _gelu(x):
    return torch.nn.functional.gelu(x, approximate='tanh')

def _silu(x):
    return torch.nn.functional.silu(x)

def _sigmoid(x):
    return torch.sigmoid(x)

def _layernorm(x, axis=-1, eps=1e-05):
    m = x.mean(dim=axis, keepdim=True)
    v = x.var(dim=axis, keepdim=True, unbiased=False)
    return (x - m) / torch.sqrt(v + eps)

def _scatter_add(tgt, idx, src, axis=0):
    return tgt.clone().index_add_(axis, idx, src)

def _segment_sum(src, seg, n):
    out = torch.zeros((n,) + src.shape[1:], dtype=src.dtype)
    return out.index_add_(0, seg, src)

def _pad(x, pw):
    flat = tuple((v for pair in reversed(pw) for v in pair))
    return torch.nn.functional.pad(x, flat)
kernel_name = 'adaLN_cond__memory_aug_recurrent_mem_tr__dense_activation_silu__prompt'

def setup_inputs():

    _w = lambda a: (lambda t: t.to(torch.bfloat16) if t.is_floating_point() else t)(torch.as_tensor(a))

    def _A_setup():
        B, S, Dm = (1, 2048, 512)
        H, Dh = (32, 128)
        M, seg = (8, 32)
        seg = min(seg, S)
        S = S // seg * seg
        return {'x': _w((lambda *s: torch.randn(*s, dtype=torch.bfloat16) * 0.05)(B, S, Dm)), 'mem0': _w((lambda *s: torch.randn(*s, dtype=torch.bfloat16) * 0.8)(B, M, Dm)), 'Wq': _w((lambda *s: torch.randn(*s, dtype=torch.bfloat16) * 1.6)(Dm, H, Dh) * Dm ** (-0.5)), 'Wk': _w((lambda *s: torch.randn(*s, dtype=torch.bfloat16) * 1.6)(Dm, H, Dh) * Dm ** (-0.5)), 'Wv': _w((lambda *s: torch.randn(*s, dtype=torch.bfloat16) * 0.8)(Dm, H, Dh) * Dm ** (-0.5)), 'Wo': _w((lambda *s: torch.randn(*s, dtype=torch.bfloat16) * 0.8)(H, Dh, Dm) * (H * Dh) ** (-0.5)), 'seg_len': seg}
    _A_in = _A_setup()

    def _B_setup():
        B, S, D, F = (1, 2048, 512, 1792)
        return {'x': _w((lambda *s: torch.randn(*s, dtype=torch.bfloat16) * 0.05)(B, S, D)), 'w1': _w((lambda *s: torch.randn(*s, dtype=torch.bfloat16) * 3.2)(D, F) * D ** (-0.5)), 'w2': _w((lambda *s: torch.randn(*s, dtype=torch.bfloat16) * 0.2)(F, D) * F ** (-0.5))}
    _B_in = _B_setup()
    return {'A_x': _A_in['x'], 'A_mem0': _A_in['mem0'], 'A_Wq': _A_in['Wq'], 'A_Wk': _A_in['Wk'], 'A_Wv': _A_in['Wv'], 'A_Wo': _A_in['Wo'], 'A_seg_len': _A_in['seg_len'], 'B_x': _B_in['x'], 'B_w1': _B_in['w1'], 'B_w2': _B_in['w2'], 'c': _w((lambda *s: torch.randn(*s, dtype=torch.bfloat16) * 0.1)(1, 512) * 8.0), 'w_mod': _w((lambda *s: torch.randn(*s, dtype=torch.bfloat16) * 0.1)(512, 6 * 512) * 512 ** (-0.5) * 8.0)}

def reference(A_x, A_mem0, A_Wq, A_Wk, A_Wv, A_Wo, A_seg_len, B_x, B_w1, B_w2, c, w_mod):

    def _A_ref(x, mem0, Wq, Wk, Wv, Wo, seg_len):
        B, S, Dm = x.shape
        H, Dh = (Wq.shape[1], Wq.shape[2])
        M = mem0.shape[1]
        scale = Dh ** (-0.5)
        n_seg = S // seg_len
        L = M + seg_len
        idx = torch.arange(L)
        mask = (idx[:, None] < M) | (idx[:, None] >= idx[None, :])
        mem = mem0
        outs = []
        for s in range(n_seg):
            xs = x[:, s * seg_len:(s + 1) * seg_len, :].clone()
            h = torch.concatenate([mem, xs], axis=1)
            q = torch.einsum('btd,dhe->bhte', h, Wq)
            k = torch.einsum('btd,dhe->bhte', h, Wk)
            v = torch.einsum('btd,dhe->bhte', h, Wv)
            scores = torch.einsum('bhqe,bhke->bhqk', q, k) * scale
            scores = torch.where(mask[None, None], scores, -1000000000.0)
            p = _softmax(scores, axis=-1)
            o = torch.einsum('bhqk,bhke->bhqe', p, v)
            o = torch.einsum('bhte,hed->btd', o, Wo)
            mem = o[:, :M, :].clone()
            outs.append(o[:, M:, :])
        return torch.concatenate(outs, axis=1)

    def _B_ref(x, w1, w2):
        h = torch.einsum('bsd,df->bsf', x, w1)
        h = _silu(h)
        out = torch.einsum('bsf,fd->bsd', h, w2)
        return out
    x = A_x
    mod = (_silu(c) @ w_mod).reshape(c.shape[0], 6, 1, -1)
    sa, ca, ga, sb, cb, gb = (mod[:, 0].clone(), mod[:, 1].clone(), mod[:, 2].clone(), mod[:, 3].clone(), mod[:, 4].clone(), mod[:, 5].clone())
    h = _layernorm(x, axis=-1) * (1 + ca) + sa
    x = x + ga * _A_ref(h, A_mem0, A_Wq, A_Wk, A_Wv, A_Wo, A_seg_len)
    h = _layernorm(x, axis=-1) * (1 + cb) + sb
    x = x + gb * _B_ref(h, B_w1, B_w2)
    return x
```

```asm
; @launch grid=(256,1,1) block=(256,1,1) lds=163840
.amdgcn_target "amdgcn-amd-amdhsa--gfx950"
.text
.globl adaLN_cond__memory_aug_recurrent_mem_tr__dense_activation_silu__prompt_kernel
.p2align 8
.type adaLN_cond__memory_aug_recurrent_mem_tr__dense_activation_silu__prompt_kernel,@function
adaLN_cond__memory_aug_recurrent_mem_tr__dense_activation_silu__prompt_kernel:

 s_cmp_ge_u32 s2, 256
 s_cbranch_scc1 L_exit
 s_load_dwordx4 s[56:59], s[0:1], 104
 s_load_dwordx8 s[48:55], s[0:1], 16
 s_load_dwordx2 s[46:47], s[0:1], 8
 s_getreg_b32 s44, hwreg(HW_REG_XCC_ID, 0, 4)
 v_mov_b32 v31, v0
 s_lshl_b32 s24, s44, 2
 s_lshr_b32 s24, 0x75430621, s24
 s_and_b32 s24, s24, 7
 s_cmp_lt_u32 s44, 8
 s_cselect_b32 s44, s24, s44
 v_readfirstlane_b32 s27, v0
 s_waitcnt lgkmcnt(0)
 s_mov_b32 s12, s56
 s_and_b32 s13, s57, 0xffff
 s_mov_b32 s14, 0x100
 s_mov_b32 s15, 0x20000
 s_mov_b32 s4, s58
 s_and_b32 s5, s59, 0xffff
 s_mov_b32 s6, 0x10000000
 s_mov_b32 s7, 0x20000
 s_cmp_eq_u32 s27, 0
 s_cbranch_scc1 L_rank
 s_branch L_have
L_rank:
 s_min_u32 s44, s44, 8
 s_add_u32 s24, s44, 3
 s_lshr_b32 s25, s24, 2
 s_lshl_b32 s25, s25, 6
 s_and_b32 s24, s24, 3
 s_lshl_b32 s24, s24, 2
 s_cmp_eq_u32 s44, 0
 s_cselect_b32 s24, 0, s24
 s_add_u32 s24, s24, s25
 s_mov_b64 exec, 1
 v_mov_b32 v20, 1
 buffer_atomic_add v20, off, s[12:15], s24 sc0
 s_waitcnt vmcnt(0)
 v_readfirstlane_b32 s25, v20
 s_lshl_b32 s45, s44, 5
 s_add_u32 s45, s45, s25
 s_cmp_lt_u32 s25, 32
 s_cselect_b32 s24, 1, 0
 s_cmp_lt_u32 s44, 8
 s_cselect_b32 s24, s24, 0
 s_cmp_eq_u32 s24, 1
 s_cbranch_scc1 L_pub
 v_mov_b32 v20, 1
 buffer_atomic_add v20, off, s[12:15], 0 offset:144 sc0
 s_mov_b32 s23, 0
L_ovf:
 buffer_load_dword v21, off, s[12:15], 0 sc1
 buffer_load_dwordx4 v[24:27], off, s[12:15], 0 offset:64 sc1
 buffer_load_dwordx4 v[32:35], off, s[12:15], 0 offset:128 sc1
 s_add_u32 s23, s23, 1
 s_cmp_gt_u32 s23, 262144
 s_cbranch_scc1 L_bail
 s_waitcnt vmcnt(0)
 v_add3_u32 v22, v21, v24, v25
 v_add3_u32 v22, v22, v26, v27
 v_add3_u32 v22, v22, v32, v33
 v_add3_u32 v22, v22, v34, v35
 v_cmp_le_u32 vcc, 256, v22
 s_cbranch_vccz L_ovf
 v_mov_b32 v23, 0
 v_mov_b32 v36, 0
 v_min_u32 v37, 32, v21
 v_sub_u32 v38, v20, v36
 v_add_u32 v39, v38, v37
 v_cmp_le_u32 vcc, v36, v20
 v_add_u32 v39, 0, v39
 s_nop 0
 v_cndmask_b32 v23, v23, v39, vcc
 v_sub_u32 v37, 32, v37
 v_add_u32 v36, v36, v37
 v_min_u32 v37, 32, v24
 v_sub_u32 v38, v20, v36
 v_add_u32 v39, v38, v37
 v_cmp_le_u32 vcc, v36, v20
 v_add_u32 v39, 32, v39
 s_nop 0
 v_cndmask_b32 v23, v23, v39, vcc
 v_sub_u32 v37, 32, v37
 v_add_u32 v36, v36, v37
 v_min_u32 v37, 32, v25
 v_sub_u32 v38, v20, v36
 v_add_u32 v39, v38, v37
 v_cmp_le_u32 vcc, v36, v20
 v_add_u32 v39, 64, v39
 s_nop 0
 v_cndmask_b32 v23, v23, v39, vcc
 v_sub_u32 v37, 32, v37
 v_add_u32 v36, v36, v37
 v_min_u32 v37, 32, v26
 v_sub_u32 v38, v20, v36
 v_add_u32 v39, v38, v37
 v_cmp_le_u32 vcc, v36, v20
 v_add_u32 v39, 96, v39
 s_nop 0
 v_cndmask_b32 v23, v23, v39, vcc
 v_sub_u32 v37, 32, v37
 v_add_u32 v36, v36, v37
 v_min_u32 v37, 32, v27
 v_sub_u32 v38, v20, v36
 v_add_u32 v39, v38, v37
 v_cmp_le_u32 vcc, v36, v20
 v_add_u32 v39, 128, v39
 s_nop 0
 v_cndmask_b32 v23, v23, v39, vcc
 v_sub_u32 v37, 32, v37
 v_add_u32 v36, v36, v37
 v_min_u32 v37, 32, v32
 v_sub_u32 v38, v20, v36
 v_add_u32 v39, v38, v37
 v_cmp_le_u32 vcc, v36, v20
 v_add_u32 v39, 160, v39
 s_nop 0
 v_cndmask_b32 v23, v23, v39, vcc
 v_sub_u32 v37, 32, v37
 v_add_u32 v36, v36, v37
 v_min_u32 v37, 32, v33
 v_sub_u32 v38, v20, v36
 v_add_u32 v39, v38, v37
 v_cmp_le_u32 vcc, v36, v20
 v_add_u32 v39, 192, v39
 s_nop 0
 v_cndmask_b32 v23, v23, v39, vcc
 v_sub_u32 v37, 32, v37
 v_add_u32 v36, v36, v37
 v_min_u32 v37, 32, v34
 v_sub_u32 v38, v20, v36
 v_add_u32 v39, v38, v37
 v_cmp_le_u32 vcc, v36, v20
 v_add_u32 v39, 224, v39
 s_nop 0
 v_cndmask_b32 v23, v23, v39, vcc
 v_sub_u32 v37, 32, v37
 v_add_u32 v36, v36, v37
 s_nop 0
 v_readfirstlane_b32 s45, v23
L_pub:
 v_mov_b32 v20, s45
 v_mov_b32 v21, 0
 ds_write_b32 v21, v20
 s_waitcnt lgkmcnt(0)
 s_mov_b64 exec, -1
L_have:
 s_barrier
 v_mov_b32 v21, 0
 ds_read_b32 v20, v21
 s_waitcnt lgkmcnt(0)
 v_readfirstlane_b32 s45, v20
 s_barrier
 s_cmp_lt_u32 s45, 32
 s_cbranch_scc1 L_R
 s_cmp_lt_u32 s45, 160
 s_cbranch_scc1 L_T
 s_sub_u32 s16, s45, 160
 s_cmp_lt_u32 s16, 48
 s_cbranch_scc0 L_noinit
 s_load_dwordx2 s[48:49], s[0:1], 80
 s_load_dwordx2 s[50:51], s[0:1], 88
 v_lshrrev_b32 v20, 3, v31
 v_and_b32 v21, 7, v31
 v_mul_u32_u24 v22, 6144, v20
 v_lshl_add_u32 v22, v21, 4, v22
 s_lshl_b32 s24, s16, 7
 v_add_u32 v22, s24, v22
 v_lshlrev_b32 v23, 1, v20
 v_lshlrev_b32 v24, 2, v31
 v_mov_b32 v25, 0
 s_lshl_b32 s24, s16, 10
 s_add_u32 s24, s24, 0x110000
 buffer_store_dword v25, v24, s[4:7], s24 offen sc1
 s_waitcnt lgkmcnt(0)
 s_mov_b32 s76, s48
 s_and_b32 s77, s49, 0xffff
 s_mov_b32 s78, 0x400
 s_mov_b32 s79, 0x20000
 s_mov_b32 s80, s50
 s_and_b32 s81, s51, 0xffff
 s_mov_b32 s82, 0x300000
 s_mov_b32 s83, 0x20000
 buffer_load_ushort v40, v23, s[76:79], 0 offen offset:0
 buffer_load_ushort v41, v23, s[76:79], 0 offen offset:64
 buffer_load_ushort v42, v23, s[76:79], 0 offen offset:128
 buffer_load_ushort v43, v23, s[76:79], 0 offen offset:192
 buffer_load_ushort v44, v23, s[76:79], 0 offen offset:256
 buffer_load_ushort v45, v23, s[76:79], 0 offen offset:320
 buffer_load_ushort v46, v23, s[76:79], 0 offen offset:384
 buffer_load_ushort v47, v23, s[76:79], 0 offen offset:448
 buffer_load_ushort v48, v23, s[76:79], 0 offen offset:512
 buffer_load_ushort v49, v23, s[76:79], 0 offen offset:576
 buffer_load_ushort v50, v23, s[76:79], 0 offen offset:640
 buffer_load_ushort v51, v23, s[76:79], 0 offen offset:704
 buffer_load_ushort v52, v23, s[76:79], 0 offen offset:768
 buffer_load_ushort v53, v23, s[76:79], 0 offen offset:832
 buffer_load_ushort v54, v23, s[76:79], 0 offen offset:896
 buffer_load_ushort v55, v23, s[76:79], 0 offen offset:960
 s_mov_b32 s24, 0
 buffer_load_dwordx4 v[64:67], v22, s[80:83], s24 offen
 s_mov_b32 s24, 196608
 buffer_load_dwordx4 v[68:71], v22, s[80:83], s24 offen
 s_mov_b32 s24, 393216
 buffer_load_dwordx4 v[72:75], v22, s[80:83], s24 offen
 s_mov_b32 s24, 589824
 buffer_load_dwordx4 v[76:79], v22, s[80:83], s24 offen
 s_mov_b32 s24, 786432
 buffer_load_dwordx4 v[80:83], v22, s[80:83], s24 offen
 s_mov_b32 s24, 983040
 buffer_load_dwordx4 v[84:87], v22, s[80:83], s24 offen
 s_mov_b32 s24, 1179648
 buffer_load_dwordx4 v[88:91], v22, s[80:83], s24 offen
 s_mov_b32 s24, 1376256
 buffer_load_dwordx4 v[92:95], v22, s[80:83], s24 offen
 s_mov_b32 s24, 1572864
 buffer_load_dwordx4 v[96:99], v22, s[80:83], s24 offen
 s_mov_b32 s24, 1769472
 buffer_load_dwordx4 v[100:103], v22, s[80:83], s24 offen
 s_mov_b32 s24, 1966080
 buffer_load_dwordx4 v[104:107], v22, s[80:83], s24 offen
 s_mov_b32 s24, 2162688
 buffer_load_dwordx4 v[108:111], v22, s[80:83], s24 offen
 s_mov_b32 s24, 2359296
 buffer_load_dwordx4 v[112:115], v22, s[80:83], s24 offen
 s_mov_b32 s24, 2555904
 buffer_load_dwordx4 v[116:119], v22, s[80:83], s24 offen
 s_mov_b32 s24, 2752512
 buffer_load_dwordx4 v[120:123], v22, s[80:83], s24 offen
 s_mov_b32 s24, 2949120
 buffer_load_dwordx4 v[124:127], v22, s[80:83], s24 offen
 s_waitcnt vmcnt(16)
 v_lshlrev_b32 v40, 16, v40
 v_mul_f32 v26, 0xbfb8aa3b, v40
 v_exp_f32 v26, v26
 s_nop 0
 v_add_f32 v26, 1.0, v26
 v_rcp_f32 v26, v26
 s_nop 0
 v_mul_f32 v40, v40, v26
 v_cvt_pk_bf16_f32 v40, v40, v40
 v_and_b32 v40, 0xffff0000, v40
 v_lshlrev_b32 v41, 16, v41
 v_mul_f32 v26, 0xbfb8aa3b, v41
 v_exp_f32 v26, v26
 s_nop 0
 v_add_f32 v26, 1.0, v26
 v_rcp_f32 v26, v26
 s_nop 0
 v_mul_f32 v41, v41, v26
 v_cvt_pk_bf16_f32 v41, v41, v41
 v_and_b32 v41, 0xffff0000, v41
 v_lshlrev_b32 v42, 16, v42
 v_mul_f32 v26, 0xbfb8aa3b, v42
 v_exp_f32 v26, v26
 s_nop 0
 v_add_f32 v26, 1.0, v26
 v_rcp_f32 v26, v26
 s_nop 0
 v_mul_f32 v42, v42, v26
 v_cvt_pk_bf16_f32 v42, v42, v42
 v_and_b32 v42, 0xffff0000, v42
 v_lshlrev_b32 v43, 16, v43
 v_mul_f32 v26, 0xbfb8aa3b, v43
 v_exp_f32 v26, v26
 s_nop 0
 v_add_f32 v26, 1.0, v26
 v_rcp_f32 v26, v26
 s_nop 0
 v_mul_f32 v43, v43, v26
 v_cvt_pk_bf16_f32 v43, v43, v43
 v_and_b32 v43, 0xffff0000, v43
 v_lshlrev_b32 v44, 16, v44
 v_mul_f32 v26, 0xbfb8aa3b, v44
 v_exp_f32 v26, v26
 s_nop 0
 v_add_f32 v26, 1.0, v26
 v_rcp_f32 v26, v26
 s_nop 0
 v_mul_f32 v44, v44, v26
 v_cvt_pk_bf16_f32 v44, v44, v44
 v_and_b32 v44, 0xffff0000, v44
 v_lshlrev_b32 v45, 16, v45
 v_mul_f32 v26, 0xbfb8aa3b, v45
 v_exp_f32 v26, v26
 s_nop 0
 v_add_f32 v26, 1.0, v26
 v_rcp_f32 v26, v26
 s_nop 0
 v_mul_f32 v45, v45, v26
 v_cvt_pk_bf16_f32 v45, v45, v45
 v_and_b32 v45, 0xffff0000, v45
 v_lshlrev_b32 v46, 16, v46
 v_mul_f32 v26, 0xbfb8aa3b, v46
 v_exp_f32 v26, v26
 s_nop 0
 v_add_f32 v26, 1.0, v26
 v_rcp_f32 v26, v26
 s_nop 0
 v_mul_f32 v46, v46, v26
 v_cvt_pk_bf16_f32 v46, v46, v46
 v_and_b32 v46, 0xffff0000, v46
 v_lshlrev_b32 v47, 16, v47
 v_mul_f32 v26, 0xbfb8aa3b, v47
 v_exp_f32 v26, v26
 s_nop 0
 v_add_f32 v26, 1.0, v26
 v_rcp_f32 v26, v26
 s_nop 0
 v_mul_f32 v47, v47, v26
 v_cvt_pk_bf16_f32 v47, v47, v47
 v_and_b32 v47, 0xffff0000, v47
 v_lshlrev_b32 v48, 16, v48
 v_mul_f32 v26, 0xbfb8aa3b, v48
 v_exp_f32 v26, v26
 s_nop 0
 v_add_f32 v26, 1.0, v26
 v_rcp_f32 v26, v26
 s_nop 0
 v_mul_f32 v48, v48, v26
 v_cvt_pk_bf16_f32 v48, v48, v48
 v_and_b32 v48, 0xffff0000, v48
 v_lshlrev_b32 v49, 16, v49
 v_mul_f32 v26, 0xbfb8aa3b, v49
 v_exp_f32 v26, v26
 s_nop 0
 v_add_f32 v26, 1.0, v26
 v_rcp_f32 v26, v26
 s_nop 0
 v_mul_f32 v49, v49, v26
 v_cvt_pk_bf16_f32 v49, v49, v49
 v_and_b32 v49, 0xffff0000, v49
 v_lshlrev_b32 v50, 16, v50
 v_mul_f32 v26, 0xbfb8aa3b, v50
 v_exp_f32 v26, v26
 s_nop 0
 v_add_f32 v26, 1.0, v26
 v_rcp_f32 v26, v26
 s_nop 0
 v_mul_f32 v50, v50, v26
 v_cvt_pk_bf16_f32 v50, v50, v50
 v_and_b32 v50, 0xffff0000, v50
 v_lshlrev_b32 v51, 16, v51
 v_mul_f32 v26, 0xbfb8aa3b, v51
 v_exp_f32 v26, v26
 s_nop 0
 v_add_f32 v26, 1.0, v26
 v_rcp_f32 v26, v26
 s_nop 0
 v_mul_f32 v51, v51, v26
 v_cvt_pk_bf16_f32 v51, v51, v51
 v_and_b32 v51, 0xffff0000, v51
 v_lshlrev_b32 v52, 16, v52
 v_mul_f32 v26, 0xbfb8aa3b, v52
 v_exp_f32 v26, v26
 s_nop 0
 v_add_f32 v26, 1.0, v26
 v_rcp_f32 v26, v26
 s_nop 0
 v_mul_f32 v52, v52, v26
 v_cvt_pk_bf16_f32 v52, v52, v52
 v_and_b32 v52, 0xffff0000, v52
 v_lshlrev_b32 v53, 16, v53
 v_mul_f32 v26, 0xbfb8aa3b, v53
 v_exp_f32 v26, v26
 s_nop 0
 v_add_f32 v26, 1.0, v26
 v_rcp_f32 v26, v26
 s_nop 0
 v_mul_f32 v53, v53, v26
 v_cvt_pk_bf16_f32 v53, v53, v53
 v_and_b32 v53, 0xffff0000, v53
 v_lshlrev_b32 v54, 16, v54
 v_mul_f32 v26, 0xbfb8aa3b, v54
 v_exp_f32 v26, v26
 s_nop 0
 v_add_f32 v26, 1.0, v26
 v_rcp_f32 v26, v26
 s_nop 0
 v_mul_f32 v54, v54, v26
 v_cvt_pk_bf16_f32 v54, v54, v54
 v_and_b32 v54, 0xffff0000, v54
 v_lshlrev_b32 v55, 16, v55
 v_mul_f32 v26, 0xbfb8aa3b, v55
 v_exp_f32 v26, v26
 s_nop 0
 v_add_f32 v26, 1.0, v26
 v_rcp_f32 v26, v26
 s_nop 0
 v_mul_f32 v55, v55, v26
 v_cvt_pk_bf16_f32 v55, v55, v55
 v_and_b32 v55, 0xffff0000, v55
 v_mov_b64 v[32:33], 0
 v_mov_b64 v[34:35], 0
 v_mov_b64 v[36:37], 0
 v_mov_b64 v[38:39], 0
 s_waitcnt vmcnt(15)
 v_lshlrev_b32 v26, 16, v64
 v_and_b32 v27, 0xffff0000, v64
 v_fmac_f32 v32, v26, v40
 v_fmac_f32 v33, v27, v40
 v_lshlrev_b32 v26, 16, v65
 v_and_b32 v27, 0xffff0000, v65
 v_fmac_f32 v34, v26, v40
 v_fmac_f32 v35, v27, v40
 v_lshlrev_b32 v26, 16, v66
 v_and_b32 v27, 0xffff0000, v66
 v_fmac_f32 v36, v26, v40
 v_fmac_f32 v37, v27, v40
 v_lshlrev_b32 v26, 16, v67
 v_and_b32 v27, 0xffff0000, v67
 v_fmac_f32 v38, v26, v40
 v_fmac_f32 v39, v27, v40
 s_waitcnt vmcnt(14)
 v_lshlrev_b32 v26, 16, v68
 v_and_b32 v27, 0xffff0000, v68
 v_fmac_f32 v32, v26, v41
 v_fmac_f32 v33, v27, v41
 v_lshlrev_b32 v26, 16, v69
 v_and_b32 v27, 0xffff0000, v69
 v_fmac_f32 v34, v26, v41
 v_fmac_f32 v35, v27, v41
 v_lshlrev_b32 v26, 16, v70
 v_and_b32 v27, 0xffff0000, v70
 v_fmac_f32 v36, v26, v41
 v_fmac_f32 v37, v27, v41
 v_lshlrev_b32 v26, 16, v71
 v_and_b32 v27, 0xffff0000, v71
 v_fmac_f32 v38, v26, v41
 v_fmac_f32 v39, v27, v41
 s_waitcnt vmcnt(13)
 v_lshlrev_b32 v26, 16, v72
 v_and_b32 v27, 0xffff0000, v72
 v_fmac_f32 v32, v26, v42
 v_fmac_f32 v33, v27, v42
 v_lshlrev_b32 v26, 16, v73
 v_and_b32 v27, 0xffff0000, v73
 v_fmac_f32 v34, v26, v42
 v_fmac_f32 v35, v27, v42
 v_lshlrev_b32 v26, 16, v74
 v_and_b32 v27, 0xffff0000, v74
 v_fmac_f32 v36, v26, v42
 v_fmac_f32 v37, v27, v42
 v_lshlrev_b32 v26, 16, v75
 v_and_b32 v27, 0xffff0000, v75
 v_fmac_f32 v38, v26, v42
 v_fmac_f32 v39, v27, v42
 s_waitcnt vmcnt(12)
 v_lshlrev_b32 v26, 16, v76
 v_and_b32 v27, 0xffff0000, v76
 v_fmac_f32 v32, v26, v43
 v_fmac_f32 v33, v27, v43
 v_lshlrev_b32 v26, 16, v77
 v_and_b32 v27, 0xffff0000, v77
 v_fmac_f32 v34, v26, v43
 v_fmac_f32 v35, v27, v43
 v_lshlrev_b32 v26, 16, v78
 v_and_b32 v27, 0xffff0000, v78
 v_fmac_f32 v36, v26, v43
 v_fmac_f32 v37, v27, v43
 v_lshlrev_b32 v26, 16, v79
 v_and_b32 v27, 0xffff0000, v79
 v_fmac_f32 v38, v26, v43
 v_fmac_f32 v39, v27, v43
 s_waitcnt vmcnt(11)
 v_lshlrev_b32 v26, 16, v80
 v_and_b32 v27, 0xffff0000, v80
 v_fmac_f32 v32, v26, v44
 v_fmac_f32 v33, v27, v44
 v_lshlrev_b32 v26, 16, v81
 v_and_b32 v27, 0xffff0000, v81
 v_fmac_f32 v34, v26, v44
 v_fmac_f32 v35, v27, v44
 v_lshlrev_b32 v26, 16, v82
 v_and_b32 v27, 0xffff0000, v82
 v_fmac_f32 v36, v26, v44
 v_fmac_f32 v37, v27, v44
 v_lshlrev_b32 v26, 16, v83
 v_and_b32 v27, 0xffff0000, v83
 v_fmac_f32 v38, v26, v44
 v_fmac_f32 v39, v27, v44
 s_waitcnt vmcnt(10)
 v_lshlrev_b32 v26, 16, v84
 v_and_b32 v27, 0xffff0000, v84
 v_fmac_f32 v32, v26, v45
 v_fmac_f32 v33, v27, v45
 v_lshlrev_b32 v26, 16, v85
 v_and_b32 v27, 0xffff0000, v85
 v_fmac_f32 v34, v26, v45
 v_fmac_f32 v35, v27, v45
 v_lshlrev_b32 v26, 16, v86
 v_and_b32 v27, 0xffff0000, v86
 v_fmac_f32 v36, v26, v45
 v_fmac_f32 v37, v27, v45
 v_lshlrev_b32 v26, 16, v87
 v_and_b32 v27, 0xffff0000, v87
 v_fmac_f32 v38, v26, v45
 v_fmac_f32 v39, v27, v45
 s_waitcnt vmcnt(9)
 v_lshlrev_b32 v26, 16, v88
 v_and_b32 v27, 0xffff0000, v88
 v_fmac_f32 v32, v26, v46
 v_fmac_f32 v33, v27, v46
 v_lshlrev_b32 v26, 16, v89
 v_and_b32 v27, 0xffff0000, v89
 v_fmac_f32 v34, v26, v46
 v_fmac_f32 v35, v27, v46
 v_lshlrev_b32 v26, 16, v90
 v_and_b32 v27, 0xffff0000, v90
 v_fmac_f32 v36, v26, v46
 v_fmac_f32 v37, v27, v46
 v_lshlrev_b32 v26, 16, v91
 v_and_b32 v27, 0xffff0000, v91
 v_fmac_f32 v38, v26, v46
 v_fmac_f32 v39, v27, v46
 s_waitcnt vmcnt(8)
 v_lshlrev_b32 v26, 16, v92
 v_and_b32 v27, 0xffff0000, v92
 v_fmac_f32 v32, v26, v47
 v_fmac_f32 v33, v27, v47
 v_lshlrev_b32 v26, 16, v93
 v_and_b32 v27, 0xffff0000, v93
 v_fmac_f32 v34, v26, v47
 v_fmac_f32 v35, v27, v47
 v_lshlrev_b32 v26, 16, v94
 v_and_b32 v27, 0xffff0000, v94
 v_fmac_f32 v36, v26, v47
 v_fmac_f32 v37, v27, v47
 v_lshlrev_b32 v26, 16, v95
 v_and_b32 v27, 0xffff0000, v95
 v_fmac_f32 v38, v26, v47
 v_fmac_f32 v39, v27, v47
 s_waitcnt vmcnt(7)
 v_lshlrev_b32 v26, 16, v96
 v_and_b32 v27, 0xffff0000, v96
 v_fmac_f32 v32, v26, v48
 v_fmac_f32 v33, v27, v48
 v_lshlrev_b32 v26, 16, v97
 v_and_b32 v27, 0xffff0000, v97
 v_fmac_f32 v34, v26, v48
 v_fmac_f32 v35, v27, v48
 v_lshlrev_b32 v26, 16, v98
 v_and_b32 v27, 0xffff0000, v98
 v_fmac_f32 v36, v26, v48
 v_fmac_f32 v37, v27, v48
 v_lshlrev_b32 v26, 16, v99
 v_and_b32 v27, 0xffff0000, v99
 v_fmac_f32 v38, v26, v48
 v_fmac_f32 v39, v27, v48
 s_waitcnt vmcnt(6)
 v_lshlrev_b32 v26, 16, v100
 v_and_b32 v27, 0xffff0000, v100
 v_fmac_f32 v32, v26, v49
 v_fmac_f32 v33, v27, v49
 v_lshlrev_b32 v26, 16, v101
 v_and_b32 v27, 0xffff0000, v101
 v_fmac_f32 v34, v26, v49
 v_fmac_f32 v35, v27, v49
 v_lshlrev_b32 v26, 16, v102
 v_and_b32 v27, 0xffff0000, v102
 v_fmac_f32 v36, v26, v49
 v_fmac_f32 v37, v27, v49
 v_lshlrev_b32 v26, 16, v103
 v_and_b32 v27, 0xffff0000, v103
 v_fmac_f32 v38, v26, v49
 v_fmac_f32 v39, v27, v49
 s_waitcnt vmcnt(5)
 v_lshlrev_b32 v26, 16, v104
 v_and_b32 v27, 0xffff0000, v104
 v_fmac_f32 v32, v26, v50
 v_fmac_f32 v33, v27, v50
 v_lshlrev_b32 v26, 16, v105
 v_and_b32 v27, 0xffff0000, v105
 v_fmac_f32 v34, v26, v50
 v_fmac_f32 v35, v27, v50
 v_lshlrev_b32 v26, 16, v106
 v_and_b32 v27, 0xffff0000, v106
 v_fmac_f32 v36, v26, v50
 v_fmac_f32 v37, v27, v50
 v_lshlrev_b32 v26, 16, v107
 v_and_b32 v27, 0xffff0000, v107
 v_fmac_f32 v38, v26, v50
 v_fmac_f32 v39, v27, v50
 s_waitcnt vmcnt(4)
 v_lshlrev_b32 v26, 16, v108
 v_and_b32 v27, 0xffff0000, v108
 v_fmac_f32 v32, v26, v51
 v_fmac_f32 v33, v27, v51
 v_lshlrev_b32 v26, 16, v109
 v_and_b32 v27, 0xffff0000, v109
 v_fmac_f32 v34, v26, v51
 v_fmac_f32 v35, v27, v51
 v_lshlrev_b32 v26, 16, v110
 v_and_b32 v27, 0xffff0000, v110
 v_fmac_f32 v36, v26, v51
 v_fmac_f32 v37, v27, v51
 v_lshlrev_b32 v26, 16, v111
 v_and_b32 v27, 0xffff0000, v111
 v_fmac_f32 v38, v26, v51
 v_fmac_f32 v39, v27, v51
 s_waitcnt vmcnt(3)
 v_lshlrev_b32 v26, 16, v112
 v_and_b32 v27, 0xffff0000, v112
 v_fmac_f32 v32, v26, v52
 v_fmac_f32 v33, v27, v52
 v_lshlrev_b32 v26, 16, v113
 v_and_b32 v27, 0xffff0000, v113
 v_fmac_f32 v34, v26, v52
 v_fmac_f32 v35, v27, v52
 v_lshlrev_b32 v26, 16, v114
 v_and_b32 v27, 0xffff0000, v114
 v_fmac_f32 v36, v26, v52
 v_fmac_f32 v37, v27, v52
 v_lshlrev_b32 v26, 16, v115
 v_and_b32 v27, 0xffff0000, v115
 v_fmac_f32 v38, v26, v52
 v_fmac_f32 v39, v27, v52
 s_waitcnt vmcnt(2)
 v_lshlrev_b32 v26, 16, v116
 v_and_b32 v27, 0xffff0000, v116
 v_fmac_f32 v32, v26, v53
 v_fmac_f32 v33, v27, v53
 v_lshlrev_b32 v26, 16, v117
 v_and_b32 v27, 0xffff0000, v117
 v_fmac_f32 v34, v26, v53
 v_fmac_f32 v35, v27, v53
 v_lshlrev_b32 v26, 16, v118
 v_and_b32 v27, 0xffff0000, v118
 v_fmac_f32 v36, v26, v53
 v_fmac_f32 v37, v27, v53
 v_lshlrev_b32 v26, 16, v119
 v_and_b32 v27, 0xffff0000, v119
 v_fmac_f32 v38, v26, v53
 v_fmac_f32 v39, v27, v53
 s_waitcnt vmcnt(1)
 v_lshlrev_b32 v26, 16, v120
 v_and_b32 v27, 0xffff0000, v120
 v_fmac_f32 v32, v26, v54
 v_fmac_f32 v33, v27, v54
 v_lshlrev_b32 v26, 16, v121
 v_and_b32 v27, 0xffff0000, v121
 v_fmac_f32 v34, v26, v54
 v_fmac_f32 v35, v27, v54
 v_lshlrev_b32 v26, 16, v122
 v_and_b32 v27, 0xffff0000, v122
 v_fmac_f32 v36, v26, v54
 v_fmac_f32 v37, v27, v54
 v_lshlrev_b32 v26, 16, v123
 v_and_b32 v27, 0xffff0000, v123
 v_fmac_f32 v38, v26, v54
 v_fmac_f32 v39, v27, v54
 s_waitcnt vmcnt(0)
 v_lshlrev_b32 v26, 16, v124
 v_and_b32 v27, 0xffff0000, v124
 v_fmac_f32 v32, v26, v55
 v_fmac_f32 v33, v27, v55
 v_lshlrev_b32 v26, 16, v125
 v_and_b32 v27, 0xffff0000, v125
 v_fmac_f32 v34, v26, v55
 v_fmac_f32 v35, v27, v55
 v_lshlrev_b32 v26, 16, v126
 v_and_b32 v27, 0xffff0000, v126
 v_fmac_f32 v36, v26, v55
 v_fmac_f32 v37, v27, v55
 v_lshlrev_b32 v26, 16, v127
 v_and_b32 v27, 0xffff0000, v127
 v_fmac_f32 v38, v26, v55
 v_fmac_f32 v39, v27, v55
 v_lshlrev_b32 v26, 8, v20
 v_lshl_add_u32 v26, v21, 5, v26
 ds_write_b128 v26, v[32:35]
 ds_write_b128 v26, v[36:39] offset:16
 s_waitcnt lgkmcnt(0)
 s_barrier
 v_readfirstlane_b32 s25, v31
 s_cmp_lt_u32 s25, 64
 s_cbranch_scc0 L_ini_1
 ds_read_b32 v64, v24 offset:0
 ds_read_b32 v65, v24 offset:256
 ds_read_b32 v66, v24 offset:512
 ds_read_b32 v67, v24 offset:768
 ds_read_b32 v68, v24 offset:1024
 ds_read_b32 v69, v24 offset:1280
 ds_read_b32 v70, v24 offset:1536
 ds_read_b32 v71, v24 offset:1792
 s_waitcnt lgkmcnt(0)
 ds_read_b32 v72, v24 offset:2048
 ds_read_b32 v73, v24 offset:2304
 ds_read_b32 v74, v24 offset:2560
 ds_read_b32 v75, v24 offset:2816
 ds_read_b32 v76, v24 offset:3072
 ds_read_b32 v77, v24 offset:3328
 ds_read_b32 v78, v24 offset:3584
 ds_read_b32 v79, v24 offset:3840
 s_waitcnt lgkmcnt(0)
 ds_read_b32 v80, v24 offset:4096
 ds_read_b32 v81, v24 offset:4352
 ds_read_b32 v82, v24 offset:4608
 ds_read_b32 v83, v24 offset:4864
 ds_read_b32 v84, v24 offset:5120
 ds_read_b32 v85, v24 offset:5376
 ds_read_b32 v86, v24 offset:5632
 ds_read_b32 v87, v24 offset:5888
 s_waitcnt lgkmcnt(0)
 ds_read_b32 v88, v24 offset:6144
 ds_read_b32 v89, v24 offset:6400
 ds_read_b32 v90, v24 offset:6656
 ds_read_b32 v91, v24 offset:6912
 ds_read_b32 v92, v24 offset:7168
 ds_read_b32 v93, v24 offset:7424
 ds_read_b32 v94, v24 offset:7680
 ds_read_b32 v95, v24 offset:7936
 s_waitcnt lgkmcnt(0)
 v_add_f32 v64, v64, v65
 v_add_f32 v64, v64, v66
 v_add_f32 v64, v64, v67
 v_add_f32 v64, v64, v68
 v_add_f32 v64, v64, v69
 v_add_f32 v64, v64, v70
 v_add_f32 v64, v64, v71
 v_add_f32 v64, v64, v72
 v_add_f32 v64, v64, v73
 v_add_f32 v64, v64, v74
 v_add_f32 v64, v64, v75
 v_add_f32 v64, v64, v76
 v_add_f32 v64, v64, v77
 v_add_f32 v64, v64, v78
 v_add_f32 v64, v64, v79
 v_add_f32 v64, v64, v80
 v_add_f32 v64, v64, v81
 v_add_f32 v64, v64, v82
 v_add_f32 v64, v64, v83
 v_add_f32 v64, v64, v84
 v_add_f32 v64, v64, v85
 v_add_f32 v64, v64, v86
 v_add_f32 v64, v64, v87
 v_add_f32 v64, v64, v88
 v_add_f32 v64, v64, v89
 v_add_f32 v64, v64, v90
 v_add_f32 v64, v64, v91
 v_add_f32 v64, v64, v92
 v_add_f32 v64, v64, v93
 v_add_f32 v64, v64, v94
 v_add_f32 v64, v64, v95
 v_cvt_pk_bf16_f32 v64, v64, v64
 v_and_b32 v64, 0xffff0000, v64
 v_add_f32 v65, 1.0, v64
 v_cvt_pk_bf16_f32 v65, v65, v65
 v_and_b32 v65, 0xffff0000, v65
 s_lshr_b32 s24, s16, 3
 s_cmp_eq_u32 s24, 1
 s_cselect_b64 vcc, -1, 0
 s_cmp_eq_u32 s24, 4
 s_cselect_b64 vcc, -1, vcc
 v_cndmask_b32 v64, v64, v65, vcc
 s_lshl_b32 s24, s16, 8
 s_add_u32 s24, s24, 0x120000
 buffer_store_dword v64, v24, s[4:7], s24 offen sc1
L_ini_1:
 s_waitcnt vmcnt(0)
 s_barrier
 s_cmp_lt_u32 s25, 64
 s_cbranch_scc0 L_ini2_2
 s_mov_b64 exec, 1
 v_mov_b32 v25, 1
 buffer_atomic_add v25, off, s[12:15], 0 offset:192
 s_mov_b64 exec, -1
L_ini2_2:
L_noinit:
 s_cmp_lt_u32 s16, 28
 s_cbranch_scc1 L_F
 s_cmp_lt_u32 s16, 32
 s_cbranch_scc1 L_exit
 s_sub_u32 s16, s16, 32
 v_lshrrev_b32 v20, 6, v31
 v_and_b32 v21, 63, v31
 v_readfirstlane_b32 s17, v20
 v_and_b32 v22, 15, v21
 v_lshrrev_b32 v23, 4, v21
 s_mov_b32 s28, -1
 s_mov_b32 s29, 0
 s_mov_b32 s30, 0
 s_mov_b32 s31, -1
 s_mov_b32 s39, 0x7f817f81
 s_mov_b32 s33, 0x3e0293ee
 s_load_dwordx2 s[48:49], s[0:1], 0
 s_load_dwordx2 s[50:51], s[0:1], 96
 v_and_b32 v24, 1, v23
 v_lshrrev_b32 v25, 1, v23
 v_lshl_add_u32 v26, v25, 4, v22
 v_lshlrev_b32 v27, 4, v26
 v_lshl_add_u32 v1, v24, 10, v27
 v_lshl_add_u32 v2, v24, 3, v27
 v_lshlrev_b32 v3, 1, v2
 v_lshlrev_b32 v6, 4, v21
 v_and_b32 v24, 31, v21
 v_lshlrev_b32 v4, 2, v24
 v_min_u32 v24, 13, v24
 s_lshr_b32 s36, s16, 5
 s_and_b32 s37, s16, 31
 s_and_b32 s24, s16, 16
 v_add_u32 v24, s24, v24
 v_lshlrev_b32 v5, 2, v24
 v_bfe_u32 v24, v21, 1, 2
 v_and_b32 v26, 1, v21
 v_lshlrev_b32 v26, 4, v26
 v_mov_b32 v27, 0x3f80
 v_lshlrev_b32 v27, v26, v27
 v_bfe_u32 v26, v21, 3, 1
 v_cmp_eq_u32 vcc, v26, v25
 s_nop 1
 v_cndmask_b32 v27, 0, v27, vcc
 v_cmp_eq_u32 vcc, 0, v24
 s_nop 1
 v_cndmask_b32 v8, 0, v27, vcc
 v_cmp_eq_u32 vcc, 1, v24
 s_nop 1
 v_cndmask_b32 v9, 0, v27, vcc
 v_cmp_eq_u32 vcc, 2, v24
 s_nop 1
 v_cndmask_b32 v10, 0, v27, vcc
 v_cmp_eq_u32 vcc, 3, v24
 s_nop 1
 v_cndmask_b32 v11, 0, v27, vcc
 s_waitcnt lgkmcnt(0)
 s_mov_b32 s76, s48
 s_and_b32 s77, s49, 0xffff
 s_mov_b32 s78, 0x200000
 s_mov_b32 s79, 0x20000
 s_mov_b32 s80, s50
 s_and_b32 s81, s51, 0xffff
 s_mov_b32 s82, 0x200000
 s_mov_b32 s83, 0x20000
 s_lshl_b32 s25, s17, 1
 s_add_u32 s25, s25, s36
 s_lshl_b32 s34, s25, 15
 s_lshl_b32 s24, s37, 10
 s_add_u32 s34, s34, s24
 s_add_u32 s34, s34, 0
 buffer_load_dwordx2 v[128:129], v2, s[76:79], s34 offen offset:0
 buffer_load_dwordx2 v[130:131], v2, s[76:79], s34 offen offset:512
 s_lshl_b32 s34, s25, 15
 s_lshl_b32 s24, s37, 10
 s_add_u32 s34, s34, s24
 s_add_u32 s34, s34, 262144
 buffer_load_dwordx2 v[132:133], v2, s[76:79], s34 offen offset:0
 buffer_load_dwordx2 v[134:135], v2, s[76:79], s34 offen offset:512
 s_lshl_b32 s34, s25, 15
 s_lshl_b32 s24, s37, 10
 s_add_u32 s34, s34, s24
 s_add_u32 s34, s34, 524288
 buffer_load_dwordx2 v[136:137], v2, s[76:79], s34 offen offset:0
 buffer_load_dwordx2 v[138:139], v2, s[76:79], s34 offen offset:512
 s_lshl_b32 s34, s25, 15
 s_lshl_b32 s24, s37, 10
 s_add_u32 s34, s34, s24
 s_add_u32 s34, s34, 786432
 buffer_load_dwordx2 v[140:141], v2, s[76:79], s34 offen offset:0
 buffer_load_dwordx2 v[142:143], v2, s[76:79], s34 offen offset:512
 s_lshl_b32 s34, s25, 15
 s_lshl_b32 s24, s37, 10
 s_add_u32 s34, s34, s24
 s_add_u32 s34, s34, 1048576
 buffer_load_dwordx2 v[144:145], v2, s[76:79], s34 offen offset:0
 buffer_load_dwordx2 v[146:147], v2, s[76:79], s34 offen offset:512
 s_lshl_b32 s34, s25, 15
 s_lshl_b32 s24, s37, 10
 s_add_u32 s34, s34, s24
 s_add_u32 s34, s34, 1310720
 buffer_load_dwordx2 v[148:149], v2, s[76:79], s34 offen offset:0
 buffer_load_dwordx2 v[150:151], v2, s[76:79], s34 offen offset:512
 s_lshl_b32 s34, s25, 15
 s_lshl_b32 s24, s37, 10
 s_add_u32 s34, s34, s24
 s_add_u32 s34, s34, 1572864
 buffer_load_dwordx2 v[152:153], v2, s[76:79], s34 offen offset:0
 buffer_load_dwordx2 v[154:155], v2, s[76:79], s34 offen offset:512
 s_lshl_b32 s34, s25, 15
 s_lshl_b32 s24, s37, 10
 s_add_u32 s34, s34, s24
 s_add_u32 s34, s34, 1835008
 buffer_load_dwordx2 v[156:157], v2, s[76:79], s34 offen offset:0
 buffer_load_dwordx2 v[158:159], v2, s[76:79], s34 offen offset:512
 s_cmp_eq_u32 s17, 0
 s_cbranch_scc0 L_winit_3_ok
 s_mov_b32 s23, 0
L_winit_3:
 buffer_load_dword v24, off, s[12:15], 0 offset:192 sc1
 s_add_u32 s23, s23, 1
 s_cmp_gt_u32 s23, 262144
 s_cbranch_scc1 L_bail
 s_waitcnt vmcnt(0)
 v_cmp_le_u32 vcc, 48, v24
 s_cbranch_vccnz L_winit_3_ok
 s_sleep 4
 s_branch L_winit_3
L_winit_3_ok:
 s_barrier
 s_mov_b32 s24, 0x120000
 buffer_load_dwordx4 v[32:35], v3, s[4:7], s24 offen offset:0 sc1
 buffer_load_dwordx4 v[36:39], v3, s[4:7], s24 offen offset:1024 sc1
 s_mov_b32 s24, 0x120800
 buffer_load_dwordx4 v[40:43], v3, s[4:7], s24 offen offset:0 sc1
 buffer_load_dwordx4 v[44:47], v3, s[4:7], s24 offen offset:1024 sc1
 s_mov_b32 s24, 0x121000
 buffer_load_dwordx4 v[48:51], v3, s[4:7], s24 offen offset:0 sc1
 buffer_load_dwordx4 v[52:55], v3, s[4:7], s24 offen offset:1024 sc1
 s_mov_b32 s24, 0x121800
 buffer_load_dwordx4 v[56:59], v3, s[4:7], s24 offen offset:0 sc1
 buffer_load_dwordx4 v[60:63], v3, s[4:7], s24 offen offset:1024 sc1
 s_mov_b32 s24, 0x122000
 buffer_load_dwordx4 v[64:67], v3, s[4:7], s24 offen offset:0 sc1
 buffer_load_dwordx4 v[68:71], v3, s[4:7], s24 offen offset:1024 sc1
 s_mov_b32 s24, 0x122800
 buffer_load_dwordx4 v[72:75], v3, s[4:7], s24 offen offset:0 sc1
 buffer_load_dwordx4 v[76:79], v3, s[4:7], s24 offen offset:1024 sc1
 s_waitcnt vmcnt(0)
 s_lshl_b32 s18, s17, 1
 s_add_u32 s18, s18, s36
 s_add_u32 s18, s18, 0
 s_lshl_b32 s24, s18, 5
 s_add_u32 s24, s24, s37
 s_lshl_b32 s34, s24, 10
 s_lshl_b32 s35, s24, 2
 s_lshl_b32 s21, s24, 15
 s_lshl_b32 s25, s18, 7
 v_lshlrev_b32 v12, 16, v128
 v_and_b32 v13, 0xffff0000, v128
 v_lshlrev_b32 v14, 16, v129
 v_and_b32 v15, 0xffff0000, v129
 v_lshlrev_b32 v16, 16, v130
 v_and_b32 v17, 0xffff0000, v130
 v_lshlrev_b32 v18, 16, v131
 v_and_b32 v19, 0xffff0000, v131
 v_add_f32 v28, v12, v13
 v_add_f32 v28, v28, v14
 v_add_f32 v28, v28, v15
 v_add_f32 v28, v28, v16
 v_add_f32 v28, v28, v17
 v_add_f32 v28, v28, v18
 v_add_f32 v28, v28, v19
 s_nop 1
 v_add_f32_dpp v28, v28, v28 quad_perm:[1,0,3,2] row_mask:0xf bank_mask:0xf
 s_nop 1
 v_add_f32_dpp v28, v28, v28 quad_perm:[2,3,0,1] row_mask:0xf bank_mask:0xf
 s_nop 1
 v_add_f32_dpp v28, v28, v28 row_half_mirror row_mask:0xf bank_mask:0xf
 s_nop 1
 v_add_f32_dpp v28, v28, v28 row_mirror row_mask:0xf bank_mask:0xf
 v_mov_b32 v29, v28
 s_nop 1
 v_permlane16_swap_b32 v29, v28
 v_add_f32 v28, v28, v29
 v_mov_b32 v29, v28
 s_nop 1
 v_permlane32_swap_b32 v29, v28
 v_add_f32 v28, v28, v29
 v_mul_f32 v31, 0x3b000000, v28
 v_sub_f32 v20, v12, v31
 v_sub_f32 v21, v13, v31
 v_sub_f32 v22, v14, v31
 v_sub_f32 v23, v15, v31
 v_sub_f32 v24, v16, v31
 v_sub_f32 v25, v17, v31
 v_sub_f32 v26, v18, v31
 v_sub_f32 v27, v19, v31
 v_mul_f32 v28, v20, v20
 v_fmac_f32 v28, v21, v21
 v_fmac_f32 v28, v22, v22
 v_fmac_f32 v28, v23, v23
 v_fmac_f32 v28, v24, v24
 v_fmac_f32 v28, v25, v25
 v_fmac_f32 v28, v26, v26
 v_fmac_f32 v28, v27, v27
 s_nop 1
 v_add_f32_dpp v28, v28, v28 quad_perm:[1,0,3,2] row_mask:0xf bank_mask:0xf
 s_nop 1
 v_add_f32_dpp v28, v28, v28 quad_perm:[2,3,0,1] row_mask:0xf bank_mask:0xf
 s_nop 1
 v_add_f32_dpp v28, v28, v28 row_half_mirror row_mask:0xf bank_mask:0xf
 s_nop 1
 v_add_f32_dpp v28, v28, v28 row_mirror row_mask:0xf bank_mask:0xf
 v_mov_b32 v29, v28
 s_nop 1
 v_permlane16_swap_b32 v29, v28
 v_add_f32 v28, v28, v29
 v_mov_b32 v29, v28
 s_nop 1
 v_permlane32_swap_b32 v29, v28
 v_add_f32 v28, v28, v29
 v_cvt_pk_bf16_f32 v31, v31, v31
 v_and_b32 v31, 0xffff0000, v31
 v_sub_f32 v20, v12, v31
 v_sub_f32 v21, v13, v31
 v_sub_f32 v22, v14, v31
 v_sub_f32 v23, v15, v31
 v_sub_f32 v24, v16, v31
 v_sub_f32 v25, v17, v31
 v_sub_f32 v26, v18, v31
 v_sub_f32 v27, v19, v31
 v_cvt_pk_bf16_f32 v80, v20, v21
 v_cvt_pk_bf16_f32 v81, v22, v23
 v_cvt_pk_bf16_f32 v82, v24, v25
 v_cvt_pk_bf16_f32 v83, v26, v27
 v_lshlrev_b32 v20, 16, v80
 v_and_b32 v21, 0xffff0000, v80
 v_lshlrev_b32 v22, 16, v81
 v_and_b32 v23, 0xffff0000, v81
 v_lshlrev_b32 v24, 16, v82
 v_and_b32 v25, 0xffff0000, v82
 v_lshlrev_b32 v26, 16, v83
 v_and_b32 v27, 0xffff0000, v83
 v_mul_f32 v28, 0x3b000000, v28
 v_cvt_pk_bf16_f32 v28, v28, v28
 v_and_b32 v28, 0xffff0000, v28
 v_add_f32 v28, 0x3727c5ac, v28
 v_cvt_pk_bf16_f32 v28, v28, v28
 v_and_b32 v28, 0xffff0000, v28
 v_sqrt_f32 v28, v28
 s_nop 0
 v_cvt_pk_bf16_f32 v28, v28, v28
 v_and_b32 v28, 0xffff0000, v28
 v_rcp_f32 v29, v28
 s_nop 0
 v_mul_f32 v20, v20, v29
 v_mul_f32 v21, v21, v29
 v_mul_f32 v22, v22, v29
 v_mul_f32 v23, v23, v29
 v_mul_f32 v24, v24, v29
 v_mul_f32 v25, v25, v29
 v_mul_f32 v26, v26, v29
 v_mul_f32 v27, v27, v29
 v_cvt_pk_bf16_f32 v80, v20, v21
 v_cvt_pk_bf16_f32 v81, v22, v23
 v_cvt_pk_bf16_f32 v82, v24, v25
 v_cvt_pk_bf16_f32 v83, v26, v27
 v_lshlrev_b32 v20, 16, v80
 v_and_b32 v21, 0xffff0000, v80
 v_lshlrev_b32 v22, 16, v81
 v_and_b32 v23, 0xffff0000, v81
 v_lshlrev_b32 v24, 16, v82
 v_and_b32 v25, 0xffff0000, v82
 v_lshlrev_b32 v26, 16, v83
 v_and_b32 v27, 0xffff0000, v83
 v_mul_f32 v20, v20, v40
 v_mul_f32 v21, v21, v41
 v_mul_f32 v22, v22, v42
 v_mul_f32 v23, v23, v43
 v_mul_f32 v24, v24, v44
 v_mul_f32 v25, v25, v45
 v_mul_f32 v26, v26, v46
 v_mul_f32 v27, v27, v47
 v_cvt_pk_bf16_f32 v80, v20, v21
 v_cvt_pk_bf16_f32 v81, v22, v23
 v_cvt_pk_bf16_f32 v82, v24, v25
 v_cvt_pk_bf16_f32 v83, v26, v27
 v_lshlrev_b32 v20, 16, v80
 v_and_b32 v21, 0xffff0000, v80
 v_lshlrev_b32 v22, 16, v81
 v_and_b32 v23, 0xffff0000, v81
 v_lshlrev_b32 v24, 16, v82
 v_and_b32 v25, 0xffff0000, v82
 v_lshlrev_b32 v26, 16, v83
 v_and_b32 v27, 0xffff0000, v83
 v_add_f32 v20, v20, v32
 v_add_f32 v21, v21, v33
 v_add_f32 v22, v22, v34
 v_add_f32 v23, v23, v35
 v_add_f32 v24, v24, v36
 v_add_f32 v25, v25, v37
 v_add_f32 v26, v26, v38
 v_add_f32 v27, v27, v39
 v_cvt_pk_bf16_f32 v80, v20, v21
 v_cvt_pk_bf16_f32 v81, v22, v23
 v_cvt_pk_bf16_f32 v82, v24, v25
 v_cvt_pk_bf16_f32 v83, v26, v27
 s_add_u32 s24, s34, 0x200000
 buffer_store_dwordx2 v[80:81], v2, s[4:7], s24 offen offset:0 sc1
 buffer_store_dwordx2 v[82:83], v2, s[4:7], s24 offen offset:512 sc1
 s_add_u32 s24, s35, 0x114000
 s_waitcnt vmcnt(0) lgkmcnt(0)
 s_mov_b64 exec, 1
 v_mov_b32 v29, 2
 buffer_store_dword v29, off, s[4:7], s24 sc1
 s_mov_b64 exec, -1
 s_lshl_b32 s18, s17, 1
 s_add_u32 s18, s18, s36
 s_add_u32 s18, s18, 8
 s_lshl_b32 s24, s18, 5
 s_add_u32 s24, s24, s37
 s_lshl_b32 s34, s24, 10
 s_lshl_b32 s35, s24, 2
 s_lshl_b32 s21, s24, 15
 s_lshl_b32 s25, s18, 7
 v_lshlrev_b32 v12, 16, v132
 v_and_b32 v13, 0xffff0000, v132
 v_lshlrev_b32 v14, 16, v133
 v_and_b32 v15, 0xffff0000, v133
 v_lshlrev_b32 v16, 16, v134
 v_and_b32 v17, 0xffff0000, v134
 v_lshlrev_b32 v18, 16, v135
 v_and_b32 v19, 0xffff0000, v135
 v_add_f32 v28, v12, v13
 v_add_f32 v28, v28, v14
 v_add_f32 v28, v28, v15
 v_add_f32 v28, v28, v16
 v_add_f32 v28, v28, v17
 v_add_f32 v28, v28, v18
 v_add_f32 v28, v28, v19
 s_nop 1
 v_add_f32_dpp v28, v28, v28 quad_perm:[1,0,3,2] row_mask:0xf bank_mask:0xf
 s_nop 1
 v_add_f32_dpp v28, v28, v28 quad_perm:[2,3,0,1] row_mask:0xf bank_mask:0xf
 s_nop 1
 v_add_f32_dpp v28, v28, v28 row_half_mirror row_mask:0xf bank_mask:0xf
 s_nop 1
 v_add_f32_dpp v28, v28, v28 row_mirror row_mask:0xf bank_mask:0xf
 v_mov_b32 v29, v28
 s_nop 1
 v_permlane16_swap_b32 v29, v28
 v_add_f32 v28, v28, v29
 v_mov_b32 v29, v28
 s_nop 1
 v_permlane32_swap_b32 v29, v28
 v_add_f32 v28, v28, v29
 v_mul_f32 v31, 0x3b000000, v28
 v_sub_f32 v20, v12, v31
 v_sub_f32 v21, v13, v31
 v_sub_f32 v22, v14, v31
 v_sub_f32 v23, v15, v31
 v_sub_f32 v24, v16, v31
 v_sub_f32 v25, v17, v31
 v_sub_f32 v26, v18, v31
 v_sub_f32 v27, v19, v31
 v_mul_f32 v28, v20, v20
 v_fmac_f32 v28, v21, v21
 v_fmac_f32 v28, v22, v22
 v_fmac_f32 v28, v23, v23
 v_fmac_f32 v28, v24, v24
 v_fmac_f32 v28, v25, v25
 v_fmac_f32 v28, v26, v26
 v_fmac_f32 v28, v27, v27
 s_nop 1
 v_add_f32_dpp v28, v28, v28 quad_perm:[1,0,3,2] row_mask:0xf bank_mask:0xf
 s_nop 1
 v_add_f32_dpp v28, v28, v28 quad_perm:[2,3,0,1] row_mask:0xf bank_mask:0xf
 s_nop 1
 v_add_f32_dpp v28, v28, v28 row_half_mirror row_mask:0xf bank_mask:0xf
 s_nop 1
 v_add_f32_dpp v28, v28, v28 row_mirror row_mask:0xf bank_mask:0xf
 v_mov_b32 v29, v28
 s_nop 1
 v_permlane16_swap_b32 v29, v28
 v_add_f32 v28, v28, v29
 v_mov_b32 v29, v28
 s_nop 1
 v_permlane32_swap_b32 v29, v28
 v_add_f32 v28, v28, v29
 v_cvt_pk_bf16_f32 v31, v31, v31
 v_and_b32 v31, 0xffff0000, v31
 v_sub_f32 v20, v12, v31
 v_sub_f32 v21, v13, v31
 v_sub_f32 v22, v14, v31
 v_sub_f32 v23, v15, v31
 v_sub_f32 v24, v16, v31
 v_sub_f32 v25, v17, v31
 v_sub_f32 v26, v18, v31
 v_sub_f32 v27, v19, v31
 v_cvt_pk_bf16_f32 v80, v20, v21
 v_cvt_pk_bf16_f32 v81, v22, v23
 v_cvt_pk_bf16_f32 v82, v24, v25
 v_cvt_pk_bf16_f32 v83, v26, v27
 v_lshlrev_b32 v20, 16, v80
 v_and_b32 v21, 0xffff0000, v80
 v_lshlrev_b32 v22, 16, v81
 v_and_b32 v23, 0xffff0000, v81
 v_lshlrev_b32 v24, 16, v82
 v_and_b32 v25, 0xffff0000, v82
 v_lshlrev_b32 v26, 16, v83
 v_and_b32 v27, 0xffff0000, v83
 v_mul_f32 v28, 0x3b000000, v28
 v_cvt_pk_bf16_f32 v28, v28, v28
 v_and_b32 v28, 0xffff0000, v28
 v_add_f32 v28, 0x3727c5ac, v28
 v_cvt_pk_bf16_f32 v28, v28, v28
 v_and_b32 v28, 0xffff0000, v28
 v_sqrt_f32 v28, v28
 s_nop 0
 v_cvt_pk_bf16_f32 v28, v28, v28
 v_and_b32 v28, 0xffff0000, v28
 v_rcp_f32 v29, v28
 s_nop 0
 v_mul_f32 v20, v20, v29
 v_mul_f32 v21, v21, v29
 v_mul_f32 v22, v22, v29
 v_mul_f32 v23, v23, v29
 v_mul_f32 v24, v24, v29
 v_mul_f32 v25, v25, v29
 v_mul_f32 v26, v26, v29
 v_mul_f32 v27, v27, v29
 v_cvt_pk_bf16_f32 v80, v20, v21
 v_cvt_pk_bf16_f32 v81, v22, v23
 v_cvt_pk_bf16_f32 v82, v24, v25
 v_cvt_pk_bf16_f32 v83, v26, v27
 v_lshlrev_b32 v20, 16, v80
 v_and_b32 v21, 0xffff0000, v80
 v_lshlrev_b32 v22, 16, v81
 v_and_b32 v23, 0xffff0000, v81
 v_lshlrev_b32 v24, 16, v82
 v_and_b32 v25, 0xffff0000, v82
 v_lshlrev_b32 v26, 16, v83
 v_and_b32 v27, 0xffff0000, v83
 v_mul_f32 v20, v20, v40
 v_mul_f32 v21, v21, v41
 v_mul_f32 v22, v22, v42
 v_mul_f32 v23, v23, v43
 v_mul_f32 v24, v24, v44
 v_mul_f32 v25, v25, v45
 v_mul_f32 v26, v26, v46
 v_mul_f32 v27, v27, v47
 v_cvt_pk_bf16_f32 v80, v20, v21
 v_cvt_pk_bf16_f32 v81, v22, v23
 v_cvt_pk_bf16_f32 v82, v24, v25
 v_cvt_pk_bf16_f32 v83, v26, v27
 v_lshlrev_b32 v20, 16, v80
 v_and_b32 v21, 0xffff0000, v80
 v_lshlrev_b32 v22, 16, v81
 v_and_b32 v23, 0xffff0000, v81
 v_lshlrev_b32 v24, 16, v82
 v_and_b32 v25, 0xffff0000, v82
 v_lshlrev_b32 v26, 16, v83
 v_and_b32 v27, 0xffff0000, v83
 v_add_f32 v20, v20, v32
 v_add_f32 v21, v21, v33
 v_add_f32 v22, v22, v34
 v_add_f32 v23, v23, v35
 v_add_f32 v24, v24, v36
 v_add_f32 v25, v25, v37
 v_add_f32 v26, v26, v38
 v_add_f32 v27, v27, v39
 v_cvt_pk_bf16_f32 v80, v20, v21
 v_cvt_pk_bf16_f32 v81, v22, v23
 v_cvt_pk_bf16_f32 v82, v24, v25
 v_cvt_pk_bf16_f32 v83, v26, v27
 s_add_u32 s24, s34, 0x200000
 buffer_store_dwordx2 v[80:81], v2, s[4:7], s24 offen offset:0 sc1
 buffer_store_dwordx2 v[82:83], v2, s[4:7], s24 offen offset:512 sc1
 s_add_u32 s24, s35, 0x114000
 s_waitcnt vmcnt(0) lgkmcnt(0)
 s_mov_b64 exec, 1
 v_mov_b32 v29, 2
 buffer_store_dword v29, off, s[4:7], s24 sc1
 s_mov_b64 exec, -1
 s_lshl_b32 s18, s17, 1
 s_add_u32 s18, s18, s36
 s_add_u32 s18, s18, 16
 s_lshl_b32 s24, s18, 5
 s_add_u32 s24, s24, s37
 s_lshl_b32 s34, s24, 10
 s_lshl_b32 s35, s24, 2
 s_lshl_b32 s21, s24, 15
 s_lshl_b32 s25, s18, 7
 v_lshlrev_b32 v12, 16, v136
 v_and_b32 v13, 0xffff0000, v136
 v_lshlrev_b32 v14, 16, v137
 v_and_b32 v15, 0xffff0000, v137
 v_lshlrev_b32 v16, 16, v138
 v_and_b32 v17, 0xffff0000, v138
 v_lshlrev_b32 v18, 16, v139
 v_and_b32 v19, 0xffff0000, v139
 v_add_f32 v28, v12, v13
 v_add_f32 v28, v28, v14
 v_add_f32 v28, v28, v15
 v_add_f32 v28, v28, v16
 v_add_f32 v28, v28, v17
 v_add_f32 v28, v28, v18
 v_add_f32 v28, v28, v19
 s_nop 1
 v_add_f32_dpp v28, v28, v28 quad_perm:[1,0,3,2] row_mask:0xf bank_mask:0xf
 s_nop 1
 v_add_f32_dpp v28, v28, v28 quad_perm:[2,3,0,1] row_mask:0xf bank_mask:0xf
 s_nop 1
 v_add_f32_dpp v28, v28, v28 row_half_mirror row_mask:0xf bank_mask:0xf
 s_nop 1
 v_add_f32_dpp v28, v28, v28 row_mirror row_mask:0xf bank_mask:0xf
 v_mov_b32 v29, v28
 s_nop 1
 v_permlane16_swap_b32 v29, v28
 v_add_f32 v28, v28, v29
 v_mov_b32 v29, v28
 s_nop 1
 v_permlane32_swap_b32 v29, v28
 v_add_f32 v28, v28, v29
 v_mul_f32 v31, 0x3b000000, v28
 v_sub_f32 v20, v12, v31
 v_sub_f32 v21, v13, v31
 v_sub_f32 v22, v14, v31
 v_sub_f32 v23, v15, v31
 v_sub_f32 v24, v16, v31
 v_sub_f32 v25, v17, v31
 v_sub_f32 v26, v18, v31
 v_sub_f32 v27, v19, v31
 v_mul_f32 v28, v20, v20
 v_fmac_f32 v28, v21, v21
 v_fmac_f32 v28, v22, v22
 v_fmac_f32 v28, v23, v23
 v_fmac_f32 v28, v24, v24
 v_fmac_f32 v28, v25, v25
 v_fmac_f32 v28, v26, v26
 v_fmac_f32 v28, v27, v27
 s_nop 1
 v_add_f32_dpp v28, v28, v28 quad_perm:[1,0,3,2] row_mask:0xf bank_mask:0xf
 s_nop 1
 v_add_f32_dpp v28, v28, v28 quad_perm:[2,3,0,1] row_mask:0xf bank_mask:0xf
 s_nop 1
 v_add_f32_dpp v28, v28, v28 row_half_mirror row_mask:0xf bank_mask:0xf
 s_nop 1
 v_add_f32_dpp v28, v28, v28 row_mirror row_mask:0xf bank_mask:0xf
 v_mov_b32 v29, v28
 s_nop 1
 v_permlane16_swap_b32 v29, v28
 v_add_f32 v28, v28, v29
 v_mov_b32 v29, v28
 s_nop 1
 v_permlane32_swap_b32 v29, v28
 v_add_f32 v28, v28, v29
 v_cvt_pk_bf16_f32 v31, v31, v31
 v_and_b32 v31, 0xffff0000, v31
 v_sub_f32 v20, v12, v31
 v_sub_f32 v21, v13, v31
 v_sub_f32 v22, v14, v31
 v_sub_f32 v23, v15, v31
 v_sub_f32 v24, v16, v31
 v_sub_f32 v25, v17, v31
 v_sub_f32 v26, v18, v31
 v_sub_f32 v27, v19, v31
 v_cvt_pk_bf16_f32 v80, v20, v21
 v_cvt_pk_bf16_f32 v81, v22, v23
 v_cvt_pk_bf16_f32 v82, v24, v25
 v_cvt_pk_bf16_f32 v83, v26, v27
 v_lshlrev_b32 v20, 16, v80
 v_and_b32 v21, 0xffff0000, v80
 v_lshlrev_b32 v22, 16, v81
 v_and_b32 v23, 0xffff0000, v81
 v_lshlrev_b32 v24, 16, v82
 v_and_b32 v25, 0xffff0000, v82
 v_lshlrev_b32 v26, 16, v83
 v_and_b32 v27, 0xffff0000, v83
 v_mul_f32 v28, 0x3b000000, v28
 v_cvt_pk_bf16_f32 v28, v28, v28
 v_and_b32 v28, 0xffff0000, v28
 v_add_f32 v28, 0x3727c5ac, v28
 v_cvt_pk_bf16_f32 v28, v28, v28
 v_and_b32 v28, 0xffff0000, v28
 v_sqrt_f32 v28, v28
 s_nop 0
 v_cvt_pk_bf16_f32 v28, v28, v28
 v_and_b32 v28, 0xffff0000, v28
 v_rcp_f32 v29, v28
 s_nop 0
 v_mul_f32 v20, v20, v29
 v_mul_f32 v21, v21, v29
 v_mul_f32 v22, v22, v29
 v_mul_f32 v23, v23, v29
 v_mul_f32 v24, v24, v29
 v_mul_f32 v25, v25, v29
 v_mul_f32 v26, v26, v29
 v_mul_f32 v27, v27, v29
 v_cvt_pk_bf16_f32 v80, v20, v21
 v_cvt_pk_bf16_f32 v81, v22, v23
 v_cvt_pk_bf16_f32 v82, v24, v25
 v_cvt_pk_bf16_f32 v83, v26, v27
 v_lshlrev_b32 v20, 16, v80
 v_and_b32 v21, 0xffff0000, v80
 v_lshlrev_b32 v22, 16, v81
 v_and_b32 v23, 0xffff0000, v81
 v_lshlrev_b32 v24, 16, v82
 v_and_b32 v25, 0xffff0000, v82
 v_lshlrev_b32 v26, 16, v83
 v_and_b32 v27, 0xffff0000, v83
 v_mul_f32 v20, v20, v40
 v_mul_f32 v21, v21, v41
 v_mul_f32 v22, v22, v42
 v_mul_f32 v23, v23, v43
 v_mul_f32 v24, v24, v44
 v_mul_f32 v25, v25, v45
 v_mul_f32 v26, v26, v46
 v_mul_f32 v27, v27, v47
 v_cvt_pk_bf16_f32 v80, v20, v21
 v_cvt_pk_bf16_f32 v81, v22, v23
 v_cvt_pk_bf16_f32 v82, v24, v25
 v_cvt_pk_bf16_f32 v83, v26, v27
 v_lshlrev_b32 v20, 16, v80
 v_and_b32 v21, 0xffff0000, v80
 v_lshlrev_b32 v22, 16, v81
 v_and_b32 v23, 0xffff0000, v81
 v_lshlrev_b32 v24, 16, v82
 v_and_b32 v25, 0xffff0000, v82
 v_lshlrev_b32 v26, 16, v83
 v_and_b32 v27, 0xffff0000, v83
 v_add_f32 v20, v20, v32
 v_add_f32 v21, v21, v33
 v_add_f32 v22, v22, v34
 v_add_f32 v23, v23, v35
 v_add_f32 v24, v24, v36
 v_add_f32 v25, v25, v37
 v_add_f32 v26, v26, v38
 v_add_f32 v27, v27, v39
 v_cvt_pk_bf16_f32 v80, v20, v21
 v_cvt_pk_bf16_f32 v81, v22, v23
 v_cvt_pk_bf16_f32 v82, v24, v25
 v_cvt_pk_bf16_f32 v83, v26, v27
 s_add_u32 s24, s34, 0x200000
 buffer_store_dwordx2 v[80:81], v2, s[4:7], s24 offen offset:0 sc1
 buffer_store_dwordx2 v[82:83], v2, s[4:7], s24 offen offset:512 sc1
 s_add_u32 s24, s35, 0x114000
 s_waitcnt vmcnt(0) lgkmcnt(0)
 s_mov_b64 exec, 1
 v_mov_b32 v29, 2
 buffer_store_dword v29, off, s[4:7], s24 sc1
 s_mov_b64 exec, -1
 s_lshl_b32 s18, s17, 1
 s_add_u32 s18, s18, s36
 s_add_u32 s18, s18, 24
 s_lshl_b32 s24, s18, 5
 s_add_u32 s24, s24, s37
 s_lshl_b32 s34, s24, 10
 s_lshl_b32 s35, s24, 2
 s_lshl_b32 s21, s24, 15
 s_lshl_b32 s25, s18, 7
 v_lshlrev_b32 v12, 16, v140
 v_and_b32 v13, 0xffff0000, v140
 v_lshlrev_b32 v14, 16, v141
 v_and_b32 v15, 0xffff0000, v141
 v_lshlrev_b32 v16, 16, v142
 v_and_b32 v17, 0xffff0000, v142
 v_lshlrev_b32 v18, 16, v143
 v_and_b32 v19, 0xffff0000, v143
 v_add_f32 v28, v12, v13
 v_add_f32 v28, v28, v14
 v_add_f32 v28, v28, v15
 v_add_f32 v28, v28, v16
 v_add_f32 v28, v28, v17
 v_add_f32 v28, v28, v18
 v_add_f32 v28, v28, v19
 s_nop 1
 v_add_f32_dpp v28, v28, v28 quad_perm:[1,0,3,2] row_mask:0xf bank_mask:0xf
 s_nop 1
 v_add_f32_dpp v28, v28, v28 quad_perm:[2,3,0,1] row_mask:0xf bank_mask:0xf
 s_nop 1
 v_add_f32_dpp v28, v28, v28 row_half_mirror row_mask:0xf bank_mask:0xf
 s_nop 1
 v_add_f32_dpp v28, v28, v28 row_mirror row_mask:0xf bank_mask:0xf
 v_mov_b32 v29, v28
 s_nop 1
 v_permlane16_swap_b32 v29, v28
 v_add_f32 v28, v28, v29
 v_mov_b32 v29, v28
 s_nop 1
 v_permlane32_swap_b32 v29, v28
 v_add_f32 v28, v28, v29
 v_mul_f32 v31, 0x3b000000, v28
 v_sub_f32 v20, v12, v31
 v_sub_f32 v21, v13, v31
 v_sub_f32 v22, v14, v31
 v_sub_f32 v23, v15, v31
 v_sub_f32 v24, v16, v31
 v_sub_f32 v25, v17, v31
 v_sub_f32 v26, v18, v31
 v_sub_f32 v27, v19, v31
 v_mul_f32 v28, v20, v20
 v_fmac_f32 v28, v21, v21
 v_fmac_f32 v28, v22, v22
 v_fmac_f32 v28, v23, v23
 v_fmac_f32 v28, v24, v24
 v_fmac_f32 v28, v25, v25
 v_fmac_f32 v28, v26, v26
 v_fmac_f32 v28, v27, v27
 s_nop 1
 v_add_f32_dpp v28, v28, v28 quad_perm:[1,0,3,2] row_mask:0xf bank_mask:0xf
 s_nop 1
 v_add_f32_dpp v28, v28, v28 quad_perm:[2,3,0,1] row_mask:0xf bank_mask:0xf
 s_nop 1
 v_add_f32_dpp v28, v28, v28 row_half_mirror row_mask:0xf bank_mask:0xf
 s_nop 1
 v_add_f32_dpp v28, v28, v28 row_mirror row_mask:0xf bank_mask:0xf
 v_mov_b32 v29, v28
 s_nop 1
 v_permlane16_swap_b32 v29, v28
 v_add_f32 v28, v28, v29
 v_mov_b32 v29, v28
 s_nop 1
 v_permlane32_swap_b32 v29, v28
 v_add_f32 v28, v28, v29
 v_cvt_pk_bf16_f32 v31, v31, v31
 v_and_b32 v31, 0xffff0000, v31
 v_sub_f32 v20, v12, v31
 v_sub_f32 v21, v13, v31
 v_sub_f32 v22, v14, v31
 v_sub_f32 v23, v15, v31
 v_sub_f32 v24, v16, v31
 v_sub_f32 v25, v17, v31
 v_sub_f32 v26, v18, v31
 v_sub_f32 v27, v19, v31
 v_cvt_pk_bf16_f32 v80, v20, v21
 v_cvt_pk_bf16_f32 v81, v22, v23
 v_cvt_pk_bf16_f32 v82, v24, v25
 v_cvt_pk_bf16_f32 v83, v26, v27
 v_lshlrev_b32 v20, 16, v80
 v_and_b32 v21, 0xffff0000, v80
 v_lshlrev_b32 v22, 16, v81
 v_and_b32 v23, 0xffff0000, v81
 v_lshlrev_b32 v24, 16, v82
 v_and_b32 v25, 0xffff0000, v82
 v_lshlrev_b32 v26, 16, v83
 v_and_b32 v27, 0xffff0000, v83
 v_mul_f32 v28, 0x3b000000, v28
 v_cvt_pk_bf16_f32 v28, v28, v28
 v_and_b32 v28, 0xffff0000, v28
 v_add_f32 v28, 0x3727c5ac, v28
 v_cvt_pk_bf16_f32 v28, v28, v28
 v_and_b32 v28, 0xffff0000, v28
 v_sqrt_f32 v28, v28
 s_nop 0
 v_cvt_pk_bf16_f32 v28, v28, v28
 v_and_b32 v28, 0xffff0000, v28
 v_rcp_f32 v29, v28
 s_nop 0
 v_mul_f32 v20, v20, v29
 v_mul_f32 v21, v21, v29
 v_mul_f32 v22, v22, v29
 v_mul_f32 v23, v23, v29
 v_mul_f32 v24, v24, v29
 v_mul_f32 v25, v25, v29
 v_mul_f32 v26, v26, v29
 v_mul_f32 v27, v27, v29
 v_cvt_pk_bf16_f32 v80, v20, v21
 v_cvt_pk_bf16_f32 v81, v22, v23
 v_cvt_pk_bf16_f32 v82, v24, v25
 v_cvt_pk_bf16_f32 v83, v26, v27
 v_lshlrev_b32 v20, 16, v80
 v_and_b32 v21, 0xffff0000, v80
 v_lshlrev_b32 v22, 16, v81
 v_and_b32 v23, 0xffff0000, v81
 v_lshlrev_b32 v24, 16, v82
 v_and_b32 v25, 0xffff0000, v82
 v_lshlrev_b32 v26, 16, v83
 v_and_b32 v27, 0xffff0000, v83
 v_mul_f32 v20, v20, v40
 v_mul_f32 v21, v21, v41
 v_mul_f32 v22, v22, v42
 v_mul_f32 v23, v23, v43
 v_mul_f32 v24, v24, v44
 v_mul_f32 v25, v25, v45
 v_mul_f32 v26, v26, v46
 v_mul_f32 v27, v27, v47
 v_cvt_pk_bf16_f32 v80, v20, v21
 v_cvt_pk_bf16_f32 v81, v22, v23
 v_cvt_pk_bf16_f32 v82, v24, v25
 v_cvt_pk_bf16_f32 v83, v26, v27
 v_lshlrev_b32 v20, 16, v80
 v_and_b32 v21, 0xffff0000, v80
 v_lshlrev_b32 v22, 16, v81
 v_and_b32 v23, 0xffff0000, v81
 v_lshlrev_b32 v24, 16, v82
 v_and_b32 v25, 0xffff0000, v82
 v_lshlrev_b32 v26, 16, v83
 v_and_b32 v27, 0xffff0000, v83
 v_add_f32 v20, v20, v32
 v_add_f32 v21, v21, v33
 v_add_f32 v22, v22, v34
 v_add_f32 v23, v23, v35
 v_add_f32 v24, v24, v36
 v_add_f32 v25, v25, v37
 v_add_f32 v26, v26, v38
 v_add_f32 v27, v27, v39
 v_cvt_pk_bf16_f32 v80, v20, v21
 v_cvt_pk_bf16_f32 v81, v22, v23
 v_cvt_pk_bf16_f32 v82, v24, v25
 v_cvt_pk_bf16_f32 v83, v26, v27
 s_add_u32 s24, s34, 0x200000
 buffer_store_dwordx2 v[80:81], v2, s[4:7], s24 offen offset:0 sc1
 buffer_store_dwordx2 v[82:83], v2, s[4:7], s24 offen offset:512 sc1
 s_add_u32 s24, s35, 0x114000
 s_waitcnt vmcnt(0) lgkmcnt(0)
 s_mov_b64 exec, 1
 v_mov_b32 v29, 2
 buffer_store_dword v29, off, s[4:7], s24 sc1
 s_mov_b64 exec, -1
 s_lshl_b32 s18, s17, 1
 s_add_u32 s18, s18, s36
 s_add_u32 s18, s18, 32
 s_lshl_b32 s24, s18, 5
 s_add_u32 s24, s24, s37
 s_lshl_b32 s34, s24, 10
 s_lshl_b32 s35, s24, 2
 s_lshl_b32 s21, s24, 15
 s_lshl_b32 s25, s18, 7
 v_lshlrev_b32 v12, 16, v144
 v_and_b32 v13, 0xffff0000, v144
 v_lshlrev_b32 v14, 16, v145
 v_and_b32 v15, 0xffff0000, v145
 v_lshlrev_b32 v16, 16, v146
 v_and_b32 v17, 0xffff0000, v146
 v_lshlrev_b32 v18, 16, v147
 v_and_b32 v19, 0xffff0000, v147
 v_add_f32 v28, v12, v13
 v_add_f32 v28, v28, v14
 v_add_f32 v28, v28, v15
 v_add_f32 v28, v28, v16
 v_add_f32 v28, v28, v17
 v_add_f32 v28, v28, v18
 v_add_f32 v28, v28, v19
 s_nop 1
 v_add_f32_dpp v28, v28, v28 quad_perm:[1,0,3,2] row_mask:0xf bank_mask:0xf
 s_nop 1
 v_add_f32_dpp v28, v28, v28 quad_perm:[2,3,0,1] row_mask:0xf bank_mask:0xf
 s_nop 1
 v_add_f32_dpp v28, v28, v28 row_half_mirror row_mask:0xf bank_mask:0xf
 s_nop 1
 v_add_f32_dpp v28, v28, v28 row_mirror row_mask:0xf bank_mask:0xf
 v_mov_b32 v29, v28
 s_nop 1
 v_permlane16_swap_b32 v29, v28
 v_add_f32 v28, v28, v29
 v_mov_b32 v29, v28
 s_nop 1
 v_permlane32_swap_b32 v29, v28
 v_add_f32 v28, v28, v29
 v_mul_f32 v31, 0x3b000000, v28
 v_sub_f32 v20, v12, v31
 v_sub_f32 v21, v13, v31
 v_sub_f32 v22, v14, v31
 v_sub_f32 v23, v15, v31
 v_sub_f32 v24, v16, v31
 v_sub_f32 v25, v17, v31
 v_sub_f32 v26, v18, v31
 v_sub_f32 v27, v19, v31
 v_mul_f32 v28, v20, v20
 v_fmac_f32 v28, v21, v21
 v_fmac_f32 v28, v22, v22
 v_fmac_f32 v28, v23, v23
 v_fmac_f32 v28, v24, v24
 v_fmac_f32 v28, v25, v25
 v_fmac_f32 v28, v26, v26
 v_fmac_f32 v28, v27, v27
 s_nop 1
 v_add_f32_dpp v28, v28, v28 quad_perm:[1,0,3,2] row_mask:0xf bank_mask:0xf
 s_nop 1
 v_add_f32_dpp v28, v28, v28 quad_perm:[2,3,0,1] row_mask:0xf bank_mask:0xf
 s_nop 1
 v_add_f32_dpp v28, v28, v28 row_half_mirror row_mask:0xf bank_mask:0xf
 s_nop 1
 v_add_f32_dpp v28, v28, v28 row_mirror row_mask:0xf bank_mask:0xf
 v_mov_b32 v29, v28
 s_nop 1
 v_permlane16_swap_b32 v29, v28
 v_add_f32 v28, v28, v29
 v_mov_b32 v29, v28
 s_nop 1
 v_permlane32_swap_b32 v29, v28
 v_add_f32 v28, v28, v29
 v_cvt_pk_bf16_f32 v31, v31, v31
 v_and_b32 v31, 0xffff0000, v31
 v_sub_f32 v20, v12, v31
 v_sub_f32 v21, v13, v31
 v_sub_f32 v22, v14, v31
 v_sub_f32 v23, v15, v31
 v_sub_f32 v24, v16, v31
 v_sub_f32 v25, v17, v31
 v_sub_f32 v26, v18, v31
 v_sub_f32 v27, v19, v31
 v_cvt_pk_bf16_f32 v80, v20, v21
 v_cvt_pk_bf16_f32 v81, v22, v23
 v_cvt_pk_bf16_f32 v82, v24, v25
 v_cvt_pk_bf16_f32 v83, v26, v27
 v_lshlrev_b32 v20, 16, v80
 v_and_b32 v21, 0xffff0000, v80
 v_lshlrev_b32 v22, 16, v81
 v_and_b32 v23, 0xffff0000, v81
 v_lshlrev_b32 v24, 16, v82
 v_and_b32 v25, 0xffff0000, v82
 v_lshlrev_b32 v26, 16, v83
 v_and_b32 v27, 0xffff0000, v83
 v_mul_f32 v28, 0x3b000000, v28
 v_cvt_pk_bf16_f32 v28, v28, v28
 v_and_b32 v28, 0xffff0000, v28
 v_add_f32 v28, 0x3727c5ac, v28
 v_cvt_pk_bf16_f32 v28, v28, v28
 v_and_b32 v28, 0xffff0000, v28
 v_sqrt_f32 v28, v28
 s_nop 0
 v_cvt_pk_bf16_f32 v28, v28, v28
 v_and_b32 v28, 0xffff0000, v28
 v_rcp_f32 v29, v28
 s_nop 0
 v_mul_f32 v20, v20, v29
 v_mul_f32 v21, v21, v29
 v_mul_f32 v22, v22, v29
 v_mul_f32 v23, v23, v29
 v_mul_f32 v24, v24, v29
 v_mul_f32 v25, v25, v29
 v_mul_f32 v26, v26, v29
 v_mul_f32 v27, v27, v29
 v_cvt_pk_bf16_f32 v80, v20, v21
 v_cvt_pk_bf16_f32 v81, v22, v23
 v_cvt_pk_bf16_f32 v82, v24, v25
 v_cvt_pk_bf16_f32 v83, v26, v27
 v_lshlrev_b32 v20, 16, v80
 v_and_b32 v21, 0xffff0000, v80
 v_lshlrev_b32 v22, 16, v81
 v_and_b32 v23, 0xffff0000, v81
 v_lshlrev_b32 v24, 16, v82
 v_and_b32 v25, 0xffff0000, v82
 v_lshlrev_b32 v26, 16, v83
 v_and_b32 v27, 0xffff0000, v83
 v_mul_f32 v20, v20, v40
 v_mul_f32 v21, v21, v41
 v_mul_f32 v22, v22, v42
 v_mul_f32 v23, v23, v43
 v_mul_f32 v24, v24, v44
 v_mul_f32 v25, v25, v45
 v_mul_f32 v26, v26, v46
 v_mul_f32 v27, v27, v47
 v_cvt_pk_bf16_f32 v80, v20, v21
 v_cvt_pk_bf16_f32 v81, v22, v23
 v_cvt_pk_bf16_f32 v82, v24, v25
 v_cvt_pk_bf16_f32 v83, v26, v27
 v_lshlrev_b32 v20, 16, v80
 v_and_b32 v21, 0xffff0000, v80
 v_lshlrev_b32 v22, 16, v81
 v_and_b32 v23, 0xffff0000, v81
 v_lshlrev_b32 v24, 16, v82
 v_and_b32 v25, 0xffff0000, v82
 v_lshlrev_b32 v26, 16, v83
 v_and_b32 v27, 0xffff0000, v83
 v_add_f32 v20, v20, v32
 v_add_f32 v21, v21, v33
 v_add_f32 v22, v22, v34
 v_add_f32 v23, v23, v35
 v_add_f32 v24, v24, v36
 v_add_f32 v25, v25, v37
 v_add_f32 v26, v26, v38
 v_add_f32 v27, v27, v39
 v_cvt_pk_bf16_f32 v80, v20, v21
 v_cvt_pk_bf16_f32 v81, v22, v23
 v_cvt_pk_bf16_f32 v82, v24, v25
 v_cvt_pk_bf16_f32 v83, v26, v27
 s_add_u32 s24, s34, 0x200000
 buffer_store_dwordx2 v[80:81], v2, s[4:7], s24 offen offset:0 sc1
 buffer_store_dwordx2 v[82:83], v2, s[4:7], s24 offen offset:512 sc1
 s_add_u32 s24, s35, 0x114000
 s_waitcnt vmcnt(0) lgkmcnt(0)
 s_mov_b64 exec, 1
 v_mov_b32 v29, 2
 buffer_store_dword v29, off, s[4:7], s24 sc1
 s_mov_b64 exec, -1
 s_lshl_b32 s18, s17, 1
 s_add_u32 s18, s18, s36
 s_add_u32 s18, s18, 40
 s_lshl_b32 s24, s18, 5
 s_add_u32 s24, s24, s37
 s_lshl_b32 s34, s24, 10
 s_lshl_b32 s35, s24, 2
 s_lshl_b32 s21, s24, 15
 s_lshl_b32 s25, s18, 7
 v_lshlrev_b32 v12, 16, v148
 v_and_b32 v13, 0xffff0000, v148
 v_lshlrev_b32 v14, 16, v149
 v_and_b32 v15, 0xffff0000, v149
 v_lshlrev_b32 v16, 16, v150
 v_and_b32 v17, 0xffff0000, v150
 v_lshlrev_b32 v18, 16, v151
 v_and_b32 v19, 0xffff0000, v151
 v_add_f32 v28, v12, v13
 v_add_f32 v28, v28, v14
 v_add_f32 v28, v28, v15
 v_add_f32 v28, v28, v16
 v_add_f32 v28, v28, v17
 v_add_f32 v28, v28, v18
 v_add_f32 v28, v28, v19
 s_nop 1
 v_add_f32_dpp v28, v28, v28 quad_perm:[1,0,3,2] row_mask:0xf bank_mask:0xf
 s_nop 1
 v_add_f32_dpp v28, v28, v28 quad_perm:[2,3,0,1] row_mask:0xf bank_mask:0xf
 s_nop 1
 v_add_f32_dpp v28, v28, v28 row_half_mirror row_mask:0xf bank_mask:0xf
 s_nop 1
 v_add_f32_dpp v28, v28, v28 row_mirror row_mask:0xf bank_mask:0xf
 v_mov_b32 v29, v28
 s_nop 1
 v_permlane16_swap_b32 v29, v28
 v_add_f32 v28, v28, v29
 v_mov_b32 v29, v28
 s_nop 1
 v_permlane32_swap_b32 v29, v28
 v_add_f32 v28, v28, v29
 v_mul_f32 v31, 0x3b000000, v28
 v_sub_f32 v20, v12, v31
 v_sub_f32 v21, v13, v31
 v_sub_f32 v22, v14, v31
 v_sub_f32 v23, v15, v31
 v_sub_f32 v24, v16, v31
 v_sub_f32 v25, v17, v31
 v_sub_f32 v26, v18, v31
 v_sub_f32 v27, v19, v31
 v_mul_f32 v28, v20, v20
 v_fmac_f32 v28, v21, v21
 v_fmac_f32 v28, v22, v22
 v_fmac_f32 v28, v23, v23
 v_fmac_f32 v28, v24, v24
 v_fmac_f32 v28, v25, v25
 v_fmac_f32 v28, v26, v26
 v_fmac_f32 v28, v27, v27
 s_nop 1
 v_add_f32_dpp v28, v28, v28 quad_perm:[1,0,3,2] row_mask:0xf bank_mask:0xf
 s_nop 1
 v_add_f32_dpp v28, v28, v28 quad_perm:[2,3,0,1] row_mask:0xf bank_mask:0xf
 s_nop 1
 v_add_f32_dpp v28, v28, v28 row_half_mirror row_mask:0xf bank_mask:0xf
 s_nop 1
 v_add_f32_dpp v28, v28, v28 row_mirror row_mask:0xf bank_mask:0xf
 v_mov_b32 v29, v28
 s_nop 1
 v_permlane16_swap_b32 v29, v28
 v_add_f32 v28, v28, v29
 v_mov_b32 v29, v28
 s_nop 1
 v_permlane32_swap_b32 v29, v28
 v_add_f32 v28, v28, v29
 v_cvt_pk_bf16_f32 v31, v31, v31
 v_and_b32 v31, 0xffff0000, v31
 v_sub_f32 v20, v12, v31
 v_sub_f32 v21, v13, v31
 v_sub_f32 v22, v14, v31
 v_sub_f32 v23, v15, v31
 v_sub_f32 v24, v16, v31
 v_sub_f32 v25, v17, v31
 v_sub_f32 v26, v18, v31
 v_sub_f32 v27, v19, v31
 v_cvt_pk_bf16_f32 v80, v20, v21
 v_cvt_pk_bf16_f32 v81, v22, v23
 v_cvt_pk_bf16_f32 v82, v24, v25
 v_cvt_pk_bf16_f32 v83, v26, v27
 v_lshlrev_b32 v20, 16, v80
 v_and_b32 v21, 0xffff0000, v80
 v_lshlrev_b32 v22, 16, v81
 v_and_b32 v23, 0xffff0000, v81
 v_lshlrev_b32 v24, 16, v82
 v_and_b32 v25, 0xffff0000, v82
 v_lshlrev_b32 v26, 16, v83
 v_and_b32 v27, 0xffff0000, v83
 v_mul_f32 v28, 0x3b000000, v28
 v_cvt_pk_bf16_f32 v28, v28, v28
 v_and_b32 v28, 0xffff0000, v28
 v_add_f32 v28, 0x3727c5ac, v28
 v_cvt_pk_bf16_f32 v28, v28, v28
 v_and_b32 v28, 0xffff0000, v28
 v_sqrt_f32 v28, v28
 s_nop 0
 v_cvt_pk_bf16_f32 v28, v28, v28
 v_and_b32 v28, 0xffff0000, v28
 v_rcp_f32 v29, v28
 s_nop 0
 v_mul_f32 v20, v20, v29
 v_mul_f32 v21, v21, v29
 v_mul_f32 v22, v22, v29
 v_mul_f32 v23, v23, v29
 v_mul_f32 v24, v24, v29
 v_mul_f32 v25, v25, v29
 v_mul_f32 v26, v26, v29
 v_mul_f32 v27, v27, v29
 v_cvt_pk_bf16_f32 v80, v20, v21
 v_cvt_pk_bf16_f32 v81, v22, v23
 v_cvt_pk_bf16_f32 v82, v24, v25
 v_cvt_pk_bf16_f32 v83, v26, v27
 v_lshlrev_b32 v20, 16, v80
 v_and_b32 v21, 0xffff0000, v80
 v_lshlrev_b32 v22, 16, v81
 v_and_b32 v23, 0xffff0000, v81
 v_lshlrev_b32 v24, 16, v82
 v_and_b32 v25, 0xffff0000, v82
 v_lshlrev_b32 v26, 16, v83
 v_and_b32 v27, 0xffff0000, v83
 v_mul_f32 v20, v20, v40
 v_mul_f32 v21, v21, v41
 v_mul_f32 v22, v22, v42
 v_mul_f32 v23, v23, v43
 v_mul_f32 v24, v24, v44
 v_mul_f32 v25, v25, v45
 v_mul_f32 v26, v26, v46
 v_mul_f32 v27, v27, v47
 v_cvt_pk_bf16_f32 v80, v20, v21
 v_cvt_pk_bf16_f32 v81, v22, v23
 v_cvt_pk_bf16_f32 v82, v24, v25
 v_cvt_pk_bf16_f32 v83, v26, v27
 v_lshlrev_b32 v20, 16, v80
 v_and_b32 v21, 0xffff0000, v80
 v_lshlrev_b32 v22, 16, v81
 v_and_b32 v23, 0xffff0000, v81
 v_lshlrev_b32 v24, 16, v82
 v_and_b32 v25, 0xffff0000, v82
 v_lshlrev_b32 v26, 16, v83
 v_and_b32 v27, 0xffff0000, v83
 v_add_f32 v20, v20, v32
 v_add_f32 v21, v21, v33
 v_add_f32 v22, v22, v34
 v_add_f32 v23, v23, v35
 v_add_f32 v24, v24, v36
 v_add_f32 v25, v25, v37
 v_add_f32 v26, v26, v38
 v_add_f32 v27, v27, v39
 v_cvt_pk_bf16_f32 v80, v20, v21
 v_cvt_pk_bf16_f32 v81, v22, v23
 v_cvt_pk_bf16_f32 v82, v24, v25
 v_cvt_pk_bf16_f32 v83, v26, v27
 s_add_u32 s24, s34, 0x200000
 buffer_store_dwordx2 v[80:81], v2, s[4:7], s24 offen offset:0 sc1
 buffer_store_dwordx2 v[82:83], v2, s[4:7], s24 offen offset:512 sc1
 s_add_u32 s24, s35, 0x114000
 s_waitcnt vmcnt(0) lgkmcnt(0)
 s_mov_b64 exec, 1
 v_mov_b32 v29, 2
 buffer_store_dword v29, off, s[4:7], s24 sc1
 s_mov_b64 exec, -1
 s_lshl_b32 s18, s17, 1
 s_add_u32 s18, s18, s36
 s_add_u32 s18, s18, 48
 s_lshl_b32 s24, s18, 5
 s_add_u32 s24, s24, s37
 s_lshl_b32 s34, s24, 10
 s_lshl_b32 s35, s24, 2
 s_lshl_b32 s21, s24, 15
 s_lshl_b32 s25, s18, 7
 v_lshlrev_b32 v12, 16, v152
 v_and_b32 v13, 0xffff0000, v152
 v_lshlrev_b32 v14, 16, v153
 v_and_b32 v15, 0xffff0000, v153
 v_lshlrev_b32 v16, 16, v154
 v_and_b32 v17, 0xffff0000, v154
 v_lshlrev_b32 v18, 16, v155
 v_and_b32 v19, 0xffff0000, v155
 v_add_f32 v28, v12, v13
 v_add_f32 v28, v28, v14
 v_add_f32 v28, v28, v15
 v_add_f32 v28, v28, v16
 v_add_f32 v28, v28, v17
 v_add_f32 v28, v28, v18
 v_add_f32 v28, v28, v19
 s_nop 1
 v_add_f32_dpp v28, v28, v28 quad_perm:[1,0,3,2] row_mask:0xf bank_mask:0xf
 s_nop 1
 v_add_f32_dpp v28, v28, v28 quad_perm:[2,3,0,1] row_mask:0xf bank_mask:0xf
 s_nop 1
 v_add_f32_dpp v28, v28, v28 row_half_mirror row_mask:0xf bank_mask:0xf
 s_nop 1
 v_add_f32_dpp v28, v28, v28 row_mirror row_mask:0xf bank_mask:0xf
 v_mov_b32 v29, v28
 s_nop 1
 v_permlane16_swap_b32 v29, v28
 v_add_f32 v28, v28, v29
 v_mov_b32 v29, v28
 s_nop 1
 v_permlane32_swap_b32 v29, v28
 v_add_f32 v28, v28, v29
 v_mul_f32 v31, 0x3b000000, v28
 v_sub_f32 v20, v12, v31
 v_sub_f32 v21, v13, v31
 v_sub_f32 v22, v14, v31
 v_sub_f32 v23, v15, v31
 v_sub_f32 v24, v16, v31
 v_sub_f32 v25, v17, v31
 v_sub_f32 v26, v18, v31
 v_sub_f32 v27, v19, v31
 v_mul_f32 v28, v20, v20
 v_fmac_f32 v28, v21, v21
 v_fmac_f32 v28, v22, v22
 v_fmac_f32 v28, v23, v23
 v_fmac_f32 v28, v24, v24
 v_fmac_f32 v28, v25, v25
 v_fmac_f32 v28, v26, v26
 v_fmac_f32 v28, v27, v27
 s_nop 1
 v_add_f32_dpp v28, v28, v28 quad_perm:[1,0,3,2] row_mask:0xf bank_mask:0xf
 s_nop 1
 v_add_f32_dpp v28, v28, v28 quad_perm:[2,3,0,1] row_mask:0xf bank_mask:0xf
 s_nop 1
 v_add_f32_dpp v28, v28, v28 row_half_mirror row_mask:0xf bank_mask:0xf
 s_nop 1
 v_add_f32_dpp v28, v28, v28 row_mirror row_mask:0xf bank_mask:0xf
 v_mov_b32 v29, v28
 s_nop 1
 v_permlane16_swap_b32 v29, v28
 v_add_f32 v28, v28, v29
 v_mov_b32 v29, v28
 s_nop 1
 v_permlane32_swap_b32 v29, v28
 v_add_f32 v28, v28, v29
 v_cvt_pk_bf16_f32 v31, v31, v31
 v_and_b32 v31, 0xffff0000, v31
 v_sub_f32 v20, v12, v31
 v_sub_f32 v21, v13, v31
 v_sub_f32 v22, v14, v31
 v_sub_f32 v23, v15, v31
 v_sub_f32 v24, v16, v31
 v_sub_f32 v25, v17, v31
 v_sub_f32 v26, v18, v31
 v_sub_f32 v27, v19, v31
 v_cvt_pk_bf16_f32 v80, v20, v21
 v_cvt_pk_bf16_f32 v81, v22, v23
 v_cvt_pk_bf16_f32 v82, v24, v25
 v_cvt_pk_bf16_f32 v83, v26, v27
 v_lshlrev_b32 v20, 16, v80
 v_and_b32 v21, 0xffff0000, v80
 v_lshlrev_b32 v22, 16, v81
 v_and_b32 v23, 0xffff0000, v81
 v_lshlrev_b32 v24, 16, v82
 v_and_b32 v25, 0xffff0000, v82
 v_lshlrev_b32 v26, 16, v83
 v_and_b32 v27, 0xffff0000, v83
 v_mul_f32 v28, 0x3b000000, v28
 v_cvt_pk_bf16_f32 v28, v28, v28
 v_and_b32 v28, 0xffff0000, v28
 v_add_f32 v28, 0x3727c5ac, v28
 v_cvt_pk_bf16_f32 v28, v28, v28
 v_and_b32 v28, 0xffff0000, v28
 v_sqrt_f32 v28, v28
 s_nop 0
 v_cvt_pk_bf16_f32 v28, v28, v28
 v_and_b32 v28, 0xffff0000, v28
 v_rcp_f32 v29, v28
 s_nop 0
 v_mul_f32 v20, v20, v29
 v_mul_f32 v21, v21, v29
 v_mul_f32 v22, v22, v29
 v_mul_f32 v23, v23, v29
 v_mul_f32 v24, v24, v29
 v_mul_f32 v25, v25, v29
 v_mul_f32 v26, v26, v29
 v_mul_f32 v27, v27, v29
 v_cvt_pk_bf16_f32 v80, v20, v21
 v_cvt_pk_bf16_f32 v81, v22, v23
 v_cvt_pk_bf16_f32 v82, v24, v25
 v_cvt_pk_bf16_f32 v83, v26, v27
 v_lshlrev_b32 v20, 16, v80
 v_and_b32 v21, 0xffff0000, v80
 v_lshlrev_b32 v22, 16, v81
 v_and_b32 v23, 0xffff0000, v81
 v_lshlrev_b32 v24, 16, v82
 v_and_b32 v25, 0xffff0000, v82
 v_lshlrev_b32 v26, 16, v83
 v_and_b32 v27, 0xffff0000, v83
 v_mul_f32 v20, v20, v40
 v_mul_f32 v21, v21, v41
 v_mul_f32 v22, v22, v42
 v_mul_f32 v23, v23, v43
 v_mul_f32 v24, v24, v44
 v_mul_f32 v25, v25, v45
 v_mul_f32 v26, v26, v46
 v_mul_f32 v27, v27, v47
 v_cvt_pk_bf16_f32 v80, v20, v21
 v_cvt_pk_bf16_f32 v81, v22, v23
 v_cvt_pk_bf16_f32 v82, v24, v25
 v_cvt_pk_bf16_f32 v83, v26, v27
 v_lshlrev_b32 v20, 16, v80
 v_and_b32 v21, 0xffff0000, v80
 v_lshlrev_b32 v22, 16, v81
 v_and_b32 v23, 0xffff0000, v81
 v_lshlrev_b32 v24, 16, v82
 v_and_b32 v25, 0xffff0000, v82
 v_lshlrev_b32 v26, 16, v83
 v_and_b32 v27, 0xffff0000, v83
 v_add_f32 v20, v20, v32
 v_add_f32 v21, v21, v33
 v_add_f32 v22, v22, v34
 v_add_f32 v23, v23, v35
 v_add_f32 v24, v24, v36
 v_add_f32 v25, v25, v37
 v_add_f32 v26, v26, v38
 v_add_f32 v27, v27, v39
 v_cvt_pk_bf16_f32 v80, v20, v21
 v_cvt_pk_bf16_f32 v81, v22, v23
 v_cvt_pk_bf16_f32 v82, v24, v25
 v_cvt_pk_bf16_f32 v83, v26, v27
 s_add_u32 s24, s34, 0x200000
 buffer_store_dwordx2 v[80:81], v2, s[4:7], s24 offen offset:0 sc1
 buffer_store_dwordx2 v[82:83], v2, s[4:7], s24 offen offset:512 sc1
 s_add_u32 s24, s35, 0x114000
 s_waitcnt vmcnt(0) lgkmcnt(0)
 s_mov_b64 exec, 1
 v_mov_b32 v29, 2
 buffer_store_dword v29, off, s[4:7], s24 sc1
 s_mov_b64 exec, -1
 s_lshl_b32 s18, s17, 1
 s_add_u32 s18, s18, s36
 s_add_u32 s18, s18, 56
 s_lshl_b32 s24, s18, 5
 s_add_u32 s24, s24, s37
 s_lshl_b32 s34, s24, 10
 s_lshl_b32 s35, s24, 2
 s_lshl_b32 s21, s24, 15
 s_lshl_b32 s25, s18, 7
 v_lshlrev_b32 v12, 16, v156
 v_and_b32 v13, 0xffff0000, v156
 v_lshlrev_b32 v14, 16, v157
 v_and_b32 v15, 0xffff0000, v157
 v_lshlrev_b32 v16, 16, v158
 v_and_b32 v17, 0xffff0000, v158
 v_lshlrev_b32 v18, 16, v159
 v_and_b32 v19, 0xffff0000, v159
 v_add_f32 v28, v12, v13
 v_add_f32 v28, v28, v14
 v_add_f32 v28, v28, v15
 v_add_f32 v28, v28, v16
 v_add_f32 v28, v28, v17
 v_add_f32 v28, v28, v18
 v_add_f32 v28, v28, v19
 s_nop 1
 v_add_f32_dpp v28, v28, v28 quad_perm:[1,0,3,2] row_mask:0xf bank_mask:0xf
 s_nop 1
 v_add_f32_dpp v28, v28, v28 quad_perm:[2,3,0,1] row_mask:0xf bank_mask:0xf
 s_nop 1
 v_add_f32_dpp v28, v28, v28 row_half_mirror row_mask:0xf bank_mask:0xf
 s_nop 1
 v_add_f32_dpp v28, v28, v28 row_mirror row_mask:0xf bank_mask:0xf
 v_mov_b32 v29, v28
 s_nop 1
 v_permlane16_swap_b32 v29, v28
 v_add_f32 v28, v28, v29
 v_mov_b32 v29, v28
 s_nop 1
 v_permlane32_swap_b32 v29, v28
 v_add_f32 v28, v28, v29
 v_mul_f32 v31, 0x3b000000, v28
 v_sub_f32 v20, v12, v31
 v_sub_f32 v21, v13, v31
 v_sub_f32 v22, v14, v31
 v_sub_f32 v23, v15, v31
 v_sub_f32 v24, v16, v31
 v_sub_f32 v25, v17, v31
 v_sub_f32 v26, v18, v31
 v_sub_f32 v27, v19, v31
 v_mul_f32 v28, v20, v20
 v_fmac_f32 v28, v21, v21
 v_fmac_f32 v28, v22, v22
 v_fmac_f32 v28, v23, v23
 v_fmac_f32 v28, v24, v24
 v_fmac_f32 v28, v25, v25
 v_fmac_f32 v28, v26, v26
 v_fmac_f32 v28, v27, v27
 s_nop 1
 v_add_f32_dpp v28, v28, v28 quad_perm:[1,0,3,2] row_mask:0xf bank_mask:0xf
 s_nop 1
 v_add_f32_dpp v28, v28, v28 quad_perm:[2,3,0,1] row_mask:0xf bank_mask:0xf
 s_nop 1
 v_add_f32_dpp v28, v28, v28 row_half_mirror row_mask:0xf bank_mask:0xf
 s_nop 1
 v_add_f32_dpp v28, v28, v28 row_mirror row_mask:0xf bank_mask:0xf
 v_mov_b32 v29, v28
 s_nop 1
 v_permlane16_swap_b32 v29, v28
 v_add_f32 v28, v28, v29
 v_mov_b32 v29, v28
 s_nop 1
 v_permlane32_swap_b32 v29, v28
 v_add_f32 v28, v28, v29
 v_cvt_pk_bf16_f32 v31, v31, v31
 v_and_b32 v31, 0xffff0000, v31
 v_sub_f32 v20, v12, v31
 v_sub_f32 v21, v13, v31
 v_sub_f32 v22, v14, v31
 v_sub_f32 v23, v15, v31
 v_sub_f32 v24, v16, v31
 v_sub_f32 v25, v17, v31
 v_sub_f32 v26, v18, v31
 v_sub_f32 v27, v19, v31
 v_cvt_pk_bf16_f32 v80, v20, v21
 v_cvt_pk_bf16_f32 v81, v22, v23
 v_cvt_pk_bf16_f32 v82, v24, v25
 v_cvt_pk_bf16_f32 v83, v26, v27
 v_lshlrev_b32 v20, 16, v80
 v_and_b32 v21, 0xffff0000, v80
 v_lshlrev_b32 v22, 16, v81
 v_and_b32 v23, 0xffff0000, v81
 v_lshlrev_b32 v24, 16, v82
 v_and_b32 v25, 0xffff0000, v82
 v_lshlrev_b32 v26, 16, v83
 v_and_b32 v27, 0xffff0000, v83
 v_mul_f32 v28, 0x3b000000, v28
 v_cvt_pk_bf16_f32 v28, v28, v28
 v_and_b32 v28, 0xffff0000, v28
 v_add_f32 v28, 0x3727c5ac, v28
 v_cvt_pk_bf16_f32 v28, v28, v28
 v_and_b32 v28, 0xffff0000, v28
 v_sqrt_f32 v28, v28
 s_nop 0
 v_cvt_pk_bf16_f32 v28, v28, v28
 v_and_b32 v28, 0xffff0000, v28
 v_rcp_f32 v29, v28
 s_nop 0
 v_mul_f32 v20, v20, v29
 v_mul_f32 v21, v21, v29
 v_mul_f32 v22, v22, v29
 v_mul_f32 v23, v23, v29
 v_mul_f32 v24, v24, v29
 v_mul_f32 v25, v25, v29
 v_mul_f32 v26, v26, v29
 v_mul_f32 v27, v27, v29
 v_cvt_pk_bf16_f32 v80, v20, v21
 v_cvt_pk_bf16_f32 v81, v22, v23
 v_cvt_pk_bf16_f32 v82, v24, v25
 v_cvt_pk_bf16_f32 v83, v26, v27
 v_lshlrev_b32 v20, 16, v80
 v_and_b32 v21, 0xffff0000, v80
 v_lshlrev_b32 v22, 16, v81
 v_and_b32 v23, 0xffff0000, v81
 v_lshlrev_b32 v24, 16, v82
 v_and_b32 v25, 0xffff0000, v82
 v_lshlrev_b32 v26, 16, v83
 v_and_b32 v27, 0xffff0000, v83
 v_mul_f32 v20, v20, v40
 v_mul_f32 v21, v21, v41
 v_mul_f32 v22, v22, v42
 v_mul_f32 v23, v23, v43
 v_mul_f32 v24, v24, v44
 v_mul_f32 v25, v25, v45
 v_mul_f32 v26, v26, v46
 v_mul_f32 v27, v27, v47
 v_cvt_pk_bf16_f32 v80, v20, v21
 v_cvt_pk_bf16_f32 v81, v22, v23
 v_cvt_pk_bf16_f32 v82, v24, v25
 v_cvt_pk_bf16_f32 v83, v26, v27
 v_lshlrev_b32 v20, 16, v80
 v_and_b32 v21, 0xffff0000, v80
 v_lshlrev_b32 v22, 16, v81
 v_and_b32 v23, 0xffff0000, v81
 v_lshlrev_b32 v24, 16, v82
 v_and_b32 v25, 0xffff0000, v82
 v_lshlrev_b32 v26, 16, v83
 v_and_b32 v27, 0xffff0000, v83
 v_add_f32 v20, v20, v32
 v_add_f32 v21, v21, v33
 v_add_f32 v22, v22, v34
 v_add_f32 v23, v23, v35
 v_add_f32 v24, v24, v36
 v_add_f32 v25, v25, v37
 v_add_f32 v26, v26, v38
 v_add_f32 v27, v27, v39
 v_cvt_pk_bf16_f32 v80, v20, v21
 v_cvt_pk_bf16_f32 v81, v22, v23
 v_cvt_pk_bf16_f32 v82, v24, v25
 v_cvt_pk_bf16_f32 v83, v26, v27
 s_add_u32 s24, s34, 0x200000
 buffer_store_dwordx2 v[80:81], v2, s[4:7], s24 offen offset:0 sc1
 buffer_store_dwordx2 v[82:83], v2, s[4:7], s24 offen offset:512 sc1
 s_add_u32 s24, s35, 0x114000
 s_waitcnt vmcnt(0) lgkmcnt(0)
 s_mov_b64 exec, 1
 v_mov_b32 v29, 2
 buffer_store_dword v29, off, s[4:7], s24 sc1
 s_mov_b64 exec, -1
 s_and_b32 s18, s17, 1
 s_lshl_b32 s18, s18, 1
 s_add_u32 s18, s18, s36
 s_cmp_ge_u32 s17, 2
 s_cbranch_scc1 L_d2l_6
L_d1l_5:
 s_lshl_b32 s24, s18, 5
 s_add_u32 s24, s24, s37
 s_lshl_b32 s34, s24, 10
 s_lshl_b32 s35, s24, 2
 s_lshl_b32 s21, s24, 15
 s_lshl_b32 s25, s18, 7
 buffer_load_dwordx2 v[84:85], v2, s[76:79], s34 offen offset:0
 buffer_load_dwordx2 v[86:87], v2, s[76:79], s34 offen offset:512
 s_add_u32 s25, s25, 0x116000
 s_add_u32 s21, s21, 0x4000000
 s_mov_b32 s23, 0
L_wline_8:
 buffer_load_dword v24, v4, s[4:7], s25 offen sc1
 s_add_u32 s23, s23, 1
 s_cmp_gt_u32 s23, 262144
 s_cbranch_scc1 L_bail
 s_waitcnt vmcnt(0)
 v_cmp_gt_u32 vcc, 1, v24
 s_cbranch_vccz L_wline_8_ok
 s_sleep 2
 s_branch L_wline_8
L_wline_8_ok:
 v_lshlrev_b32 v12, 16, v84
 v_and_b32 v13, 0xffff0000, v84
 v_lshlrev_b32 v14, 16, v85
 v_and_b32 v15, 0xffff0000, v85
 v_lshlrev_b32 v16, 16, v86
 v_and_b32 v17, 0xffff0000, v86
 v_lshlrev_b32 v18, 16, v87
 v_and_b32 v19, 0xffff0000, v87
 s_mov_b32 s27, 0
L_rt_9:
 s_add_u32 s24, s21, 0
 buffer_load_dwordx4 v[128:131], v1, s[4:7], s24 offen offset:0 sc1
 buffer_load_dwordx4 v[132:135], v1, s[4:7], s24 offen offset:512 sc1
 s_add_u32 s24, s21, 2048
 buffer_load_dwordx4 v[136:139], v1, s[4:7], s24 offen offset:0 sc1
 buffer_load_dwordx4 v[140:143], v1, s[4:7], s24 offen offset:512 sc1
 s_add_u32 s24, s21, 4096
 buffer_load_dwordx4 v[144:147], v1, s[4:7], s24 offen offset:0 sc1
 buffer_load_dwordx4 v[148:151], v1, s[4:7], s24 offen offset:512 sc1
 s_add_u32 s24, s21, 6144
 buffer_load_dwordx4 v[152:155], v1, s[4:7], s24 offen offset:0 sc1
 buffer_load_dwordx4 v[156:159], v1, s[4:7], s24 offen offset:512 sc1
 s_add_u32 s24, s21, 8192
 buffer_load_dwordx4 v[160:163], v1, s[4:7], s24 offen offset:0 sc1
 buffer_load_dwordx4 v[164:167], v1, s[4:7], s24 offen offset:512 sc1
 s_add_u32 s24, s21, 10240
 buffer_load_dwordx4 v[168:171], v1, s[4:7], s24 offen offset:0 sc1
 buffer_load_dwordx4 v[172:175], v1, s[4:7], s24 offen offset:512 sc1
 s_add_u32 s24, s21, 12288
 buffer_load_dwordx4 v[176:179], v1, s[4:7], s24 offen offset:0 sc1
 buffer_load_dwordx4 v[180:183], v1, s[4:7], s24 offen offset:512 sc1
 s_add_u32 s24, s21, 14336
 buffer_load_dwordx4 v[184:187], v1, s[4:7], s24 offen offset:0 sc1
 buffer_load_dwordx4 v[188:191], v1, s[4:7], s24 offen offset:512 sc1
 s_add_u32 s24, s21, 16384
 buffer_load_dwordx4 v[192:195], v1, s[4:7], s24 offen offset:0 sc1
 buffer_load_dwordx4 v[196:199], v1, s[4:7], s24 offen offset:512 sc1
 s_add_u32 s24, s21, 18432
 buffer_load_dwordx4 v[200:203], v1, s[4:7], s24 offen offset:0 sc1
 buffer_load_dwordx4 v[204:207], v1, s[4:7], s24 offen offset:512 sc1
 s_add_u32 s24, s21, 20480
 buffer_load_dwordx4 v[208:211], v1, s[4:7], s24 offen offset:0 sc1
 buffer_load_dwordx4 v[212:215], v1, s[4:7], s24 offen offset:512 sc1
 s_add_u32 s24, s21, 22528
 buffer_load_dwordx4 v[216:219], v1, s[4:7], s24 offen offset:0 sc1
 buffer_load_dwordx4 v[220:223], v1, s[4:7], s24 offen offset:512 sc1
 s_add_u32 s24, s21, 24576
 buffer_load_dwordx4 v[224:227], v1, s[4:7], s24 offen offset:0 sc1
 buffer_load_dwordx4 v[228:231], v1, s[4:7], s24 offen offset:512 sc1
 s_add_u32 s24, s21, 26624
 buffer_load_dwordx4 v[232:235], v1, s[4:7], s24 offen offset:0 sc1
 buffer_load_dwordx4 v[236:239], v1, s[4:7], s24 offen offset:512 sc1
 s_add_u32 s24, s21, 28672
 buffer_load_dwordx4 v[240:243], v1, s[4:7], s24 offen offset:0 sc1
 buffer_load_dwordx4 v[244:247], v1, s[4:7], s24 offen offset:512 sc1
 s_add_u32 s24, s21, 30720
 buffer_load_dwordx4 v[248:251], v1, s[4:7], s24 offen offset:0 sc1
 buffer_load_dwordx4 v[252:255], v1, s[4:7], s24 offen offset:512 sc1
 s_waitcnt vmcnt(31)
 v_mfma_f32_16x16x32_bf16 v[20:23], v[8:11], v[128:131], 0
 s_waitcnt vmcnt(30)
 v_mfma_f32_16x16x32_bf16 v[24:27], v[8:11], v[132:135], 0
 s_waitcnt vmcnt(29)
 v_mfma_f32_16x16x32_bf16 v[20:23], v[8:11], v[136:139], v[20:23]
 s_waitcnt vmcnt(28)
 v_mfma_f32_16x16x32_bf16 v[24:27], v[8:11], v[140:143], v[24:27]
 s_waitcnt vmcnt(27)
 v_mfma_f32_16x16x32_bf16 v[20:23], v[8:11], v[144:147], v[20:23]
 s_waitcnt vmcnt(26)
 v_mfma_f32_16x16x32_bf16 v[24:27], v[8:11], v[148:151], v[24:27]
 s_waitcnt vmcnt(25)
 v_mfma_f32_16x16x32_bf16 v[20:23], v[8:11], v[152:155], v[20:23]
 s_waitcnt vmcnt(24)
 v_mfma_f32_16x16x32_bf16 v[24:27], v[8:11], v[156:159], v[24:27]
 s_waitcnt vmcnt(23)
 v_mfma_f32_16x16x32_bf16 v[20:23], v[8:11], v[160:163], v[20:23]
 s_waitcnt vmcnt(22)
 v_mfma_f32_16x16x32_bf16 v[24:27], v[8:11], v[164:167], v[24:27]
 s_waitcnt vmcnt(21)
 v_mfma_f32_16x16x32_bf16 v[20:23], v[8:11], v[168:171], v[20:23]
 s_waitcnt vmcnt(20)
 v_mfma_f32_16x16x32_bf16 v[24:27], v[8:11], v[172:175], v[24:27]
 s_waitcnt vmcnt(19)
 v_mfma_f32_16x16x32_bf16 v[20:23], v[8:11], v[176:179], v[20:23]
 s_waitcnt vmcnt(18)
 v_mfma_f32_16x16x32_bf16 v[24:27], v[8:11], v[180:183], v[24:27]
 s_waitcnt vmcnt(17)
 v_mfma_f32_16x16x32_bf16 v[20:23], v[8:11], v[184:187], v[20:23]
 s_waitcnt vmcnt(16)
 v_mfma_f32_16x16x32_bf16 v[24:27], v[8:11], v[188:191], v[24:27]
 s_waitcnt vmcnt(15)
 v_mfma_f32_16x16x32_bf16 v[20:23], v[8:11], v[192:195], v[20:23]
 s_waitcnt vmcnt(14)
 v_mfma_f32_16x16x32_bf16 v[24:27], v[8:11], v[196:199], v[24:27]
 s_waitcnt vmcnt(13)
 v_mfma_f32_16x16x32_bf16 v[20:23], v[8:11], v[200:203], v[20:23]
 s_waitcnt vmcnt(12)
 v_mfma_f32_16x16x32_bf16 v[24:27], v[8:11], v[204:207], v[24:27]
 s_waitcnt vmcnt(11)
 v_mfma_f32_16x16x32_bf16 v[20:23], v[8:11], v[208:211], v[20:23]
 s_waitcnt vmcnt(10)
 v_mfma_f32_16x16x32_bf16 v[24:27], v[8:11], v[212:215], v[24:27]
 s_waitcnt vmcnt(9)
 v_mfma_f32_16x16x32_bf16 v[20:23], v[8:11], v[216:219], v[20:23]
 s_waitcnt vmcnt(8)
 v_mfma_f32_16x16x32_bf16 v[24:27], v[8:11], v[220:223], v[24:27]
 s_waitcnt vmcnt(7)
 v_mfma_f32_16x16x32_bf16 v[20:23], v[8:11], v[224:227], v[20:23]
 s_waitcnt vmcnt(6)
 v_mfma_f32_16x16x32_bf16 v[24:27], v[8:11], v[228:231], v[24:27]
 s_waitcnt vmcnt(5)
 v_mfma_f32_16x16x32_bf16 v[20:23], v[8:11], v[232:235], v[20:23]
 s_waitcnt vmcnt(4)
 v_mfma_f32_16x16x32_bf16 v[24:27], v[8:11], v[236:239], v[24:27]
 s_waitcnt vmcnt(3)
 v_mfma_f32_16x16x32_bf16 v[20:23], v[8:11], v[240:243], v[20:23]
 s_waitcnt vmcnt(2)
 v_mfma_f32_16x16x32_bf16 v[24:27], v[8:11], v[244:247], v[24:27]
 s_waitcnt vmcnt(1)
 v_mfma_f32_16x16x32_bf16 v[20:23], v[8:11], v[248:251], v[20:23]
 s_waitcnt vmcnt(0)
 v_mfma_f32_16x16x32_bf16 v[24:27], v[8:11], v[252:255], v[24:27]
 s_nop 7
 v_fmac_f32 v12, v20, v48
 v_fmac_f32 v13, v21, v49
 v_fmac_f32 v14, v22, v50
 v_fmac_f32 v15, v23, v51
 v_fmac_f32 v16, v24, v52
 v_fmac_f32 v17, v25, v53
 v_fmac_f32 v18, v26, v54
 v_fmac_f32 v19, v27, v55
 s_lshl_b32 s24, s18, 11
 v_add_u32 v24, s24, v3
 ds_write_b128 v24, v[12:15] offset:0
 ds_write_b128 v24, v[16:19] offset:1024
 v_add_f32 v28, v12, v13
 v_add_f32 v28, v28, v14
 v_add_f32 v28, v28, v15
 v_add_f32 v28, v28, v16
 v_add_f32 v28, v28, v17
 v_add_f32 v28, v28, v18
 v_add_f32 v28, v28, v19
 s_nop 1
 v_add_f32_dpp v28, v28, v28 quad_perm:[1,0,3,2] row_mask:0xf bank_mask:0xf
 s_nop 1
 v_add_f32_dpp v28, v28, v28 quad_perm:[2,3,0,1] row_mask:0xf bank_mask:0xf
 s_nop 1
 v_add_f32_dpp v28, v28, v28 row_half_mirror row_mask:0xf bank_mask:0xf
 s_nop 1
 v_add_f32_dpp v28, v28, v28 row_mirror row_mask:0xf bank_mask:0xf
 v_mov_b32 v29, v28
 s_nop 1
 v_permlane16_swap_b32 v29, v28
 v_add_f32 v28, v28, v29
 v_mov_b32 v29, v28
 s_nop 1
 v_permlane32_swap_b32 v29, v28
 v_add_f32 v28, v28, v29
 v_mul_f32 v31, 0x3b000000, v28
 v_sub_f32 v20, v12, v31
 v_sub_f32 v21, v13, v31
 v_sub_f32 v22, v14, v31
 v_sub_f32 v23, v15, v31
 v_sub_f32 v24, v16, v31
 v_sub_f32 v25, v17, v31
 v_sub_f32 v26, v18, v31
 v_sub_f32 v27, v19, v31
 v_mul_f32 v28, v20, v20
 v_fmac_f32 v28, v21, v21
 v_fmac_f32 v28, v22, v22
 v_fmac_f32 v28, v23, v23
 v_fmac_f32 v28, v24, v24
 v_fmac_f32 v28, v25, v25
 v_fmac_f32 v28, v26, v26
 v_fmac_f32 v28, v27, v27
 s_nop 1
 v_add_f32_dpp v28, v28, v28 quad_perm:[1,0,3,2] row_mask:0xf bank_mask:0xf
 s_nop 1
 v_add_f32_dpp v28, v28, v28 quad_perm:[2,3,0,1] row_mask:0xf bank_mask:0xf
 s_nop 1
 v_add_f32_dpp v28, v28, v28 row_half_mirror row_mask:0xf bank_mask:0xf
 s_nop 1
 v_add_f32_dpp v28, v28, v28 row_mirror row_mask:0xf bank_mask:0xf
 v_mov_b32 v29, v28
 s_nop 1
 v_permlane16_swap_b32 v29, v28
 v_add_f32 v28, v28, v29
 v_mov_b32 v29, v28
 s_nop 1
 v_permlane32_swap_b32 v29, v28
 v_add_f32 v28, v28, v29
 v_mov_b32 v29, 0x3727c5ac
 v_fmac_f32 v29, 0x3b000000, v28
 v_rsq_f32 v29, v29
 s_nop 0
 v_mul_f32 v20, v20, v29
 v_mul_f32 v21, v21, v29
 v_mul_f32 v22, v22, v29
 v_mul_f32 v23, v23, v29
 v_mul_f32 v24, v24, v29
 v_mul_f32 v25, v25, v29
 v_mul_f32 v26, v26, v29
 v_mul_f32 v27, v27, v29
 v_fma_f32 v20, v20, v64, v56
 v_fma_f32 v21, v21, v65, v57
 v_fma_f32 v22, v22, v66, v58
 v_fma_f32 v23, v23, v67, v59
 v_fma_f32 v24, v24, v68, v60
 v_fma_f32 v25, v25, v69, v61
 v_fma_f32 v26, v26, v70, v62
 v_fma_f32 v27, v27, v71, v63
 v_cvt_pk_bf16_f32 v80, v20, v21
 v_cvt_pk_bf16_f32 v81, v22, v23
 v_cvt_pk_bf16_f32 v82, v24, v25
 v_cvt_pk_bf16_f32 v83, v26, v27
 s_add_u32 s24, s34, 0x400000
 buffer_store_dwordx2 v[80:81], v2, s[4:7], s24 offen offset:0 sc1
 buffer_store_dwordx2 v[82:83], v2, s[4:7], s24 offen offset:512 sc1
 s_add_u32 s24, s35, 0x118000
 s_waitcnt vmcnt(0) lgkmcnt(0)
 s_mov_b64 exec, 1
 v_mov_b32 v29, 2
 buffer_store_dword v29, off, s[4:7], s24 sc1
 s_mov_b64 exec, -1
 s_add_u32 s18, s18, 4
 s_cmp_lt_u32 s18, 64
 s_cbranch_scc1 L_d1l_5
 s_branch L_dend_7
L_d2l_6:
 s_lshl_b32 s24, s18, 5
 s_add_u32 s24, s24, s37
 s_lshl_b32 s34, s24, 10
 s_lshl_b32 s35, s24, 2
 s_lshl_b32 s21, s24, 14
 s_lshl_b32 s25, s18, 7
 s_add_u32 s25, s25, 0x11a000
 s_add_u32 s21, s21, 0x8000000
 s_mov_b32 s23, 0
L_wline_11:
 buffer_load_dword v24, v5, s[4:7], s25 offen sc1
 s_add_u32 s23, s23, 1
 s_cmp_gt_u32 s23, 262144
 s_cbranch_scc1 L_bail
 s_waitcnt vmcnt(0)
 v_cmp_gt_u32 vcc, 1, v24
 s_cbranch_vccz L_wline_11_ok
 s_sleep 2
 s_branch L_wline_11
L_wline_11_ok:
 s_lshl_b32 s24, s18, 11
 v_add_u32 v24, s24, v3
 ds_read_b128 v[12:15], v24 offset:0
 ds_read_b128 v[16:19], v24 offset:1024
 s_mov_b32 s27, 0
L_rt_12:
 s_add_u32 s24, s21, 0
 buffer_load_dwordx4 v[128:131], v1, s[4:7], s24 offen offset:0 sc1
 buffer_load_dwordx4 v[132:135], v1, s[4:7], s24 offen offset:512 sc1
 s_add_u32 s24, s21, 2048
 buffer_load_dwordx4 v[136:139], v1, s[4:7], s24 offen offset:0 sc1
 buffer_load_dwordx4 v[140:143], v1, s[4:7], s24 offen offset:512 sc1
 s_add_u32 s24, s21, 4096
 buffer_load_dwordx4 v[144:147], v1, s[4:7], s24 offen offset:0 sc1
 buffer_load_dwordx4 v[148:151], v1, s[4:7], s24 offen offset:512 sc1
 s_add_u32 s24, s21, 6144
 buffer_load_dwordx4 v[152:155], v1, s[4:7], s24 offen offset:0 sc1
 buffer_load_dwordx4 v[156:159], v1, s[4:7], s24 offen offset:512 sc1
 s_add_u32 s24, s21, 8192
 buffer_load_dwordx4 v[160:163], v1, s[4:7], s24 offen offset:0 sc1
 buffer_load_dwordx4 v[164:167], v1, s[4:7], s24 offen offset:512 sc1
 s_add_u32 s24, s21, 10240
 buffer_load_dwordx4 v[168:171], v1, s[4:7], s24 offen offset:0 sc1
 buffer_load_dwordx4 v[172:175], v1, s[4:7], s24 offen offset:512 sc1
 s_add_u32 s24, s21, 12288
 buffer_load_dwordx4 v[176:179], v1, s[4:7], s24 offen offset:0 sc1
 buffer_load_dwordx4 v[180:183], v1, s[4:7], s24 offen offset:512 sc1
 s_waitcnt vmcnt(13)
 v_mfma_f32_16x16x32_bf16 v[20:23], v[8:11], v[128:131], 0
 s_waitcnt vmcnt(12)
 v_mfma_f32_16x16x32_bf16 v[24:27], v[8:11], v[132:135], 0
 s_waitcnt vmcnt(11)
 v_mfma_f32_16x16x32_bf16 v[20:23], v[8:11], v[136:139], v[20:23]
 s_waitcnt vmcnt(10)
 v_mfma_f32_16x16x32_bf16 v[24:27], v[8:11], v[140:143], v[24:27]
 s_waitcnt vmcnt(9)
 v_mfma_f32_16x16x32_bf16 v[20:23], v[8:11], v[144:147], v[20:23]
 s_waitcnt vmcnt(8)
 v_mfma_f32_16x16x32_bf16 v[24:27], v[8:11], v[148:151], v[24:27]
 s_waitcnt vmcnt(7)
 v_mfma_f32_16x16x32_bf16 v[20:23], v[8:11], v[152:155], v[20:23]
 s_waitcnt vmcnt(6)
 v_mfma_f32_16x16x32_bf16 v[24:27], v[8:11], v[156:159], v[24:27]
 s_waitcnt vmcnt(5)
 v_mfma_f32_16x16x32_bf16 v[20:23], v[8:11], v[160:163], v[20:23]
 s_waitcnt vmcnt(4)
 v_mfma_f32_16x16x32_bf16 v[24:27], v[8:11], v[164:167], v[24:27]
 s_waitcnt vmcnt(3)
 v_mfma_f32_16x16x32_bf16 v[20:23], v[8:11], v[168:171], v[20:23]
 s_waitcnt vmcnt(2)
 v_mfma_f32_16x16x32_bf16 v[24:27], v[8:11], v[172:175], v[24:27]
 s_waitcnt vmcnt(1)
 v_mfma_f32_16x16x32_bf16 v[20:23], v[8:11], v[176:179], v[20:23]
 s_waitcnt vmcnt(0)
 v_mfma_f32_16x16x32_bf16 v[24:27], v[8:11], v[180:183], v[24:27]
 s_nop 7
 s_waitcnt lgkmcnt(0)
 v_fmac_f32 v12, v20, v72
 v_fmac_f32 v13, v21, v73
 v_fmac_f32 v14, v22, v74
 v_fmac_f32 v15, v23, v75
 v_fmac_f32 v16, v24, v76
 v_fmac_f32 v17, v25, v77
 v_fmac_f32 v18, v26, v78
 v_fmac_f32 v19, v27, v79
 v_cvt_pk_bf16_f32 v80, v12, v13
 v_cvt_pk_bf16_f32 v81, v14, v15
 v_cvt_pk_bf16_f32 v82, v16, v17
 v_cvt_pk_bf16_f32 v83, v18, v19
 buffer_store_dwordx2 v[80:81], v2, s[80:83], s34 offen offset:0
 buffer_store_dwordx2 v[82:83], v2, s[80:83], s34 offen offset:512
 s_add_u32 s18, s18, 4
 s_cmp_lt_u32 s18, 64
 s_cbranch_scc1 L_d2l_6
L_dend_7:
 s_waitcnt vmcnt(0)
 s_endpgm
L_F:
 v_lshrrev_b32 v20, 6, v31
 v_and_b32 v21, 63, v31
 v_readfirstlane_b32 s17, v20
 v_and_b32 v22, 15, v21
 v_lshrrev_b32 v23, 4, v21
 s_mov_b32 s28, -1
 s_mov_b32 s29, 0
 s_mov_b32 s30, 0
 s_mov_b32 s31, -1
 s_mov_b32 s39, 0x7f817f81
 s_mov_b32 s33, 0x3e0293ee
 s_mul_i32 s25, s16, 4682
 s_lshr_b32 s25, s25, 16
 s_mul_i32 s24, s25, 14
 s_sub_u32 s19, s16, s24
 s_and_b32 s21, s25, 1
 s_lshr_b32 s18, s25, 1
 v_lshlrev_b32 v1, 4, v21
 s_lshl_b32 s24, s21, 6
 v_lshlrev_b32 v4, 2, v22
 v_add_u32 v4, s24, v4
 v_lshlrev_b32 v24, 14, v22
 v_lshl_add_u32 v24, v23, 4, v24
 s_lshl_b32 s24, s19, 10
 s_lshl_b32 s25, s17, 8
 s_add_u32 s24, s24, s25
 v_add_u32 v3, s24, v24
 s_lshl_b32 s24, s17, 10
 s_add_u32 s24, s24, 65536
 v_add_u32 v5, s24, v1
 v_add_u32 v7, 65536, v1
 s_load_dwordx2 s[48:49], s[0:1], 64
 s_load_dwordx2 s[50:51], s[0:1], 72
 v_lshrrev_b32 v24, 2, v21
 v_mul_u32_u24 v24, 3584, v24
 v_and_b32 v25, 3, v21
 v_lshl_add_u32 v26, v25, 4, v24
 s_lshl_b32 s24, s19, 8
 s_lshl_b32 s25, s17, 6
 s_add_u32 s24, s24, s25
 v_add_u32 v26, s24, v26
 v_lshlrev_b32 v27, 10, v23
 v_lshl_add_u32 v27, v22, 4, v27
 s_lshl_b32 s24, s19, 17
 s_lshl_b32 s25, s17, 8
 s_add_u32 s24, s24, s25
 v_add_u32 v27, s24, v27
 s_lshl_b32 s26, s17, 15
 v_bfe_u32 v24, v21, 2, 2
 v_and_b32 v25, 3, v21
 v_lshl_add_u32 v28, v23, 3, v24
 v_lshlrev_b32 v28, 6, v28
 v_lshl_add_u32 v28, v25, 3, v28
 v_add_u32 v28, s26, v28
 v_lshl_add_u32 v30, v23, 2, v24
 v_lshlrev_b32 v30, 8, v30
 v_lshl_add_u32 v30, v25, 4, v30
 v_add_u32 v30, s26, v30
 s_waitcnt lgkmcnt(0)
 s_mov_b32 s76, s48
 s_and_b32 s77, s49, 0xffff
 s_mov_b32 s78, 0x1c0000
 s_mov_b32 s79, 0x20000
 s_mov_b32 s80, s50
 s_and_b32 s81, s51, 0xffff
 s_mov_b32 s82, 0x1c0000
 s_mov_b32 s83, 0x20000
 v_and_b32 v24, 7, v21
 v_xor_b32 v24, v24, v23
 v_lshrrev_b32 v25, 3, v21
 v_lshlrev_b32 v25, 10, v25
 v_lshl_add_u32 v2, v24, 4, v25
 v_xor_b32 v10, 64, v2
 v_add_u32 v10, 8192, v10
 v_lshrrev_b32 v24, 1, v22
 v_xor_b32 v24, v24, v23
 v_lshlrev_b32 v25, 7, v22
 v_lshl_add_u32 v6, v24, 4, v25
 s_cmp_eq_u32 s17, 0
 s_cbranch_scc0 L_winit_14_ok
 s_mov_b32 s23, 0
L_winit_14:
 buffer_load_dword v24, off, s[12:15], 0 offset:192 sc1
 s_add_u32 s23, s23, 1
 s_cmp_gt_u32 s23, 262144
 s_cbranch_scc1 L_bail
 s_waitcnt vmcnt(0)
 v_cmp_le_u32 vcc, 48, v24
 s_cbranch_vccnz L_winit_14_ok
 s_sleep 64
 s_branch L_winit_14
L_winit_14_ok:
 s_barrier
 s_cmp_eq_u32 s17, 0
 s_cbranch_scc0 L_fw_15
 s_mov_b32 s25, 0x115f80
 s_mov_b32 s23, 0
L_wline_16:
 buffer_load_dword v24, v4, s[4:7], s25 offen sc1
 s_add_u32 s23, s23, 1
 s_cmp_gt_u32 s23, 262144
 s_cbranch_scc1 L_bail
 s_waitcnt vmcnt(0)
 v_cmp_gt_u32 vcc, 1, v24
 s_cbranch_vccz L_wline_16_ok
 s_sleep 64
 s_branch L_wline_16
L_wline_16_ok:
L_fw_15:
 s_barrier
 s_add_u32 m0, s26, 0
 s_mov_b32 s24, 0
 buffer_load_dwordx4 v26, s[76:79], s24 offen lds
 s_add_u32 m0, s26, 1024
 s_mov_b32 s24, 57344
 buffer_load_dwordx4 v26, s[76:79], s24 offen lds
 s_add_u32 m0, s26, 2048
 s_mov_b32 s24, 114688
 buffer_load_dwordx4 v26, s[76:79], s24 offen lds
 s_add_u32 m0, s26, 3072
 s_mov_b32 s24, 172032
 buffer_load_dwordx4 v26, s[76:79], s24 offen lds
 s_add_u32 m0, s26, 4096
 s_mov_b32 s24, 229376
 buffer_load_dwordx4 v26, s[76:79], s24 offen lds
 s_add_u32 m0, s26, 5120
 s_mov_b32 s24, 286720
 buffer_load_dwordx4 v26, s[76:79], s24 offen lds
 s_add_u32 m0, s26, 6144
 s_mov_b32 s24, 344064
 buffer_load_dwordx4 v26, s[76:79], s24 offen lds
 s_add_u32 m0, s26, 7168
 s_mov_b32 s24, 401408
 buffer_load_dwordx4 v26, s[76:79], s24 offen lds
 s_add_u32 m0, s26, 8192
 s_mov_b32 s24, 458752
 buffer_load_dwordx4 v26, s[76:79], s24 offen lds
 s_add_u32 m0, s26, 9216
 s_mov_b32 s24, 516096
 buffer_load_dwordx4 v26, s[76:79], s24 offen lds
 s_add_u32 m0, s26, 10240
 s_mov_b32 s24, 573440
 buffer_load_dwordx4 v26, s[76:79], s24 offen lds
 s_add_u32 m0, s26, 11264
 s_mov_b32 s24, 630784
 buffer_load_dwordx4 v26, s[76:79], s24 offen lds
 s_add_u32 m0, s26, 12288
 s_mov_b32 s24, 688128
 buffer_load_dwordx4 v26, s[76:79], s24 offen lds
 s_add_u32 m0, s26, 13312
 s_mov_b32 s24, 745472
 buffer_load_dwordx4 v26, s[76:79], s24 offen lds
 s_add_u32 m0, s26, 14336
 s_mov_b32 s24, 802816
 buffer_load_dwordx4 v26, s[76:79], s24 offen lds
 s_add_u32 m0, s26, 15360
 s_mov_b32 s24, 860160
 buffer_load_dwordx4 v26, s[76:79], s24 offen lds
 s_add_u32 m0, s26, 16384
 s_mov_b32 s24, 917504
 buffer_load_dwordx4 v26, s[76:79], s24 offen lds
 s_add_u32 m0, s26, 17408
 s_mov_b32 s24, 974848
 buffer_load_dwordx4 v26, s[76:79], s24 offen lds
 s_add_u32 m0, s26, 18432
 s_mov_b32 s24, 1032192
 buffer_load_dwordx4 v26, s[76:79], s24 offen lds
 s_add_u32 m0, s26, 19456
 s_mov_b32 s24, 1089536
 buffer_load_dwordx4 v26, s[76:79], s24 offen lds
 s_add_u32 m0, s26, 20480
 s_mov_b32 s24, 1146880
 buffer_load_dwordx4 v26, s[76:79], s24 offen lds
 s_add_u32 m0, s26, 21504
 s_mov_b32 s24, 1204224
 buffer_load_dwordx4 v26, s[76:79], s24 offen lds
 s_add_u32 m0, s26, 22528
 s_mov_b32 s24, 1261568
 buffer_load_dwordx4 v26, s[76:79], s24 offen lds
 s_add_u32 m0, s26, 23552
 s_mov_b32 s24, 1318912
 buffer_load_dwordx4 v26, s[76:79], s24 offen lds
 s_add_u32 m0, s26, 24576
 s_mov_b32 s24, 1376256
 buffer_load_dwordx4 v26, s[76:79], s24 offen lds
 s_add_u32 m0, s26, 25600
 s_mov_b32 s24, 1433600
 buffer_load_dwordx4 v26, s[76:79], s24 offen lds
 s_add_u32 m0, s26, 26624
 s_mov_b32 s24, 1490944
 buffer_load_dwordx4 v26, s[76:79], s24 offen lds
 s_add_u32 m0, s26, 27648
 s_mov_b32 s24, 1548288
 buffer_load_dwordx4 v26, s[76:79], s24 offen lds
 s_add_u32 m0, s26, 28672
 s_mov_b32 s24, 1605632
 buffer_load_dwordx4 v26, s[76:79], s24 offen lds
 s_add_u32 m0, s26, 29696
 s_mov_b32 s24, 1662976
 buffer_load_dwordx4 v26, s[76:79], s24 offen lds
 s_add_u32 m0, s26, 30720
 s_mov_b32 s24, 1720320
 buffer_load_dwordx4 v26, s[76:79], s24 offen lds
 s_add_u32 m0, s26, 31744
 s_mov_b32 s24, 1777664
 buffer_load_dwordx4 v26, s[76:79], s24 offen lds
 s_waitcnt vmcnt(0)
 ds_read_b64_tr_b16 a[0:1], v28 offset:0
 ds_read_b64_tr_b16 a[2:3], v28 offset:256
 ds_read_b64_tr_b16 a[64:65], v28 offset:32
 ds_read_b64_tr_b16 a[66:67], v28 offset:288
 ds_read_b64_tr_b16 a[4:5], v28 offset:2048
 ds_read_b64_tr_b16 a[6:7], v28 offset:2304
 ds_read_b64_tr_b16 a[68:69], v28 offset:2080
 ds_read_b64_tr_b16 a[70:71], v28 offset:2336
 s_waitcnt lgkmcnt(0)
 ds_read_b64_tr_b16 a[8:9], v28 offset:4096
 ds_read_b64_tr_b16 a[10:11], v28 offset:4352
 ds_read_b64_tr_b16 a[72:73], v28 offset:4128
 ds_read_b64_tr_b16 a[74:75], v28 offset:4384
 ds_read_b64_tr_b16 a[12:13], v28 offset:6144
 ds_read_b64_tr_b16 a[14:15], v28 offset:6400
 ds_read_b64_tr_b16 a[76:77], v28 offset:6176
 ds_read_b64_tr_b16 a[78:79], v28 offset:6432
 s_waitcnt lgkmcnt(0)
 ds_read_b64_tr_b16 a[16:17], v28 offset:8192
 ds_read_b64_tr_b16 a[18:19], v28 offset:8448
 ds_read_b64_tr_b16 a[80:81], v28 offset:8224
 ds_read_b64_tr_b16 a[82:83], v28 offset:8480
 ds_read_b64_tr_b16 a[20:21], v28 offset:10240
 ds_read_b64_tr_b16 a[22:23], v28 offset:10496
 ds_read_b64_tr_b16 a[84:85], v28 offset:10272
 ds_read_b64_tr_b16 a[86:87], v28 offset:10528
 s_waitcnt lgkmcnt(0)
 ds_read_b64_tr_b16 a[24:25], v28 offset:12288
 ds_read_b64_tr_b16 a[26:27], v28 offset:12544
 ds_read_b64_tr_b16 a[88:89], v28 offset:12320
 ds_read_b64_tr_b16 a[90:91], v28 offset:12576
 ds_read_b64_tr_b16 a[28:29], v28 offset:14336
 ds_read_b64_tr_b16 a[30:31], v28 offset:14592
 ds_read_b64_tr_b16 a[92:93], v28 offset:14368
 ds_read_b64_tr_b16 a[94:95], v28 offset:14624
 s_waitcnt lgkmcnt(0)
 ds_read_b64_tr_b16 a[32:33], v28 offset:16384
 ds_read_b64_tr_b16 a[34:35], v28 offset:16640
 ds_read_b64_tr_b16 a[96:97], v28 offset:16416
 ds_read_b64_tr_b16 a[98:99], v28 offset:16672
 ds_read_b64_tr_b16 a[36:37], v28 offset:18432
 ds_read_b64_tr_b16 a[38:39], v28 offset:18688
 ds_read_b64_tr_b16 a[100:101], v28 offset:18464
 ds_read_b64_tr_b16 a[102:103], v28 offset:18720
 s_waitcnt lgkmcnt(0)
 ds_read_b64_tr_b16 a[40:41], v28 offset:20480
 ds_read_b64_tr_b16 a[42:43], v28 offset:20736
 ds_read_b64_tr_b16 a[104:105], v28 offset:20512
 ds_read_b64_tr_b16 a[106:107], v28 offset:20768
 ds_read_b64_tr_b16 a[44:45], v28 offset:22528
 ds_read_b64_tr_b16 a[46:47], v28 offset:22784
 ds_read_b64_tr_b16 a[108:109], v28 offset:22560
 ds_read_b64_tr_b16 a[110:111], v28 offset:22816
 s_waitcnt lgkmcnt(0)
 ds_read_b64_tr_b16 a[48:49], v28 offset:24576
 ds_read_b64_tr_b16 a[50:51], v28 offset:24832
 ds_read_b64_tr_b16 a[112:113], v28 offset:24608
 ds_read_b64_tr_b16 a[114:115], v28 offset:24864
 ds_read_b64_tr_b16 a[52:53], v28 offset:26624
 ds_read_b64_tr_b16 a[54:55], v28 offset:26880
 ds_read_b64_tr_b16 a[116:117], v28 offset:26656
 ds_read_b64_tr_b16 a[118:119], v28 offset:26912
 s_waitcnt lgkmcnt(0)
 ds_read_b64_tr_b16 a[56:57], v28 offset:28672
 ds_read_b64_tr_b16 a[58:59], v28 offset:28928
 ds_read_b64_tr_b16 a[120:121], v28 offset:28704
 ds_read_b64_tr_b16 a[122:123], v28 offset:28960
 ds_read_b64_tr_b16 a[60:61], v28 offset:30720
 ds_read_b64_tr_b16 a[62:63], v28 offset:30976
 ds_read_b64_tr_b16 a[124:125], v28 offset:30752
 ds_read_b64_tr_b16 a[126:127], v28 offset:31008
 s_waitcnt lgkmcnt(0)
 s_add_u32 m0, s26, 0
 s_mov_b32 s24, 0
 buffer_load_dwordx4 v27, s[80:83], s24 offen lds
 s_add_u32 m0, s26, 1024
 s_mov_b32 s24, 4096
 buffer_load_dwordx4 v27, s[80:83], s24 offen lds
 s_add_u32 m0, s26, 2048
 s_mov_b32 s24, 8192
 buffer_load_dwordx4 v27, s[80:83], s24 offen lds
 s_add_u32 m0, s26, 3072
 s_mov_b32 s24, 12288
 buffer_load_dwordx4 v27, s[80:83], s24 offen lds
 s_add_u32 m0, s26, 4096
 s_mov_b32 s24, 16384
 buffer_load_dwordx4 v27, s[80:83], s24 offen lds
 s_add_u32 m0, s26, 5120
 s_mov_b32 s24, 20480
 buffer_load_dwordx4 v27, s[80:83], s24 offen lds
 s_add_u32 m0, s26, 6144
 s_mov_b32 s24, 24576
 buffer_load_dwordx4 v27, s[80:83], s24 offen lds
 s_add_u32 m0, s26, 7168
 s_mov_b32 s24, 28672
 buffer_load_dwordx4 v27, s[80:83], s24 offen lds
 s_add_u32 m0, s26, 8192
 s_mov_b32 s24, 32768
 buffer_load_dwordx4 v27, s[80:83], s24 offen lds
 s_add_u32 m0, s26, 9216
 s_mov_b32 s24, 36864
 buffer_load_dwordx4 v27, s[80:83], s24 offen lds
 s_add_u32 m0, s26, 10240
 s_mov_b32 s24, 40960
 buffer_load_dwordx4 v27, s[80:83], s24 offen lds
 s_add_u32 m0, s26, 11264
 s_mov_b32 s24, 45056
 buffer_load_dwordx4 v27, s[80:83], s24 offen lds
 s_add_u32 m0, s26, 12288
 s_mov_b32 s24, 49152
 buffer_load_dwordx4 v27, s[80:83], s24 offen lds
 s_add_u32 m0, s26, 13312
 s_mov_b32 s24, 53248
 buffer_load_dwordx4 v27, s[80:83], s24 offen lds
 s_add_u32 m0, s26, 14336
 s_mov_b32 s24, 57344
 buffer_load_dwordx4 v27, s[80:83], s24 offen lds
 s_add_u32 m0, s26, 15360
 s_mov_b32 s24, 61440
 buffer_load_dwordx4 v27, s[80:83], s24 offen lds
 s_add_u32 m0, s26, 16384
 s_mov_b32 s24, 65536
 buffer_load_dwordx4 v27, s[80:83], s24 offen lds
 s_add_u32 m0, s26, 17408
 s_mov_b32 s24, 69632
 buffer_load_dwordx4 v27, s[80:83], s24 offen lds
 s_add_u32 m0, s26, 18432
 s_mov_b32 s24, 73728
 buffer_load_dwordx4 v27, s[80:83], s24 offen lds
 s_add_u32 m0, s26, 19456
 s_mov_b32 s24, 77824
 buffer_load_dwordx4 v27, s[80:83], s24 offen lds
 s_add_u32 m0, s26, 20480
 s_mov_b32 s24, 81920
 buffer_load_dwordx4 v27, s[80:83], s24 offen lds
 s_add_u32 m0, s26, 21504
 s_mov_b32 s24, 86016
 buffer_load_dwordx4 v27, s[80:83], s24 offen lds
 s_add_u32 m0, s26, 22528
 s_mov_b32 s24, 90112
 buffer_load_dwordx4 v27, s[80:83], s24 offen lds
 s_add_u32 m0, s26, 23552
 s_mov_b32 s24, 94208
 buffer_load_dwordx4 v27, s[80:83], s24 offen lds
 s_add_u32 m0, s26, 24576
 s_mov_b32 s24, 98304
 buffer_load_dwordx4 v27, s[80:83], s24 offen lds
 s_add_u32 m0, s26, 25600
 s_mov_b32 s24, 102400
 buffer_load_dwordx4 v27, s[80:83], s24 offen lds
 s_add_u32 m0, s26, 26624
 s_mov_b32 s24, 106496
 buffer_load_dwordx4 v27, s[80:83], s24 offen lds
 s_add_u32 m0, s26, 27648
 s_mov_b32 s24, 110592
 buffer_load_dwordx4 v27, s[80:83], s24 offen lds
 s_add_u32 m0, s26, 28672
 s_mov_b32 s24, 114688
 buffer_load_dwordx4 v27, s[80:83], s24 offen lds
 s_add_u32 m0, s26, 29696
 s_mov_b32 s24, 118784
 buffer_load_dwordx4 v27, s[80:83], s24 offen lds
 s_add_u32 m0, s26, 30720
 s_mov_b32 s24, 122880
 buffer_load_dwordx4 v27, s[80:83], s24 offen lds
 s_add_u32 m0, s26, 31744
 s_mov_b32 s24, 126976
 buffer_load_dwordx4 v27, s[80:83], s24 offen lds
 s_waitcnt vmcnt(0)
 ds_read_b64_tr_b16 v[128:129], v30 offset:0
 ds_read_b64_tr_b16 v[130:131], v30 offset:4096
 ds_read_b64_tr_b16 v[132:133], v30 offset:8
 ds_read_b64_tr_b16 v[134:135], v30 offset:4104
 ds_read_b64_tr_b16 v[160:161], v30 offset:64
 ds_read_b64_tr_b16 v[162:163], v30 offset:4160
 ds_read_b64_tr_b16 v[164:165], v30 offset:72
 ds_read_b64_tr_b16 v[166:167], v30 offset:4168
 s_waitcnt lgkmcnt(0)
 ds_read_b64_tr_b16 v[192:193], v30 offset:128
 ds_read_b64_tr_b16 v[194:195], v30 offset:4224
 ds_read_b64_tr_b16 v[196:197], v30 offset:136
 ds_read_b64_tr_b16 v[198:199], v30 offset:4232
 ds_read_b64_tr_b16 v[224:225], v30 offset:192
 ds_read_b64_tr_b16 v[226:227], v30 offset:4288
 ds_read_b64_tr_b16 v[228:229], v30 offset:200
 ds_read_b64_tr_b16 v[230:231], v30 offset:4296
 s_waitcnt lgkmcnt(0)
 ds_read_b64_tr_b16 v[136:137], v30 offset:8192
 ds_read_b64_tr_b16 v[138:139], v30 offset:12288
 ds_read_b64_tr_b16 v[140:141], v30 offset:8200
 ds_read_b64_tr_b16 v[142:143], v30 offset:12296
 ds_read_b64_tr_b16 v[168:169], v30 offset:8256
 ds_read_b64_tr_b16 v[170:171], v30 offset:12352
 ds_read_b64_tr_b16 v[172:173], v30 offset:8264
 ds_read_b64_tr_b16 v[174:175], v30 offset:12360
 s_waitcnt lgkmcnt(0)
 ds_read_b64_tr_b16 v[200:201], v30 offset:8320
 ds_read_b64_tr_b16 v[202:203], v30 offset:12416
 ds_read_b64_tr_b16 v[204:205], v30 offset:8328
 ds_read_b64_tr_b16 v[206:207], v30 offset:12424
 ds_read_b64_tr_b16 v[232:233], v30 offset:8384
 ds_read_b64_tr_b16 v[234:235], v30 offset:12480
 ds_read_b64_tr_b16 v[236:237], v30 offset:8392
 ds_read_b64_tr_b16 v[238:239], v30 offset:12488
 s_waitcnt lgkmcnt(0)
 ds_read_b64_tr_b16 v[144:145], v30 offset:16384
 ds_read_b64_tr_b16 v[146:147], v30 offset:20480
 ds_read_b64_tr_b16 v[148:149], v30 offset:16392
 ds_read_b64_tr_b16 v[150:151], v30 offset:20488
 ds_read_b64_tr_b16 v[176:177], v30 offset:16448
 ds_read_b64_tr_b16 v[178:179], v30 offset:20544
 ds_read_b64_tr_b16 v[180:181], v30 offset:16456
 ds_read_b64_tr_b16 v[182:183], v30 offset:20552
 s_waitcnt lgkmcnt(0)
 ds_read_b64_tr_b16 v[208:209], v30 offset:16512
 ds_read_b64_tr_b16 v[210:211], v30 offset:20608
 ds_read_b64_tr_b16 v[212:213], v30 offset:16520
 ds_read_b64_tr_b16 v[214:215], v30 offset:20616
 ds_read_b64_tr_b16 v[240:241], v30 offset:16576
 ds_read_b64_tr_b16 v[242:243], v30 offset:20672
 ds_read_b64_tr_b16 v[244:245], v30 offset:16584
 ds_read_b64_tr_b16 v[246:247], v30 offset:20680
 s_waitcnt lgkmcnt(0)
 ds_read_b64_tr_b16 v[152:153], v30 offset:24576
 ds_read_b64_tr_b16 v[154:155], v30 offset:28672
 ds_read_b64_tr_b16 v[156:157], v30 offset:24584
 ds_read_b64_tr_b16 v[158:159], v30 offset:28680
 ds_read_b64_tr_b16 v[184:185], v30 offset:24640
 ds_read_b64_tr_b16 v[186:187], v30 offset:28736
 ds_read_b64_tr_b16 v[188:189], v30 offset:24648
 ds_read_b64_tr_b16 v[190:191], v30 offset:28744
 s_waitcnt lgkmcnt(0)
 ds_read_b64_tr_b16 v[216:217], v30 offset:24704
 ds_read_b64_tr_b16 v[218:219], v30 offset:28800
 ds_read_b64_tr_b16 v[220:221], v30 offset:24712
 ds_read_b64_tr_b16 v[222:223], v30 offset:28808
 ds_read_b64_tr_b16 v[248:249], v30 offset:24768
 ds_read_b64_tr_b16 v[250:251], v30 offset:28864
 ds_read_b64_tr_b16 v[252:253], v30 offset:24776
 ds_read_b64_tr_b16 v[254:255], v30 offset:28872
 s_waitcnt lgkmcnt(0)
 v_mov_b32 v8, 0
 s_mov_b32 s47, 0
 s_lshl_b32 s38, s17, 12
 v_xor_b32 v11, 64, v6
 s_barrier
 s_add_u32 s25, s18, 0
 s_lshl_b32 s37, s25, 1
 s_add_u32 s37, s37, s21
 s_lshl_b32 s37, s37, 14
 s_lshl_b32 s24, s17, 8
 s_add_u32 s37, s37, s24
 s_add_u32 s37, s37, 0x400000
 s_min_u32 s25, s25, 63
 s_lshl_b32 s43, s25, 7
 s_add_u32 s43, s43, 0x118000
 s_mov_b32 s23, 0
L_wline_17:
 buffer_load_dword v9, v4, s[4:7], s43 offen sc1
 s_add_u32 s23, s23, 1
 s_cmp_gt_u32 s23, 262144
 s_cbranch_scc1 L_bail
 s_waitcnt vmcnt(0)
 v_cmp_gt_u32 vcc, 1, v9
 s_cbranch_vccz L_wline_17_ok
 s_sleep 2
 s_branch L_wline_17
L_wline_17_ok:
 s_add_u32 m0, s38, 0
 s_add_u32 s24, s37, 0
 buffer_load_dwordx4 v2, s[4:7], s24 offen sc1 lds
 s_add_u32 m0, s38, 1024
 s_add_u32 s24, s37, 0
 buffer_load_dwordx4 v10, s[4:7], s24 offen sc1 lds
 s_add_u32 m0, s38, 2048
 s_add_u32 s24, s37, 128
 buffer_load_dwordx4 v2, s[4:7], s24 offen sc1 lds
 s_add_u32 m0, s38, 3072
 s_add_u32 s24, s37, 128
 buffer_load_dwordx4 v10, s[4:7], s24 offen sc1 lds
 buffer_load_dword v9, v4, s[4:7], s43 offen sc1
 s_cmp_eq_u32 s17, 0
 s_cselect_b32 s44, 1, 0
 s_mov_b32 s45, 0
L_floop_18:
 s_lshl_b32 s34, s18, 1
 s_add_u32 s34, s34, s21
 s_lshl_b32 s34, s34, 18
 s_add_u32 s34, s34, 0x8000000
 s_lshl_b32 s25, s18, 7
 s_lshl_b32 s35, s21, 4
 s_add_u32 s35, s35, s19
 s_lshl_b32 s35, s35, 2
 s_add_u32 s35, s35, s25
 s_add_u32 s35, s35, 0x11a000
 s_xor_b32 s38, s38, 16384
 s_add_u32 s25, s18, 1
 s_lshl_b32 s37, s25, 1
 s_add_u32 s37, s37, s21
 s_lshl_b32 s37, s37, 14
 s_lshl_b32 s24, s17, 8
 s_add_u32 s37, s37, s24
 s_add_u32 s37, s37, 0x400000
 s_min_u32 s25, s25, 63
 s_lshl_b32 s43, s25, 7
 s_add_u32 s43, s43, 0x118000
 s_cmp_eq_u32 s47, 0
 s_cbranch_scc1 L_flw_19
 s_waitcnt vmcnt(5)
 s_branch L_flb_20
L_flw_19:
 s_waitcnt vmcnt(1)
L_flb_20:
 v_cmp_eq_u32 vcc, 0, v8
 s_cmp_eq_u64 vcc, 0
 s_cselect_b32 s24, 4, 0
 v_mov_b32 v24, s24
 v_mov_b32 v25, 69696
 s_mov_b64 exec, s[44:45]
 ds_write_b32 v25, v24
 s_mov_b64 exec, -1
 s_waitcnt lgkmcnt(0)
 s_barrier
 ds_read_b32 v24, v25
 ds_read_b128 v[64:67], v6 offset:0
 ds_read_b128 v[68:71], v11 offset:0
 ds_read_b128 v[72:75], v6 offset:2048
 ds_read_b128 v[76:79], v11 offset:2048
 s_waitcnt lgkmcnt(4)
 v_readfirstlane_b32 s24, v24
 s_cmp_lt_u32 s18, 63
 s_cselect_b32 s46, s24, 2
 s_cmp_eq_u32 s46, 4
 s_cbranch_scc0 L_fne_21
 s_add_u32 m0, s38, 0
 s_add_u32 s24, s37, 0
 buffer_load_dwordx4 v2, s[4:7], s24 offen sc1 lds
 s_add_u32 m0, s38, 1024
 s_add_u32 s24, s37, 0
 buffer_load_dwordx4 v10, s[4:7], s24 offen sc1 lds
 s_add_u32 m0, s38, 2048
 s_add_u32 s24, s37, 128
 buffer_load_dwordx4 v2, s[4:7], s24 offen sc1 lds
 s_add_u32 m0, s38, 3072
 s_add_u32 s24, s37, 128
 buffer_load_dwordx4 v10, s[4:7], s24 offen sc1 lds
 s_mov_b32 s46, 5
 s_branch L_fne_21_d
L_fne_21:
 buffer_load_dword v9, v4, s[4:7], s43 offen sc1
L_fne_21_d:
 s_waitcnt lgkmcnt(3)
 v_mfma_f32_16x16x32_bf16 v[32:35], a[0:3], v[64:67], 0
 ds_read_b128 v[80:83], v6 offset:4096
 v_mfma_f32_16x16x32_bf16 v[36:39], a[64:67], v[64:67], 0
 s_waitcnt lgkmcnt(3)
 v_mfma_f32_16x16x32_bf16 v[32:35], a[4:7], v[68:71], v[32:35]
 ds_read_b128 v[84:87], v11 offset:4096
 v_mfma_f32_16x16x32_bf16 v[36:39], a[68:71], v[68:71], v[36:39]
 s_waitcnt lgkmcnt(3)
 v_mfma_f32_16x16x32_bf16 v[32:35], a[8:11], v[72:75], v[32:35]
 ds_read_b128 v[64:67], v6 offset:6144
 v_mfma_f32_16x16x32_bf16 v[36:39], a[72:75], v[72:75], v[36:39]
 s_waitcnt lgkmcnt(3)
 v_mfma_f32_16x16x32_bf16 v[32:35], a[12:15], v[76:79], v[32:35]
 ds_read_b128 v[68:71], v11 offset:6144
 v_mfma_f32_16x16x32_bf16 v[36:39], a[76:79], v[76:79], v[36:39]
 s_waitcnt lgkmcnt(3)
 v_mfma_f32_16x16x32_bf16 v[32:35], a[16:19], v[80:83], v[32:35]
 ds_read_b128 v[72:75], v6 offset:8192
 v_mfma_f32_16x16x32_bf16 v[36:39], a[80:83], v[80:83], v[36:39]
 s_waitcnt lgkmcnt(3)
 v_mfma_f32_16x16x32_bf16 v[32:35], a[20:23], v[84:87], v[32:35]
 ds_read_b128 v[76:79], v11 offset:8192
 v_mfma_f32_16x16x32_bf16 v[36:39], a[84:87], v[84:87], v[36:39]
 s_waitcnt lgkmcnt(3)
 v_mfma_f32_16x16x32_bf16 v[32:35], a[24:27], v[64:67], v[32:35]
 ds_read_b128 v[80:83], v6 offset:10240
 v_mfma_f32_16x16x32_bf16 v[36:39], a[88:91], v[64:67], v[36:39]
 s_waitcnt lgkmcnt(3)
 v_mfma_f32_16x16x32_bf16 v[32:35], a[28:31], v[68:71], v[32:35]
 ds_read_b128 v[84:87], v11 offset:10240
 v_mfma_f32_16x16x32_bf16 v[36:39], a[92:95], v[68:71], v[36:39]
 s_waitcnt lgkmcnt(3)
 v_mfma_f32_16x16x32_bf16 v[32:35], a[32:35], v[72:75], v[32:35]
 ds_read_b128 v[64:67], v6 offset:12288
 v_mfma_f32_16x16x32_bf16 v[36:39], a[96:99], v[72:75], v[36:39]
 s_waitcnt lgkmcnt(3)
 v_mfma_f32_16x16x32_bf16 v[32:35], a[36:39], v[76:79], v[32:35]
 ds_read_b128 v[68:71], v11 offset:12288
 v_mfma_f32_16x16x32_bf16 v[36:39], a[100:103], v[76:79], v[36:39]
 s_waitcnt lgkmcnt(3)
 v_mfma_f32_16x16x32_bf16 v[32:35], a[40:43], v[80:83], v[32:35]
 ds_read_b128 v[72:75], v6 offset:14336
 v_mfma_f32_16x16x32_bf16 v[36:39], a[104:107], v[80:83], v[36:39]
 s_waitcnt lgkmcnt(3)
 v_mfma_f32_16x16x32_bf16 v[32:35], a[44:47], v[84:87], v[32:35]
 ds_read_b128 v[76:79], v11 offset:14336
 v_mfma_f32_16x16x32_bf16 v[36:39], a[108:111], v[84:87], v[36:39]
 s_waitcnt lgkmcnt(3)
 v_mfma_f32_16x16x32_bf16 v[32:35], a[48:51], v[64:67], v[32:35]
 v_mfma_f32_16x16x32_bf16 v[36:39], a[112:115], v[64:67], v[36:39]
 s_waitcnt lgkmcnt(2)
 v_mfma_f32_16x16x32_bf16 v[32:35], a[52:55], v[68:71], v[32:35]
 v_mfma_f32_16x16x32_bf16 v[36:39], a[116:119], v[68:71], v[36:39]
 s_waitcnt lgkmcnt(1)
 v_mfma_f32_16x16x32_bf16 v[32:35], a[56:59], v[72:75], v[32:35]
 v_mfma_f32_16x16x32_bf16 v[36:39], a[120:123], v[72:75], v[36:39]
 s_waitcnt lgkmcnt(0)
 v_mfma_f32_16x16x32_bf16 v[32:35], a[60:63], v[76:79], v[32:35]
 v_mfma_f32_16x16x32_bf16 v[36:39], a[124:127], v[76:79], v[36:39]
 v_xor_b32 v6, 16384, v6
 v_xor_b32 v11, 16384, v11
 s_nop 5
 v_mul_f32 v48, 0xbfb8aa3b, v32
 v_mul_f32 v49, 0xbfb8aa3b, v33
 v_mul_f32 v50, 0xbfb8aa3b, v34
 v_mul_f32 v51, 0xbfb8aa3b, v35
 v_mul_f32 v52, 0xbfb8aa3b, v36
 v_mul_f32 v53, 0xbfb8aa3b, v37
 v_mul_f32 v54, 0xbfb8aa3b, v38
 v_mul_f32 v55, 0xbfb8aa3b, v39
 v_exp_f32 v48, v48
 v_exp_f32 v49, v49
 v_exp_f32 v50, v50
 v_exp_f32 v51, v51
 v_exp_f32 v52, v52
 v_exp_f32 v53, v53
 v_exp_f32 v54, v54
 v_exp_f32 v55, v55
 v_add_f32 v48, 1.0, v48
 v_add_f32 v49, 1.0, v49
 v_add_f32 v50, 1.0, v50
 v_add_f32 v51, 1.0, v51
 v_add_f32 v52, 1.0, v52
 v_add_f32 v53, 1.0, v53
 v_add_f32 v54, 1.0, v54
 v_add_f32 v55, 1.0, v55
 v_rcp_f32 v48, v48
 v_rcp_f32 v49, v49
 v_rcp_f32 v50, v50
 v_rcp_f32 v51, v51
 v_rcp_f32 v52, v52
 v_rcp_f32 v53, v53
 v_rcp_f32 v54, v54
 v_rcp_f32 v55, v55
 v_mul_f32 v32, v32, v48
 v_mul_f32 v33, v33, v49
 v_mul_f32 v34, v34, v50
 v_mul_f32 v35, v35, v51
 v_mul_f32 v36, v36, v52
 v_mul_f32 v37, v37, v53
 v_mul_f32 v38, v38, v54
 v_mul_f32 v39, v39, v55
 v_cvt_pk_bf16_f32 v48, v32, v33
 v_cvt_pk_bf16_f32 v49, v34, v35
 v_cvt_pk_bf16_f32 v50, v36, v37
 v_cvt_pk_bf16_f32 v51, v38, v39
 ds_write_b128 v5, v[48:51]
 s_waitcnt vmcnt(4)
 s_cmp_eq_u32 s46, 5
 s_cbranch_scc1 L_fmw_22
 s_waitcnt vmcnt(0)
L_fmw_22:
 v_cmp_eq_u32 vcc, 0, v9
 s_cmp_eq_u64 vcc, 0
 s_cselect_b32 s24, 4, 0
 v_mov_b32 v24, s24
 v_mov_b32 v25, 69632
 s_mov_b64 exec, s[44:45]
 ds_write_b32 v25, v24
 s_mov_b64 exec, -1
 s_waitcnt lgkmcnt(0)
 s_barrier
 ds_read_b32 v24, v25
 ds_read_b128 v[64:67], v7 offset:0
 ds_read_b128 v[68:71], v7 offset:1024
 ds_read_b128 v[72:75], v7 offset:2048
 ds_read_b128 v[76:79], v7 offset:3072
 s_cmp_eq_u32 s47, 0
 s_cbranch_scc1 L_fnp_23
 v_mov_b32 v26, 2
 s_mov_b64 exec, s[44:45]
 buffer_store_dword v26, off, s[4:7], s47 sc1
 s_mov_b64 exec, -1
 s_mov_b32 s47, 0
L_fnp_23:
 s_waitcnt lgkmcnt(4)
 v_readfirstlane_b32 s24, v24
 s_cmp_eq_u32 s46, 0
 s_cselect_b32 s46, s24, s46
 s_cmp_eq_u32 s46, 4
 s_cbranch_scc0 L_fnf_24
 s_add_u32 m0, s38, 0
 s_add_u32 s24, s37, 0
 buffer_load_dwordx4 v2, s[4:7], s24 offen sc1 lds
 s_add_u32 m0, s38, 1024
 s_add_u32 s24, s37, 0
 buffer_load_dwordx4 v10, s[4:7], s24 offen sc1 lds
 s_add_u32 m0, s38, 2048
 s_add_u32 s24, s37, 128
 buffer_load_dwordx4 v2, s[4:7], s24 offen sc1 lds
 s_add_u32 m0, s38, 3072
 s_add_u32 s24, s37, 128
 buffer_load_dwordx4 v10, s[4:7], s24 offen sc1 lds
L_fnf_24:
 s_add_u32 s24, s43, 128
 buffer_load_dword v8, v4, s[4:7], s24 offen sc1
 buffer_load_dword v9, v4, s[4:7], s43 offen sc1
 s_waitcnt lgkmcnt(3)
 v_mfma_f32_16x16x32_bf16 v[32:35], v[128:131], v[64:67], 0
 v_mfma_f32_16x16x32_bf16 v[36:39], v[132:135], v[64:67], 0
 s_waitcnt lgkmcnt(2)
 v_mfma_f32_16x16x32_bf16 v[32:35], v[136:139], v[68:71], v[32:35]
 v_mfma_f32_16x16x32_bf16 v[36:39], v[140:143], v[68:71], v[36:39]
 s_waitcnt lgkmcnt(1)
 v_mfma_f32_16x16x32_bf16 v[32:35], v[144:147], v[72:75], v[32:35]
 v_mfma_f32_16x16x32_bf16 v[36:39], v[148:151], v[72:75], v[36:39]
 s_waitcnt lgkmcnt(0)
 v_mfma_f32_16x16x32_bf16 v[32:35], v[152:155], v[76:79], v[32:35]
 v_mfma_f32_16x16x32_bf16 v[36:39], v[156:159], v[76:79], v[36:39]
 v_mfma_f32_16x16x32_bf16 v[40:43], v[160:163], v[64:67], 0
 v_mfma_f32_16x16x32_bf16 v[44:47], v[164:167], v[64:67], 0
 v_mfma_f32_16x16x32_bf16 v[40:43], v[168:171], v[68:71], v[40:43]
 v_cvt_pk_bf16_f32 v120, v32, v33
 v_mfma_f32_16x16x32_bf16 v[44:47], v[172:175], v[68:71], v[44:47]
 v_cvt_pk_bf16_f32 v121, v34, v35
 v_mfma_f32_16x16x32_bf16 v[40:43], v[176:179], v[72:75], v[40:43]
 v_cvt_pk_bf16_f32 v122, v36, v37
 v_mfma_f32_16x16x32_bf16 v[44:47], v[180:183], v[72:75], v[44:47]
 v_cvt_pk_bf16_f32 v123, v38, v39
 v_mfma_f32_16x16x32_bf16 v[40:43], v[184:187], v[76:79], v[40:43]
 buffer_store_dwordx4 v[120:123], v3, s[4:7], s34 offen offset:0 sc1
 v_mfma_f32_16x16x32_bf16 v[44:47], v[188:191], v[76:79], v[44:47]
 v_mfma_f32_16x16x32_bf16 v[32:35], v[192:195], v[64:67], 0
 v_mfma_f32_16x16x32_bf16 v[36:39], v[196:199], v[64:67], 0
 v_mfma_f32_16x16x32_bf16 v[32:35], v[200:203], v[68:71], v[32:35]
 v_cvt_pk_bf16_f32 v124, v40, v41
 v_mfma_f32_16x16x32_bf16 v[36:39], v[204:207], v[68:71], v[36:39]
 v_cvt_pk_bf16_f32 v125, v42, v43
 v_mfma_f32_16x16x32_bf16 v[32:35], v[208:211], v[72:75], v[32:35]
 v_cvt_pk_bf16_f32 v126, v44, v45
 v_mfma_f32_16x16x32_bf16 v[36:39], v[212:215], v[72:75], v[36:39]
 v_cvt_pk_bf16_f32 v127, v46, v47
 v_mfma_f32_16x16x32_bf16 v[32:35], v[216:219], v[76:79], v[32:35]
 buffer_store_dwordx4 v[124:127], v3, s[4:7], s34 offen offset:64 sc1
 v_mfma_f32_16x16x32_bf16 v[36:39], v[220:223], v[76:79], v[36:39]
 v_mfma_f32_16x16x32_bf16 v[40:43], v[224:227], v[64:67], 0
 v_mfma_f32_16x16x32_bf16 v[44:47], v[228:231], v[64:67], 0
 v_mfma_f32_16x16x32_bf16 v[40:43], v[232:235], v[68:71], v[40:43]
 v_cvt_pk_bf16_f32 v120, v32, v33
 v_mfma_f32_16x16x32_bf16 v[44:47], v[236:239], v[68:71], v[44:47]
 v_cvt_pk_bf16_f32 v121, v34, v35
 v_mfma_f32_16x16x32_bf16 v[40:43], v[240:243], v[72:75], v[40:43]
 v_cvt_pk_bf16_f32 v122, v36, v37
 v_mfma_f32_16x16x32_bf16 v[44:47], v[244:247], v[72:75], v[44:47]
 v_cvt_pk_bf16_f32 v123, v38, v39
 v_mfma_f32_16x16x32_bf16 v[40:43], v[248:251], v[76:79], v[40:43]
 buffer_store_dwordx4 v[120:123], v3, s[4:7], s34 offen offset:128 sc1
 v_mfma_f32_16x16x32_bf16 v[44:47], v[252:255], v[76:79], v[44:47]
 s_nop 7
 v_cvt_pk_bf16_f32 v124, v40, v41
 v_cvt_pk_bf16_f32 v125, v42, v43
 v_cvt_pk_bf16_f32 v126, v44, v45
 v_cvt_pk_bf16_f32 v127, v46, v47
 buffer_store_dwordx4 v[124:127], v3, s[4:7], s34 offen offset:192 sc1
 s_cmp_ge_u32 s46, 4
 s_cbranch_scc0 L_fnd_29
 s_mov_b32 s47, s35
 s_add_u32 s18, s18, 1
 s_branch L_floop_18
L_fnd_29:
 s_cmp_eq_u32 s46, 0
 s_cbranch_scc0 L_fhave_26
 s_waitcnt vmcnt(4)
 v_cmp_eq_u32 vcc, 0, v9
 s_cbranch_vccnz L_fag_28
 s_add_u32 m0, s38, 0
 s_add_u32 s24, s37, 0
 buffer_load_dwordx4 v2, s[4:7], s24 offen sc1 lds
 s_add_u32 m0, s38, 1024
 s_add_u32 s24, s37, 0
 buffer_load_dwordx4 v10, s[4:7], s24 offen sc1 lds
 s_add_u32 m0, s38, 2048
 s_add_u32 s24, s37, 128
 buffer_load_dwordx4 v2, s[4:7], s24 offen sc1 lds
 s_add_u32 m0, s38, 3072
 s_add_u32 s24, s37, 128
 buffer_load_dwordx4 v10, s[4:7], s24 offen sc1 lds
 s_mov_b32 s46, 1
 s_waitcnt vmcnt(4)
 s_branch L_ffl_27
L_fag_28:
 buffer_load_dword v9, v4, s[4:7], s43 offen sc1
 s_waitcnt vmcnt(0)
 v_cmp_eq_u32 vcc, 0, v9
 s_cbranch_vccnz L_ffl_27
 s_add_u32 m0, s38, 0
 s_add_u32 s24, s37, 0
 buffer_load_dwordx4 v2, s[4:7], s24 offen sc1 lds
 s_add_u32 m0, s38, 1024
 s_add_u32 s24, s37, 0
 buffer_load_dwordx4 v10, s[4:7], s24 offen sc1 lds
 s_add_u32 m0, s38, 2048
 s_add_u32 s24, s37, 128
 buffer_load_dwordx4 v2, s[4:7], s24 offen sc1 lds
 s_add_u32 m0, s38, 3072
 s_add_u32 s24, s37, 128
 buffer_load_dwordx4 v10, s[4:7], s24 offen sc1 lds
 s_mov_b32 s46, 1
 s_branch L_ffl_27
L_fhave_26:
 s_waitcnt vmcnt(0)
L_ffl_27:
 s_barrier
 v_mov_b32 v24, 2
 s_mov_b64 exec, s[44:45]
 buffer_store_dword v24, off, s[4:7], s35 sc1
 s_mov_b64 exec, -1
 s_add_u32 s18, s18, 1
 s_cmp_eq_u32 s46, 1
 s_cbranch_scc1 L_floop_18
 s_cmp_eq_u32 s46, 2
 s_cbranch_scc1 L_fend_25
 s_mov_b32 s23, 0
L_wline_30:
 buffer_load_dword v9, v4, s[4:7], s43 offen sc1
 s_add_u32 s23, s23, 1
 s_cmp_gt_u32 s23, 262144
 s_cbranch_scc1 L_bail
 s_waitcnt vmcnt(0)
 v_cmp_gt_u32 vcc, 1, v9
 s_cbranch_vccz L_wline_30_ok
 s_sleep 1
 s_branch L_wline_30
L_wline_30_ok:
 s_add_u32 m0, s38, 0
 s_add_u32 s24, s37, 0
 buffer_load_dwordx4 v2, s[4:7], s24 offen sc1 lds
 s_add_u32 m0, s38, 1024
 s_add_u32 s24, s37, 0
 buffer_load_dwordx4 v10, s[4:7], s24 offen sc1 lds
 s_add_u32 m0, s38, 2048
 s_add_u32 s24, s37, 128
 buffer_load_dwordx4 v2, s[4:7], s24 offen sc1 lds
 s_add_u32 m0, s38, 3072
 s_add_u32 s24, s37, 128
 buffer_load_dwordx4 v10, s[4:7], s24 offen sc1 lds
 buffer_load_dword v9, v4, s[4:7], s43 offen sc1
 s_branch L_floop_18
L_fend_25:
 s_waitcnt vmcnt(0)
 s_endpgm
L_T:
 s_sub_u32 s16, s45, 32
 v_lshrrev_b32 v20, 6, v31
 v_and_b32 v21, 63, v31
 v_readfirstlane_b32 s17, v20
 v_and_b32 v22, 15, v21
 v_lshrrev_b32 v23, 4, v21
 s_mov_b32 s28, -1
 s_mov_b32 s29, 0
 s_mov_b32 s30, 0
 s_mov_b32 s31, -1
 s_mov_b32 s39, 0x7f817f81
 s_mov_b32 s33, 0x3e0293ee
 s_lshr_b32 s24, s16, 5
 s_lshl_b32 s24, s24, 3
 s_and_b32 s25, s16, 7
 s_add_u32 s19, s24, s25
 s_bfe_u32 s20, s16, 0x20003
 v_lshlrev_b32 v1, 4, v21
 v_and_b32 v24, 31, v21
 v_lshlrev_b32 v7, 2, v24
 s_lshl_b32 s24, s17, 15
 s_add_u32 s24, s24, 32768
 v_add_u32 v3, s24, v1
 v_lshlrev_b32 v24, 15, v22
 v_lshl_add_u32 v24, v23, 4, v24
 s_lshl_b32 s24, s19, 10
 s_lshl_b32 s25, s17, 8
 s_add_u32 s24, s24, s25
 v_add_u32 v4, s24, v24
 v_lshrrev_b32 v24, 1, v23
 v_lshl_add_u32 v24, v24, 4, v22
 v_lshl_add_u32 v24, v20, 5, v24
 v_lshlrev_b32 v24, 3, v24
 v_and_b32 v25, 1, v23
 v_mul_u32_u24 v25, 1056, v25
 v_add_u32 v24, v24, v25
 v_add_u32 v5, 24576, v24
 v_bfe_u32 v24, v21, 2, 2
 v_lshl_add_u32 v24, v23, 3, v24
 v_lshlrev_b32 v24, 3, v24
 v_and_b32 v25, 1, v21
 v_mul_u32_u24 v25, 1056, v25
 v_add_u32 v24, v24, v25
 v_add_u32 v6, 24576, v24
 v_lshlrev_b32 v24, 2, v23
 v_and_b32 v24, 7, v21
 v_xor_b32 v24, v24, v23
 v_lshrrev_b32 v25, 3, v21
 v_lshlrev_b32 v25, 10, v25
 v_lshl_add_u32 v2, v24, 4, v25
 v_xor_b32 v8, 64, v2
 v_add_u32 v8, 8192, v8
 v_lshrrev_b32 v24, 1, v22
 v_xor_b32 v24, v24, v23
 v_lshlrev_b32 v25, 7, v22
 v_lshl_add_u32 v0, v24, 4, v25
 v_lshlrev_b32 v24, 2, v23
 v_add_u32 v25, 0, v24
 v_cmp_le_u32 vcc, v25, v22
 s_bitcmp1_b32 s17, 0
 s_cselect_b64 s[60:61], -1, vcc
 s_cselect_b64 s[68:69], vcc, 0
 v_add_u32 v25, 1, v24
 v_cmp_le_u32 vcc, v25, v22
 s_bitcmp1_b32 s17, 0
 s_cselect_b64 s[62:63], -1, vcc
 s_cselect_b64 s[70:71], vcc, 0
 v_add_u32 v25, 2, v24
 v_cmp_le_u32 vcc, v25, v22
 s_bitcmp1_b32 s17, 0
 s_cselect_b64 s[64:65], -1, vcc
 s_cselect_b64 s[72:73], vcc, 0
 v_add_u32 v25, 3, v24
 v_cmp_le_u32 vcc, v25, v22
 s_bitcmp1_b32 s17, 0
 s_cselect_b64 s[66:67], -1, vcc
 s_cselect_b64 s[74:75], vcc, 0
 s_load_dwordx2 s[48:49], s[0:1], 24
 s_load_dwordx2 s[50:51], s[0:1], 32
 s_load_dwordx2 s[52:53], s[0:1], 16
 s_load_dwordx2 s[54:55], s[0:1], 40
 v_lshrrev_b32 v24, 2, v21
 v_and_b32 v25, 3, v21
 v_lshlrev_b32 v25, 4, v25
 v_lshl_add_u32 v26, v24, 13, v25
 s_lshl_b32 s24, s19, 8
 s_lshl_b32 s25, s17, 6
 s_add_u32 s24, s24, s25
 v_add_u32 v26, s24, v26
 v_lshlrev_b32 v27, 10, v23
 v_lshl_add_u32 v27, v22, 4, v27
 s_lshl_b32 s24, s19, 17
 s_lshl_b32 s25, s17, 8
 s_add_u32 s24, s24, s25
 v_add_u32 v27, s24, v27
 s_lshl_b32 s26, s17, 15
 s_add_u32 s26, s26, 32768
 v_bfe_u32 v24, v21, 2, 2
 v_and_b32 v25, 3, v21
 v_lshl_add_u32 v28, v23, 3, v24
 v_lshlrev_b32 v28, 6, v28
 v_add_u32 v28, s26, v28
 v_lshl_add_u32 v29, v25, 3, v28
 v_lshl_add_u32 v28, v25, 4, v28
 v_lshl_add_u32 v30, v23, 2, v24
 v_lshlrev_b32 v30, 8, v30
 v_lshl_add_u32 v30, v25, 4, v30
 v_add_u32 v30, s26, v30
 s_waitcnt lgkmcnt(0)
 s_mov_b32 s76, s48
 s_and_b32 s77, s49, 0xffff
 s_mov_b32 s78, 0x400000
 s_mov_b32 s79, 0x20000
 s_mov_b32 s80, s50
 s_and_b32 s81, s51, 0xffff
 s_mov_b32 s82, 0x400000
 s_mov_b32 s83, 0x20000
 s_mov_b32 s84, s52
 s_and_b32 s85, s53, 0xffff
 s_mov_b32 s86, 0x400000
 s_mov_b32 s87, 0x20000
 s_mov_b32 s88, s54
 s_and_b32 s89, s55, 0xffff
 s_mov_b32 s90, 0x400000
 s_mov_b32 s91, 0x20000
 s_and_b32 s25, s16, 31
 s_lshl_b32 s25, s25, 2
 s_add_u32 s25, s25, s17
 s_lshl_b32 s27, s25, 15
 s_lshr_b32 s24, s16, 5
 s_lshl_b32 s24, s24, 11
 s_add_u32 s27, s27, s24
 s_waitcnt vmcnt(0)
 s_waitcnt vmcnt(0)
 v_lshlrev_b32 v24, 2, v23
 v_xor_b32 v24, v24, v22
 v_lshlrev_b32 v26, 13, v23
 v_lshl_add_u32 v26, v24, 4, v26
 s_lshl_b32 s24, s19, 8
 s_lshl_b32 s25, s17, 16
 s_add_u32 s24, s24, s25
 v_add_u32 v40, s24, v26
 v_bfe_u32 v24, v21, 2, 2
 v_and_b32 v25, 3, v21
 v_lshl_add_u32 v26, v23, 3, v24
 v_xor_b32 v24, s17, v24
 v_lshlrev_b32 v24, 6, v24
 v_lshl_add_u32 v26, v26, 8, v24
 v_add_u32 v26, 32768, v26
 v_lshl_add_u32 v41, v25, 4, v26
 v_add_u32 v42, 65536, v41
 v_lshl_add_u32 v28, v25, 3, v26
 v_add_u32 v29, 65536, v28
 s_lshl_b32 s94, s17, 11
 s_add_u32 s93, s94, 32768
 s_add_u32 m0, s93, 0
 s_mov_b32 s24, 0x0
 buffer_load_dwordx4 v40, s[76:79], s24 offen lds
 s_add_u32 m0, s93, 1024
 s_mov_b32 s24, 0x8000
 buffer_load_dwordx4 v40, s[76:79], s24 offen lds
 s_add_u32 m0, s93, 8192
 s_mov_b32 s24, 0x40000
 buffer_load_dwordx4 v40, s[76:79], s24 offen lds
 s_add_u32 m0, s93, 9216
 s_mov_b32 s24, 0x48000
 buffer_load_dwordx4 v40, s[76:79], s24 offen lds
 s_add_u32 m0, s93, 16384
 s_mov_b32 s24, 0x80000
 buffer_load_dwordx4 v40, s[76:79], s24 offen lds
 s_add_u32 m0, s93, 17408
 s_mov_b32 s24, 0x88000
 buffer_load_dwordx4 v40, s[76:79], s24 offen lds
 s_add_u32 m0, s93, 24576
 s_mov_b32 s24, 0xc0000
 buffer_load_dwordx4 v40, s[76:79], s24 offen lds
 s_add_u32 m0, s93, 25600
 s_mov_b32 s24, 0xc8000
 buffer_load_dwordx4 v40, s[76:79], s24 offen lds
 s_add_u32 m0, s93, 32768
 s_mov_b32 s24, 0x100000
 buffer_load_dwordx4 v40, s[76:79], s24 offen lds
 s_add_u32 m0, s93, 33792
 s_mov_b32 s24, 0x108000
 buffer_load_dwordx4 v40, s[76:79], s24 offen lds
 s_add_u32 m0, s93, 40960
 s_mov_b32 s24, 0x140000
 buffer_load_dwordx4 v40, s[76:79], s24 offen lds
 s_add_u32 m0, s93, 41984
 s_mov_b32 s24, 0x148000
 buffer_load_dwordx4 v40, s[76:79], s24 offen lds
 s_add_u32 m0, s93, 49152
 s_mov_b32 s24, 0x180000
 buffer_load_dwordx4 v40, s[76:79], s24 offen lds
 s_add_u32 m0, s93, 50176
 s_mov_b32 s24, 0x188000
 buffer_load_dwordx4 v40, s[76:79], s24 offen lds
 s_add_u32 m0, s93, 57344
 s_mov_b32 s24, 0x1c0000
 buffer_load_dwordx4 v40, s[76:79], s24 offen lds
 s_add_u32 m0, s93, 58368
 s_mov_b32 s24, 0x1c8000
 buffer_load_dwordx4 v40, s[76:79], s24 offen lds
 s_add_u32 m0, s93, 65536
 s_mov_b32 s24, 0x200000
 buffer_load_dwordx4 v40, s[76:79], s24 offen lds
 s_add_u32 m0, s93, 66560
 s_mov_b32 s24, 0x208000
 buffer_load_dwordx4 v40, s[76:79], s24 offen lds
 s_add_u32 m0, s93, 73728
 s_mov_b32 s24, 0x240000
 buffer_load_dwordx4 v40, s[76:79], s24 offen lds
 s_add_u32 m0, s93, 74752
 s_mov_b32 s24, 0x248000
 buffer_load_dwordx4 v40, s[76:79], s24 offen lds
 s_add_u32 m0, s93, 81920
 s_mov_b32 s24, 0x280000
 buffer_load_dwordx4 v40, s[76:79], s24 offen lds
 s_add_u32 m0, s93, 82944
 s_mov_b32 s24, 0x288000
 buffer_load_dwordx4 v40, s[76:79], s24 offen lds
 s_add_u32 m0, s93, 90112
 s_mov_b32 s24, 0x2c0000
 buffer_load_dwordx4 v40, s[76:79], s24 offen lds
 s_add_u32 m0, s93, 91136
 s_mov_b32 s24, 0x2c8000
 buffer_load_dwordx4 v40, s[76:79], s24 offen lds
 s_add_u32 m0, s93, 98304
 s_mov_b32 s24, 0x300000
 buffer_load_dwordx4 v40, s[76:79], s24 offen lds
 s_add_u32 m0, s93, 99328
 s_mov_b32 s24, 0x308000
 buffer_load_dwordx4 v40, s[76:79], s24 offen lds
 s_add_u32 m0, s93, 106496
 s_mov_b32 s24, 0x340000
 buffer_load_dwordx4 v40, s[76:79], s24 offen lds
 s_add_u32 m0, s93, 107520
 s_mov_b32 s24, 0x348000
 buffer_load_dwordx4 v40, s[76:79], s24 offen lds
 s_add_u32 m0, s93, 114688
 s_mov_b32 s24, 0x380000
 buffer_load_dwordx4 v40, s[76:79], s24 offen lds
 s_add_u32 m0, s93, 115712
 s_mov_b32 s24, 0x388000
 buffer_load_dwordx4 v40, s[76:79], s24 offen lds
 s_waitcnt vmcnt(28)
 s_barrier
 s_add_u32 m0, s93, 122880
 s_mov_b32 s24, 0x3c0000
 buffer_load_dwordx4 v40, s[76:79], s24 offen lds
 s_add_u32 m0, s93, 123904
 s_mov_b32 s24, 0x3c8000
 buffer_load_dwordx4 v40, s[76:79], s24 offen lds
 ds_read_b64_tr_b16 a[128:129], v41 offset:0
 ds_read_b64_tr_b16 a[130:131], v41 offset:1024
 ds_read_b64_tr_b16 a[192:193], v41 offset:8
 ds_read_b64_tr_b16 a[194:195], v41 offset:1032
 s_waitcnt lgkmcnt(0)
 s_waitcnt vmcnt(28)
 s_barrier
 s_add_u32 m0, s93, 0
 s_mov_b32 s24, 0x0
 buffer_load_dwordx4 v40, s[80:83], s24 offen lds
 s_add_u32 m0, s93, 1024
 s_mov_b32 s24, 0x8000
 buffer_load_dwordx4 v40, s[80:83], s24 offen lds
 ds_read_b64_tr_b16 a[132:133], v41 offset:8192
 ds_read_b64_tr_b16 a[134:135], v41 offset:9216
 ds_read_b64_tr_b16 a[196:197], v41 offset:8200
 ds_read_b64_tr_b16 a[198:199], v41 offset:9224
 s_waitcnt lgkmcnt(0)
 s_waitcnt vmcnt(28)
 s_barrier
 s_add_u32 m0, s93, 8192
 s_mov_b32 s24, 0x40000
 buffer_load_dwordx4 v40, s[80:83], s24 offen lds
 s_add_u32 m0, s93, 9216
 s_mov_b32 s24, 0x48000
 buffer_load_dwordx4 v40, s[80:83], s24 offen lds
 ds_read_b64_tr_b16 a[136:137], v41 offset:16384
 ds_read_b64_tr_b16 a[138:139], v41 offset:17408
 ds_read_b64_tr_b16 a[200:201], v41 offset:16392
 ds_read_b64_tr_b16 a[202:203], v41 offset:17416
 s_waitcnt lgkmcnt(0)
 s_waitcnt vmcnt(28)
 s_barrier
 s_add_u32 m0, s93, 16384
 s_mov_b32 s24, 0x80000
 buffer_load_dwordx4 v40, s[80:83], s24 offen lds
 s_add_u32 m0, s93, 17408
 s_mov_b32 s24, 0x88000
 buffer_load_dwordx4 v40, s[80:83], s24 offen lds
 ds_read_b64_tr_b16 a[140:141], v41 offset:24576
 ds_read_b64_tr_b16 a[142:143], v41 offset:25600
 ds_read_b64_tr_b16 a[204:205], v41 offset:24584
 ds_read_b64_tr_b16 a[206:207], v41 offset:25608
 s_waitcnt lgkmcnt(0)
 s_waitcnt vmcnt(28)
 s_barrier
 s_add_u32 m0, s93, 24576
 s_mov_b32 s24, 0xc0000
 buffer_load_dwordx4 v40, s[80:83], s24 offen lds
 s_add_u32 m0, s93, 25600
 s_mov_b32 s24, 0xc8000
 buffer_load_dwordx4 v40, s[80:83], s24 offen lds
 ds_read_b64_tr_b16 a[144:145], v41 offset:32768
 ds_read_b64_tr_b16 a[146:147], v41 offset:33792
 ds_read_b64_tr_b16 a[208:209], v41 offset:32776
 ds_read_b64_tr_b16 a[210:211], v41 offset:33800
 s_waitcnt lgkmcnt(0)
 s_waitcnt vmcnt(28)
 s_barrier
 s_add_u32 m0, s93, 32768
 s_mov_b32 s24, 0x100000
 buffer_load_dwordx4 v40, s[80:83], s24 offen lds
 s_add_u32 m0, s93, 33792
 s_mov_b32 s24, 0x108000
 buffer_load_dwordx4 v40, s[80:83], s24 offen lds
 ds_read_b64_tr_b16 a[148:149], v41 offset:40960
 ds_read_b64_tr_b16 a[150:151], v41 offset:41984
 ds_read_b64_tr_b16 a[212:213], v41 offset:40968
 ds_read_b64_tr_b16 a[214:215], v41 offset:41992
 s_waitcnt lgkmcnt(0)
 s_waitcnt vmcnt(28)
 s_barrier
 s_add_u32 m0, s93, 40960
 s_mov_b32 s24, 0x140000
 buffer_load_dwordx4 v40, s[80:83], s24 offen lds
 s_add_u32 m0, s93, 41984
 s_mov_b32 s24, 0x148000
 buffer_load_dwordx4 v40, s[80:83], s24 offen lds
 ds_read_b64_tr_b16 a[152:153], v41 offset:49152
 ds_read_b64_tr_b16 a[154:155], v41 offset:50176
 ds_read_b64_tr_b16 a[216:217], v41 offset:49160
 ds_read_b64_tr_b16 a[218:219], v41 offset:50184
 s_waitcnt lgkmcnt(0)
 s_waitcnt vmcnt(28)
 s_barrier
 s_add_u32 m0, s93, 49152
 s_mov_b32 s24, 0x180000
 buffer_load_dwordx4 v40, s[80:83], s24 offen lds
 s_add_u32 m0, s93, 50176
 s_mov_b32 s24, 0x188000
 buffer_load_dwordx4 v40, s[80:83], s24 offen lds
 ds_read_b64_tr_b16 a[156:157], v41 offset:57344
 ds_read_b64_tr_b16 a[158:159], v41 offset:58368
 ds_read_b64_tr_b16 a[220:221], v41 offset:57352
 ds_read_b64_tr_b16 a[222:223], v41 offset:58376
 s_waitcnt lgkmcnt(0)
 s_waitcnt vmcnt(28)
 s_barrier
 s_add_u32 m0, s93, 57344
 s_mov_b32 s24, 0x1c0000
 buffer_load_dwordx4 v40, s[80:83], s24 offen lds
 s_add_u32 m0, s93, 58368
 s_mov_b32 s24, 0x1c8000
 buffer_load_dwordx4 v40, s[80:83], s24 offen lds
 ds_read_b64_tr_b16 a[160:161], v42 offset:0
 ds_read_b64_tr_b16 a[162:163], v42 offset:1024
 ds_read_b64_tr_b16 a[224:225], v42 offset:8
 ds_read_b64_tr_b16 a[226:227], v42 offset:1032
 s_waitcnt lgkmcnt(0)
 s_waitcnt vmcnt(28)
 s_barrier
 s_add_u32 m0, s93, 65536
 s_mov_b32 s24, 0x200000
 buffer_load_dwordx4 v40, s[80:83], s24 offen lds
 s_add_u32 m0, s93, 66560
 s_mov_b32 s24, 0x208000
 buffer_load_dwordx4 v40, s[80:83], s24 offen lds
 ds_read_b64_tr_b16 a[164:165], v42 offset:8192
 ds_read_b64_tr_b16 a[166:167], v42 offset:9216
 ds_read_b64_tr_b16 a[228:229], v42 offset:8200
 ds_read_b64_tr_b16 a[230:231], v42 offset:9224
 s_waitcnt lgkmcnt(0)
 s_waitcnt vmcnt(28)
 s_barrier
 s_add_u32 m0, s93, 73728
 s_mov_b32 s24, 0x240000
 buffer_load_dwordx4 v40, s[80:83], s24 offen lds
 s_add_u32 m0, s93, 74752
 s_mov_b32 s24, 0x248000
 buffer_load_dwordx4 v40, s[80:83], s24 offen lds
 ds_read_b64_tr_b16 a[168:169], v42 offset:16384
 ds_read_b64_tr_b16 a[170:171], v42 offset:17408
 ds_read_b64_tr_b16 a[232:233], v42 offset:16392
 ds_read_b64_tr_b16 a[234:235], v42 offset:17416
 s_waitcnt lgkmcnt(0)
 s_waitcnt vmcnt(28)
 s_barrier
 s_add_u32 m0, s93, 81920
 s_mov_b32 s24, 0x280000
 buffer_load_dwordx4 v40, s[80:83], s24 offen lds
 s_add_u32 m0, s93, 82944
 s_mov_b32 s24, 0x288000
 buffer_load_dwordx4 v40, s[80:83], s24 offen lds
 ds_read_b64_tr_b16 a[172:173], v42 offset:24576
 ds_read_b64_tr_b16 a[174:175], v42 offset:25600
 ds_read_b64_tr_b16 a[236:237], v42 offset:24584
 ds_read_b64_tr_b16 a[238:239], v42 offset:25608
 s_waitcnt lgkmcnt(0)
 s_waitcnt vmcnt(28)
 s_barrier
 s_add_u32 m0, s93, 90112
 s_mov_b32 s24, 0x2c0000
 buffer_load_dwordx4 v40, s[80:83], s24 offen lds
 s_add_u32 m0, s93, 91136
 s_mov_b32 s24, 0x2c8000
 buffer_load_dwordx4 v40, s[80:83], s24 offen lds
 ds_read_b64_tr_b16 a[176:177], v42 offset:32768
 ds_read_b64_tr_b16 a[178:179], v42 offset:33792
 ds_read_b64_tr_b16 a[240:241], v42 offset:32776
 ds_read_b64_tr_b16 a[242:243], v42 offset:33800
 s_waitcnt lgkmcnt(0)
 s_waitcnt vmcnt(28)
 s_barrier
 s_add_u32 m0, s93, 98304
 s_mov_b32 s24, 0x300000
 buffer_load_dwordx4 v40, s[80:83], s24 offen lds
 s_add_u32 m0, s93, 99328
 s_mov_b32 s24, 0x308000
 buffer_load_dwordx4 v40, s[80:83], s24 offen lds
 ds_read_b64_tr_b16 a[180:181], v42 offset:40960
 ds_read_b64_tr_b16 a[182:183], v42 offset:41984
 ds_read_b64_tr_b16 a[244:245], v42 offset:40968
 ds_read_b64_tr_b16 a[246:247], v42 offset:41992
 s_waitcnt lgkmcnt(0)
 s_waitcnt vmcnt(28)
 s_barrier
 s_add_u32 m0, s93, 106496
 s_mov_b32 s24, 0x340000
 buffer_load_dwordx4 v40, s[80:83], s24 offen lds
 s_add_u32 m0, s93, 107520
 s_mov_b32 s24, 0x348000
 buffer_load_dwordx4 v40, s[80:83], s24 offen lds
 ds_read_b64_tr_b16 a[184:185], v42 offset:49152
 ds_read_b64_tr_b16 a[186:187], v42 offset:50176
 ds_read_b64_tr_b16 a[248:249], v42 offset:49160
 ds_read_b64_tr_b16 a[250:251], v42 offset:50184
 s_waitcnt lgkmcnt(0)
 s_waitcnt vmcnt(28)
 s_barrier
 s_add_u32 m0, s93, 114688
 s_mov_b32 s24, 0x380000
 buffer_load_dwordx4 v40, s[80:83], s24 offen lds
 s_add_u32 m0, s93, 115712
 s_mov_b32 s24, 0x388000
 buffer_load_dwordx4 v40, s[80:83], s24 offen lds
 ds_read_b64_tr_b16 a[188:189], v42 offset:57344
 ds_read_b64_tr_b16 a[190:191], v42 offset:58368
 ds_read_b64_tr_b16 a[252:253], v42 offset:57352
 ds_read_b64_tr_b16 a[254:255], v42 offset:58376
 s_waitcnt lgkmcnt(0)
 s_waitcnt vmcnt(28)
 s_barrier
 s_add_u32 m0, s93, 122880
 s_mov_b32 s24, 0x3c0000
 buffer_load_dwordx4 v40, s[80:83], s24 offen lds
 s_add_u32 m0, s93, 123904
 s_mov_b32 s24, 0x3c8000
 buffer_load_dwordx4 v40, s[80:83], s24 offen lds
 ds_read_b64_tr_b16 v[128:129], v28 offset:0
 ds_read_b64_tr_b16 v[130:131], v28 offset:1024
 ds_read_b64_tr_b16 v[192:193], v28 offset:32
 ds_read_b64_tr_b16 v[194:195], v28 offset:1056
 s_waitcnt lgkmcnt(0)
 s_waitcnt vmcnt(28)
 s_barrier
 s_add_u32 m0, s93, 0
 s_mov_b32 s24, 0x0
 buffer_load_dwordx4 v40, s[84:87], s24 offen lds
 s_add_u32 m0, s93, 1024
 s_mov_b32 s24, 0x8000
 buffer_load_dwordx4 v40, s[84:87], s24 offen lds
 ds_read_b64_tr_b16 v[132:133], v28 offset:8192
 ds_read_b64_tr_b16 v[134:135], v28 offset:9216
 ds_read_b64_tr_b16 v[196:197], v28 offset:8224
 ds_read_b64_tr_b16 v[198:199], v28 offset:9248
 s_waitcnt lgkmcnt(0)
 s_waitcnt vmcnt(28)
 s_barrier
 s_add_u32 m0, s93, 8192
 s_mov_b32 s24, 0x40000
 buffer_load_dwordx4 v40, s[84:87], s24 offen lds
 s_add_u32 m0, s93, 9216
 s_mov_b32 s24, 0x48000
 buffer_load_dwordx4 v40, s[84:87], s24 offen lds
 ds_read_b64_tr_b16 v[136:137], v28 offset:16384
 ds_read_b64_tr_b16 v[138:139], v28 offset:17408
 ds_read_b64_tr_b16 v[200:201], v28 offset:16416
 ds_read_b64_tr_b16 v[202:203], v28 offset:17440
 s_waitcnt lgkmcnt(0)
 s_waitcnt vmcnt(28)
 s_barrier
 s_add_u32 m0, s93, 16384
 s_mov_b32 s24, 0x80000
 buffer_load_dwordx4 v40, s[84:87], s24 offen lds
 s_add_u32 m0, s93, 17408
 s_mov_b32 s24, 0x88000
 buffer_load_dwordx4 v40, s[84:87], s24 offen lds
 ds_read_b64_tr_b16 v[140:141], v28 offset:24576
 ds_read_b64_tr_b16 v[142:143], v28 offset:25600
 ds_read_b64_tr_b16 v[204:205], v28 offset:24608
 ds_read_b64_tr_b16 v[206:207], v28 offset:25632
 s_waitcnt lgkmcnt(0)
 s_waitcnt vmcnt(28)
 s_barrier
 s_add_u32 m0, s93, 24576
 s_mov_b32 s24, 0xc0000
 buffer_load_dwordx4 v40, s[84:87], s24 offen lds
 s_add_u32 m0, s93, 25600
 s_mov_b32 s24, 0xc8000
 buffer_load_dwordx4 v40, s[84:87], s24 offen lds
 ds_read_b64_tr_b16 v[144:145], v28 offset:32768
 ds_read_b64_tr_b16 v[146:147], v28 offset:33792
 ds_read_b64_tr_b16 v[208:209], v28 offset:32800
 ds_read_b64_tr_b16 v[210:211], v28 offset:33824
 s_waitcnt lgkmcnt(0)
 s_waitcnt vmcnt(28)
 s_barrier
 s_add_u32 m0, s93, 32768
 s_mov_b32 s24, 0x100000
 buffer_load_dwordx4 v40, s[84:87], s24 offen lds
 s_add_u32 m0, s93, 33792
 s_mov_b32 s24, 0x108000
 buffer_load_dwordx4 v40, s[84:87], s24 offen lds
 ds_read_b64_tr_b16 v[148:149], v28 offset:40960
 ds_read_b64_tr_b16 v[150:151], v28 offset:41984
 ds_read_b64_tr_b16 v[212:213], v28 offset:40992
 ds_read_b64_tr_b16 v[214:215], v28 offset:42016
 s_waitcnt lgkmcnt(0)
 s_waitcnt vmcnt(28)
 s_barrier
 s_add_u32 m0, s93, 40960
 s_mov_b32 s24, 0x140000
 buffer_load_dwordx4 v40, s[84:87], s24 offen lds
 s_add_u32 m0, s93, 41984
 s_mov_b32 s24, 0x148000
 buffer_load_dwordx4 v40, s[84:87], s24 offen lds
 ds_read_b64_tr_b16 v[152:153], v28 offset:49152
 ds_read_b64_tr_b16 v[154:155], v28 offset:50176
 ds_read_b64_tr_b16 v[216:217], v28 offset:49184
 ds_read_b64_tr_b16 v[218:219], v28 offset:50208
 s_waitcnt lgkmcnt(0)
 s_waitcnt vmcnt(28)
 s_barrier
 s_add_u32 m0, s93, 49152
 s_mov_b32 s24, 0x180000
 buffer_load_dwordx4 v40, s[84:87], s24 offen lds
 s_add_u32 m0, s93, 50176
 s_mov_b32 s24, 0x188000
 buffer_load_dwordx4 v40, s[84:87], s24 offen lds
 ds_read_b64_tr_b16 v[156:157], v28 offset:57344
 ds_read_b64_tr_b16 v[158:159], v28 offset:58368
 ds_read_b64_tr_b16 v[220:221], v28 offset:57376
 ds_read_b64_tr_b16 v[222:223], v28 offset:58400
 s_waitcnt lgkmcnt(0)
 s_waitcnt vmcnt(28)
 s_barrier
 s_add_u32 m0, s93, 57344
 s_mov_b32 s24, 0x1c0000
 buffer_load_dwordx4 v40, s[84:87], s24 offen lds
 s_add_u32 m0, s93, 58368
 s_mov_b32 s24, 0x1c8000
 buffer_load_dwordx4 v40, s[84:87], s24 offen lds
 ds_read_b64_tr_b16 v[160:161], v29 offset:0
 ds_read_b64_tr_b16 v[162:163], v29 offset:1024
 ds_read_b64_tr_b16 v[224:225], v29 offset:32
 ds_read_b64_tr_b16 v[226:227], v29 offset:1056
 s_waitcnt lgkmcnt(0)
 s_waitcnt vmcnt(28)
 s_barrier
 s_add_u32 m0, s93, 65536
 s_mov_b32 s24, 0x200000
 buffer_load_dwordx4 v40, s[84:87], s24 offen lds
 s_add_u32 m0, s93, 66560
 s_mov_b32 s24, 0x208000
 buffer_load_dwordx4 v40, s[84:87], s24 offen lds
 ds_read_b64_tr_b16 v[164:165], v29 offset:8192
 ds_read_b64_tr_b16 v[166:167], v29 offset:9216
 ds_read_b64_tr_b16 v[228:229], v29 offset:8224
 ds_read_b64_tr_b16 v[230:231], v29 offset:9248
 s_waitcnt lgkmcnt(0)
 s_waitcnt vmcnt(28)
 s_barrier
 s_add_u32 m0, s93, 73728
 s_mov_b32 s24, 0x240000
 buffer_load_dwordx4 v40, s[84:87], s24 offen lds
 s_add_u32 m0, s93, 74752
 s_mov_b32 s24, 0x248000
 buffer_load_dwordx4 v40, s[84:87], s24 offen lds
 ds_read_b64_tr_b16 v[168:169], v29 offset:16384
 ds_read_b64_tr_b16 v[170:171], v29 offset:17408
 ds_read_b64_tr_b16 v[232:233], v29 offset:16416
 ds_read_b64_tr_b16 v[234:235], v29 offset:17440
 s_waitcnt lgkmcnt(0)
 s_waitcnt vmcnt(28)
 s_barrier
 s_add_u32 m0, s93, 81920
 s_mov_b32 s24, 0x280000
 buffer_load_dwordx4 v40, s[84:87], s24 offen lds
 s_add_u32 m0, s93, 82944
 s_mov_b32 s24, 0x288000
 buffer_load_dwordx4 v40, s[84:87], s24 offen lds
 ds_read_b64_tr_b16 v[172:173], v29 offset:24576
 ds_read_b64_tr_b16 v[174:175], v29 offset:25600
 ds_read_b64_tr_b16 v[236:237], v29 offset:24608
 ds_read_b64_tr_b16 v[238:239], v29 offset:25632
 s_waitcnt lgkmcnt(0)
 s_waitcnt vmcnt(28)
 s_barrier
 s_add_u32 m0, s93, 90112
 s_mov_b32 s24, 0x2c0000
 buffer_load_dwordx4 v40, s[84:87], s24 offen lds
 s_add_u32 m0, s93, 91136
 s_mov_b32 s24, 0x2c8000
 buffer_load_dwordx4 v40, s[84:87], s24 offen lds
 ds_read_b64_tr_b16 v[176:177], v29 offset:32768
 ds_read_b64_tr_b16 v[178:179], v29 offset:33792
 ds_read_b64_tr_b16 v[240:241], v29 offset:32800
 ds_read_b64_tr_b16 v[242:243], v29 offset:33824
 s_waitcnt lgkmcnt(0)
 s_waitcnt vmcnt(28)
 s_barrier
 s_add_u32 m0, s93, 98304
 s_mov_b32 s24, 0x300000
 buffer_load_dwordx4 v40, s[84:87], s24 offen lds
 s_add_u32 m0, s93, 99328
 s_mov_b32 s24, 0x308000
 buffer_load_dwordx4 v40, s[84:87], s24 offen lds
 ds_read_b64_tr_b16 v[180:181], v29 offset:40960
 ds_read_b64_tr_b16 v[182:183], v29 offset:41984
 ds_read_b64_tr_b16 v[244:245], v29 offset:40992
 ds_read_b64_tr_b16 v[246:247], v29 offset:42016
 s_waitcnt lgkmcnt(0)
 s_waitcnt vmcnt(28)
 s_barrier
 s_add_u32 m0, s93, 106496
 s_mov_b32 s24, 0x340000
 buffer_load_dwordx4 v40, s[84:87], s24 offen lds
 s_add_u32 m0, s93, 107520
 s_mov_b32 s24, 0x348000
 buffer_load_dwordx4 v40, s[84:87], s24 offen lds
 ds_read_b64_tr_b16 v[184:185], v29 offset:49152
 ds_read_b64_tr_b16 v[186:187], v29 offset:50176
 ds_read_b64_tr_b16 v[248:249], v29 offset:49184
 ds_read_b64_tr_b16 v[250:251], v29 offset:50208
 s_waitcnt lgkmcnt(0)
 s_waitcnt vmcnt(28)
 s_barrier
 s_add_u32 m0, s93, 114688
 s_mov_b32 s24, 0x380000
 buffer_load_dwordx4 v40, s[84:87], s24 offen lds
 s_add_u32 m0, s93, 115712
 s_mov_b32 s24, 0x388000
 buffer_load_dwordx4 v40, s[84:87], s24 offen lds
 ds_read_b64_tr_b16 v[188:189], v29 offset:57344
 ds_read_b64_tr_b16 v[190:191], v29 offset:58368
 ds_read_b64_tr_b16 v[252:253], v29 offset:57376
 ds_read_b64_tr_b16 v[254:255], v29 offset:58400
 s_waitcnt lgkmcnt(0)
 s_waitcnt vmcnt(28)
 s_barrier
 s_add_u32 m0, s93, 122880
 s_mov_b32 s24, 0x3c0000
 buffer_load_dwordx4 v40, s[84:87], s24 offen lds
 s_add_u32 m0, s93, 123904
 s_mov_b32 s24, 0x3c8000
 buffer_load_dwordx4 v40, s[84:87], s24 offen lds
 ds_read_b64_tr_b16 a[0:1], v41 offset:0
 ds_read_b64_tr_b16 a[2:3], v41 offset:1024
 ds_read_b64_tr_b16 a[64:65], v41 offset:8
 ds_read_b64_tr_b16 a[66:67], v41 offset:1032
 s_waitcnt lgkmcnt(0)
 s_waitcnt vmcnt(28)
 s_barrier
 ds_read_b64_tr_b16 a[4:5], v41 offset:8192
 ds_read_b64_tr_b16 a[6:7], v41 offset:9216
 ds_read_b64_tr_b16 a[68:69], v41 offset:8200
 ds_read_b64_tr_b16 a[70:71], v41 offset:9224
 s_waitcnt lgkmcnt(0)
 s_waitcnt vmcnt(26)
 s_barrier
 ds_read_b64_tr_b16 a[8:9], v41 offset:16384
 ds_read_b64_tr_b16 a[10:11], v41 offset:17408
 ds_read_b64_tr_b16 a[72:73], v41 offset:16392
 ds_read_b64_tr_b16 a[74:75], v41 offset:17416
 s_waitcnt lgkmcnt(0)
 s_waitcnt vmcnt(24)
 s_barrier
 ds_read_b64_tr_b16 a[12:13], v41 offset:24576
 ds_read_b64_tr_b16 a[14:15], v41 offset:25600
 ds_read_b64_tr_b16 a[76:77], v41 offset:24584
 ds_read_b64_tr_b16 a[78:79], v41 offset:25608
 s_waitcnt lgkmcnt(0)
 s_waitcnt vmcnt(22)
 s_barrier
 ds_read_b64_tr_b16 a[16:17], v41 offset:32768
 ds_read_b64_tr_b16 a[18:19], v41 offset:33792
 ds_read_b64_tr_b16 a[80:81], v41 offset:32776
 ds_read_b64_tr_b16 a[82:83], v41 offset:33800
 s_waitcnt lgkmcnt(0)
 s_waitcnt vmcnt(20)
 s_barrier
 ds_read_b64_tr_b16 a[20:21], v41 offset:40960
 ds_read_b64_tr_b16 a[22:23], v41 offset:41984
 ds_read_b64_tr_b16 a[84:85], v41 offset:40968
 ds_read_b64_tr_b16 a[86:87], v41 offset:41992
 s_waitcnt lgkmcnt(0)
 s_waitcnt vmcnt(18)
 s_barrier
 ds_read_b64_tr_b16 a[24:25], v41 offset:49152
 ds_read_b64_tr_b16 a[26:27], v41 offset:50176
 ds_read_b64_tr_b16 a[88:89], v41 offset:49160
 ds_read_b64_tr_b16 a[90:91], v41 offset:50184
 s_waitcnt lgkmcnt(0)
 s_waitcnt vmcnt(16)
 s_barrier
 ds_read_b64_tr_b16 a[28:29], v41 offset:57344
 ds_read_b64_tr_b16 a[30:31], v41 offset:58368
 ds_read_b64_tr_b16 a[92:93], v41 offset:57352
 ds_read_b64_tr_b16 a[94:95], v41 offset:58376
 s_waitcnt lgkmcnt(0)
 s_waitcnt vmcnt(14)
 s_barrier
 ds_read_b64_tr_b16 a[32:33], v42 offset:0
 ds_read_b64_tr_b16 a[34:35], v42 offset:1024
 ds_read_b64_tr_b16 a[96:97], v42 offset:8
 ds_read_b64_tr_b16 a[98:99], v42 offset:1032
 s_waitcnt lgkmcnt(0)
 s_waitcnt vmcnt(12)
 s_barrier
 ds_read_b64_tr_b16 a[36:37], v42 offset:8192
 ds_read_b64_tr_b16 a[38:39], v42 offset:9216
 ds_read_b64_tr_b16 a[100:101], v42 offset:8200
 ds_read_b64_tr_b16 a[102:103], v42 offset:9224
 s_waitcnt lgkmcnt(0)
 s_waitcnt vmcnt(10)
 s_barrier
 ds_read_b64_tr_b16 a[40:41], v42 offset:16384
 ds_read_b64_tr_b16 a[42:43], v42 offset:17408
 ds_read_b64_tr_b16 a[104:105], v42 offset:16392
 ds_read_b64_tr_b16 a[106:107], v42 offset:17416
 s_waitcnt lgkmcnt(0)
 s_waitcnt vmcnt(8)
 s_barrier
 ds_read_b64_tr_b16 a[44:45], v42 offset:24576
 ds_read_b64_tr_b16 a[46:47], v42 offset:25600
 ds_read_b64_tr_b16 a[108:109], v42 offset:24584
 ds_read_b64_tr_b16 a[110:111], v42 offset:25608
 s_waitcnt lgkmcnt(0)
 s_waitcnt vmcnt(6)
 s_barrier
 ds_read_b64_tr_b16 a[48:49], v42 offset:32768
 ds_read_b64_tr_b16 a[50:51], v42 offset:33792
 ds_read_b64_tr_b16 a[112:113], v42 offset:32776
 ds_read_b64_tr_b16 a[114:115], v42 offset:33800
 s_waitcnt lgkmcnt(0)
 s_waitcnt vmcnt(4)
 s_barrier
 ds_read_b64_tr_b16 a[52:53], v42 offset:40960
 ds_read_b64_tr_b16 a[54:55], v42 offset:41984
 ds_read_b64_tr_b16 a[116:117], v42 offset:40968
 ds_read_b64_tr_b16 a[118:119], v42 offset:41992
 s_waitcnt lgkmcnt(0)
 s_waitcnt vmcnt(2)
 s_barrier
 ds_read_b64_tr_b16 a[56:57], v42 offset:49152
 ds_read_b64_tr_b16 a[58:59], v42 offset:50176
 ds_read_b64_tr_b16 a[120:121], v42 offset:49160
 ds_read_b64_tr_b16 a[122:123], v42 offset:50184
 s_waitcnt lgkmcnt(0)
 s_waitcnt vmcnt(0)
 s_barrier
 ds_read_b64_tr_b16 a[60:61], v42 offset:57344
 ds_read_b64_tr_b16 a[62:63], v42 offset:58368
 ds_read_b64_tr_b16 a[124:125], v42 offset:57352
 ds_read_b64_tr_b16 a[126:127], v42 offset:58376
 s_waitcnt lgkmcnt(0)
 v_mov_b32 v14, v27
 v_mov_b32 v15, v30
 s_mov_b32 s47, s26
 s_cmp_eq_u32 s17, 0
 s_cbranch_scc0 L_winit_31_ok
 s_mov_b32 s23, 0
L_winit_31:
 buffer_load_dword v24, off, s[12:15], 0 offset:192 sc1
 s_add_u32 s23, s23, 1
 s_cmp_gt_u32 s23, 262144
 s_cbranch_scc1 L_bail
 s_waitcnt vmcnt(0)
 v_cmp_le_u32 vcc, 48, v24
 s_cbranch_vccnz L_winit_31_ok
 s_sleep 4
 s_branch L_winit_31
L_winit_31_ok:
 s_barrier
 s_lshl_b32 s38, s17, 12
 s_mov_b32 s18, s20
 s_mov_b32 s36, s20
 s_lshl_b32 s37, s36, 15
 s_lshl_b32 s24, s17, 8
 s_add_u32 s37, s37, s24
 s_add_u32 s37, s37, 0x200000
 s_lshl_b32 s24, s36, 5
 s_add_u32 s24, s24, s19
 s_lshl_b32 s41, s24, 2
 s_mul_i32 s40, s19, 65
 s_add_u32 s40, s40, s36
 s_lshl_b32 s40, s40, 14
 s_add_u32 s40, s40, 0x1c00000
 s_mul_i32 s42, s19, 129
 s_add_u32 s42, s42, s36
 s_lshl_b32 s42, s42, 12
 s_add_u32 s42, s42, 0x801000
 s_add_u32 s41, s41, 0x110000
 s_lshl_b32 s43, s36, 7
 s_add_u32 s43, s43, 0x114000
 s_mov_b32 s23, 0
L_wline_32:
 buffer_load_dword v9, v7, s[4:7], s43 offen sc1
 s_add_u32 s23, s23, 1
 s_cmp_gt_u32 s23, 262144
 s_cbranch_scc1 L_bail
 s_waitcnt vmcnt(0)
 v_cmp_gt_u32 vcc, 1, v9
 s_cbranch_vccz L_wline_32_ok
 s_sleep 2
 s_branch L_wline_32
L_wline_32_ok:
 s_barrier
 s_add_u32 m0, s38, 0
 s_add_u32 s24, s37, 0
 buffer_load_dwordx4 v2, s[4:7], s24 offen sc1 lds
 s_add_u32 m0, s38, 1024
 s_add_u32 s24, s37, 0
 buffer_load_dwordx4 v8, s[4:7], s24 offen sc1 lds
 s_add_u32 m0, s38, 2048
 s_add_u32 s24, s37, 128
 buffer_load_dwordx4 v2, s[4:7], s24 offen sc1 lds
 s_add_u32 m0, s38, 3072
 s_add_u32 s24, s37, 128
 buffer_load_dwordx4 v8, s[4:7], s24 offen sc1 lds
 s_add_u32 m0, s38, 16384
 s_add_u32 s24, s37, 16384
 buffer_load_dwordx4 v2, s[4:7], s24 offen sc1 lds
 s_add_u32 m0, s38, 17408
 s_add_u32 s24, s37, 16384
 buffer_load_dwordx4 v8, s[4:7], s24 offen sc1 lds
 s_add_u32 m0, s38, 18432
 s_add_u32 s24, s37, 16512
 buffer_load_dwordx4 v2, s[4:7], s24 offen sc1 lds
 s_add_u32 m0, s38, 19456
 s_add_u32 s24, s37, 16512
 buffer_load_dwordx4 v8, s[4:7], s24 offen sc1 lds
 s_waitcnt vmcnt(0)
 s_barrier
 v_xor_b32 v11, 64, v0
 ds_read_b128 v[112:115], v0 offset:0
 ds_read_b128 v[116:119], v0 offset:16384
 ds_read_b128 v[120:123], v11 offset:0
 ds_read_b128 v[124:127], v11 offset:16384
 v_mov_b32 v16, s39
 v_mov_b32 v17, s39
 v_mov_b32 v18, s39
 v_mov_b32 v19, s39
 s_lshl_b32 s24, s17, 10
 s_add_u32 s24, s24, s42
 buffer_store_dwordx4 v[16:19], v1, s[4:7], s24 offen sc1
 s_waitcnt lgkmcnt(2)
 v_mfma_f32_16x16x32_bf16 v[64:67], a[128:131], v[112:115], 0
 v_mfma_f32_16x16x32_bf16 v[68:71], a[192:195], v[112:115], 0
 v_mfma_f32_16x16x32_bf16 v[96:99], a[0:3], v[112:115], 0
 v_mfma_f32_16x16x32_bf16 v[100:103], a[64:67], v[112:115], 0
 v_mfma_f32_16x16x32_bf16 v[80:83], v[112:115], v[128:131], 0
 v_mfma_f32_16x16x32_bf16 v[88:91], v[112:115], v[192:195], 0
 ds_read_b128 v[112:115], v0 offset:2048
 v_mfma_f32_16x16x32_bf16 v[72:75], a[128:131], v[116:119], 0
 v_mfma_f32_16x16x32_bf16 v[76:79], a[192:195], v[116:119], 0
 v_mfma_f32_16x16x32_bf16 v[104:107], a[0:3], v[116:119], 0
 v_mfma_f32_16x16x32_bf16 v[108:111], a[64:67], v[116:119], 0
 v_mfma_f32_16x16x32_bf16 v[84:87], v[116:119], v[128:131], 0
 v_mfma_f32_16x16x32_bf16 v[92:95], v[116:119], v[192:195], 0
 ds_read_b128 v[116:119], v0 offset:18432
 s_waitcnt lgkmcnt(2)
 v_mfma_f32_16x16x32_bf16 v[64:67], a[132:135], v[120:123], v[64:67]
 v_mfma_f32_16x16x32_bf16 v[68:71], a[196:199], v[120:123], v[68:71]
 v_mfma_f32_16x16x32_bf16 v[96:99], a[4:7], v[120:123], v[96:99]
 v_mfma_f32_16x16x32_bf16 v[100:103], a[68:71], v[120:123], v[100:103]
 v_mfma_f32_16x16x32_bf16 v[80:83], v[120:123], v[132:135], v[80:83]
 v_mfma_f32_16x16x32_bf16 v[88:91], v[120:123], v[196:199], v[88:91]
 ds_read_b128 v[120:123], v11 offset:2048
 v_mfma_f32_16x16x32_bf16 v[72:75], a[132:135], v[124:127], v[72:75]
 v_mfma_f32_16x16x32_bf16 v[76:79], a[196:199], v[124:127], v[76:79]
 v_mfma_f32_16x16x32_bf16 v[104:107], a[4:7], v[124:127], v[104:107]
 v_mfma_f32_16x16x32_bf16 v[108:111], a[68:71], v[124:127], v[108:111]
 v_mfma_f32_16x16x32_bf16 v[84:87], v[124:127], v[132:135], v[84:87]
 v_mfma_f32_16x16x32_bf16 v[92:95], v[124:127], v[196:199], v[92:95]
 ds_read_b128 v[124:127], v11 offset:18432
 s_waitcnt lgkmcnt(2)
 v_mfma_f32_16x16x32_bf16 v[64:67], a[136:139], v[112:115], v[64:67]
 v_mfma_f32_16x16x32_bf16 v[68:71], a[200:203], v[112:115], v[68:71]
 v_mfma_f32_16x16x32_bf16 v[96:99], a[8:11], v[112:115], v[96:99]
 v_mfma_f32_16x16x32_bf16 v[100:103], a[72:75], v[112:115], v[100:103]
 v_mfma_f32_16x16x32_bf16 v[80:83], v[112:115], v[136:139], v[80:83]
 v_mfma_f32_16x16x32_bf16 v[88:91], v[112:115], v[200:203], v[88:91]
 ds_read_b128 v[112:115], v0 offset:4096
 v_mfma_f32_16x16x32_bf16 v[72:75], a[136:139], v[116:119], v[72:75]
 v_mfma_f32_16x16x32_bf16 v[76:79], a[200:203], v[116:119], v[76:79]
 v_mfma_f32_16x16x32_bf16 v[104:107], a[8:11], v[116:119], v[104:107]
 v_mfma_f32_16x16x32_bf16 v[108:111], a[72:75], v[116:119], v[108:111]
 v_mfma_f32_16x16x32_bf16 v[84:87], v[116:119], v[136:139], v[84:87]
 v_mfma_f32_16x16x32_bf16 v[92:95], v[116:119], v[200:203], v[92:95]
 ds_read_b128 v[116:119], v0 offset:20480
 s_waitcnt lgkmcnt(2)
 v_mfma_f32_16x16x32_bf16 v[64:67], a[140:143], v[120:123], v[64:67]
 v_mfma_f32_16x16x32_bf16 v[68:71], a[204:207], v[120:123], v[68:71]
 v_mfma_f32_16x16x32_bf16 v[96:99], a[12:15], v[120:123], v[96:99]
 v_mfma_f32_16x16x32_bf16 v[100:103], a[76:79], v[120:123], v[100:103]
 v_mfma_f32_16x16x32_bf16 v[80:83], v[120:123], v[140:143], v[80:83]
 v_mfma_f32_16x16x32_bf16 v[88:91], v[120:123], v[204:207], v[88:91]
 ds_read_b128 v[120:123], v11 offset:4096
 v_mfma_f32_16x16x32_bf16 v[72:75], a[140:143], v[124:127], v[72:75]
 v_mfma_f32_16x16x32_bf16 v[76:79], a[204:207], v[124:127], v[76:79]
 v_mfma_f32_16x16x32_bf16 v[104:107], a[12:15], v[124:127], v[104:107]
 v_mfma_f32_16x16x32_bf16 v[108:111], a[76:79], v[124:127], v[108:111]
 v_mfma_f32_16x16x32_bf16 v[84:87], v[124:127], v[140:143], v[84:87]
 v_mfma_f32_16x16x32_bf16 v[92:95], v[124:127], v[204:207], v[92:95]
 ds_read_b128 v[124:127], v11 offset:20480
 s_waitcnt lgkmcnt(2)
 v_mfma_f32_16x16x32_bf16 v[64:67], a[144:147], v[112:115], v[64:67]
 v_mfma_f32_16x16x32_bf16 v[68:71], a[208:211], v[112:115], v[68:71]
 v_mfma_f32_16x16x32_bf16 v[96:99], a[16:19], v[112:115], v[96:99]
 v_mfma_f32_16x16x32_bf16 v[100:103], a[80:83], v[112:115], v[100:103]
 v_mfma_f32_16x16x32_bf16 v[80:83], v[112:115], v[144:147], v[80:83]
 v_mfma_f32_16x16x32_bf16 v[88:91], v[112:115], v[208:211], v[88:91]
 ds_read_b128 v[112:115], v0 offset:6144
 v_mfma_f32_16x16x32_bf16 v[72:75], a[144:147], v[116:119], v[72:75]
 v_mfma_f32_16x16x32_bf16 v[76:79], a[208:211], v[116:119], v[76:79]
 v_mfma_f32_16x16x32_bf16 v[104:107], a[16:19], v[116:119], v[104:107]
 v_mfma_f32_16x16x32_bf16 v[108:111], a[80:83], v[116:119], v[108:111]
 v_mfma_f32_16x16x32_bf16 v[84:87], v[116:119], v[144:147], v[84:87]
 v_mfma_f32_16x16x32_bf16 v[92:95], v[116:119], v[208:211], v[92:95]
 ds_read_b128 v[116:119], v0 offset:22528
 s_waitcnt lgkmcnt(2)
 v_mfma_f32_16x16x32_bf16 v[64:67], a[148:151], v[120:123], v[64:67]
 v_mfma_f32_16x16x32_bf16 v[68:71], a[212:215], v[120:123], v[68:71]
 v_mfma_f32_16x16x32_bf16 v[96:99], a[20:23], v[120:123], v[96:99]
 v_mfma_f32_16x16x32_bf16 v[100:103], a[84:87], v[120:123], v[100:103]
 v_mfma_f32_16x16x32_bf16 v[80:83], v[120:123], v[148:151], v[80:83]
 v_mfma_f32_16x16x32_bf16 v[88:91], v[120:123], v[212:215], v[88:91]
 ds_read_b128 v[120:123], v11 offset:6144
 v_mfma_f32_16x16x32_bf16 v[72:75], a[148:151], v[124:127], v[72:75]
 v_mfma_f32_16x16x32_bf16 v[76:79], a[212:215], v[124:127], v[76:79]
 v_mfma_f32_16x16x32_bf16 v[104:107], a[20:23], v[124:127], v[104:107]
 v_mfma_f32_16x16x32_bf16 v[108:111], a[84:87], v[124:127], v[108:111]
 v_mfma_f32_16x16x32_bf16 v[84:87], v[124:127], v[148:151], v[84:87]
 v_mfma_f32_16x16x32_bf16 v[92:95], v[124:127], v[212:215], v[92:95]
 ds_read_b128 v[124:127], v11 offset:22528
 s_waitcnt lgkmcnt(2)
 v_mfma_f32_16x16x32_bf16 v[64:67], a[152:155], v[112:115], v[64:67]
 v_mfma_f32_16x16x32_bf16 v[68:71], a[216:219], v[112:115], v[68:71]
 v_mfma_f32_16x16x32_bf16 v[96:99], a[24:27], v[112:115], v[96:99]
 v_mfma_f32_16x16x32_bf16 v[100:103], a[88:91], v[112:115], v[100:103]
 v_mfma_f32_16x16x32_bf16 v[80:83], v[112:115], v[152:155], v[80:83]
 v_mfma_f32_16x16x32_bf16 v[88:91], v[112:115], v[216:219], v[88:91]
 ds_read_b128 v[112:115], v0 offset:8192
 v_mfma_f32_16x16x32_bf16 v[72:75], a[152:155], v[116:119], v[72:75]
 v_mfma_f32_16x16x32_bf16 v[76:79], a[216:219], v[116:119], v[76:79]
 v_mfma_f32_16x16x32_bf16 v[104:107], a[24:27], v[116:119], v[104:107]
 v_mfma_f32_16x16x32_bf16 v[108:111], a[88:91], v[116:119], v[108:111]
 v_mfma_f32_16x16x32_bf16 v[84:87], v[116:119], v[152:155], v[84:87]
 v_mfma_f32_16x16x32_bf16 v[92:95], v[116:119], v[216:219], v[92:95]
 ds_read_b128 v[116:119], v0 offset:24576
 s_waitcnt lgkmcnt(2)
 v_mfma_f32_16x16x32_bf16 v[64:67], a[156:159], v[120:123], v[64:67]
 v_mfma_f32_16x16x32_bf16 v[68:71], a[220:223], v[120:123], v[68:71]
 v_mfma_f32_16x16x32_bf16 v[96:99], a[28:31], v[120:123], v[96:99]
 v_mfma_f32_16x16x32_bf16 v[100:103], a[92:95], v[120:123], v[100:103]
 v_mfma_f32_16x16x32_bf16 v[80:83], v[120:123], v[156:159], v[80:83]
 v_mfma_f32_16x16x32_bf16 v[88:91], v[120:123], v[220:223], v[88:91]
 ds_read_b128 v[120:123], v11 offset:8192
 v_mfma_f32_16x16x32_bf16 v[72:75], a[156:159], v[124:127], v[72:75]
 v_mfma_f32_16x16x32_bf16 v[76:79], a[220:223], v[124:127], v[76:79]
 v_mfma_f32_16x16x32_bf16 v[104:107], a[28:31], v[124:127], v[104:107]
 v_mfma_f32_16x16x32_bf16 v[108:111], a[92:95], v[124:127], v[108:111]
 v_mfma_f32_16x16x32_bf16 v[84:87], v[124:127], v[156:159], v[84:87]
 v_mfma_f32_16x16x32_bf16 v[92:95], v[124:127], v[220:223], v[92:95]
 ds_read_b128 v[124:127], v11 offset:24576
 s_waitcnt lgkmcnt(2)
 v_mfma_f32_16x16x32_bf16 v[64:67], a[160:163], v[112:115], v[64:67]
 v_mfma_f32_16x16x32_bf16 v[68:71], a[224:227], v[112:115], v[68:71]
 v_mfma_f32_16x16x32_bf16 v[96:99], a[32:35], v[112:115], v[96:99]
 v_mfma_f32_16x16x32_bf16 v[100:103], a[96:99], v[112:115], v[100:103]
 v_mfma_f32_16x16x32_bf16 v[80:83], v[112:115], v[160:163], v[80:83]
 v_mfma_f32_16x16x32_bf16 v[88:91], v[112:115], v[224:227], v[88:91]
 ds_read_b128 v[112:115], v0 offset:10240
 v_mfma_f32_16x16x32_bf16 v[72:75], a[160:163], v[116:119], v[72:75]
 v_mfma_f32_16x16x32_bf16 v[76:79], a[224:227], v[116:119], v[76:79]
 v_mfma_f32_16x16x32_bf16 v[104:107], a[32:35], v[116:119], v[104:107]
 v_mfma_f32_16x16x32_bf16 v[108:111], a[96:99], v[116:119], v[108:111]
 v_mfma_f32_16x16x32_bf16 v[84:87], v[116:119], v[160:163], v[84:87]
 v_mfma_f32_16x16x32_bf16 v[92:95], v[116:119], v[224:227], v[92:95]
 ds_read_b128 v[116:119], v0 offset:26624
 s_waitcnt lgkmcnt(2)
 v_mfma_f32_16x16x32_bf16 v[64:67], a[164:167], v[120:123], v[64:67]
 v_mfma_f32_16x16x32_bf16 v[68:71], a[228:231], v[120:123], v[68:71]
 v_mfma_f32_16x16x32_bf16 v[96:99], a[36:39], v[120:123], v[96:99]
 v_mfma_f32_16x16x32_bf16 v[100:103], a[100:103], v[120:123], v[100:103]
 v_mfma_f32_16x16x32_bf16 v[80:83], v[120:123], v[164:167], v[80:83]
 v_mfma_f32_16x16x32_bf16 v[88:91], v[120:123], v[228:231], v[88:91]
 ds_read_b128 v[120:123], v11 offset:10240
 v_mfma_f32_16x16x32_bf16 v[72:75], a[164:167], v[124:127], v[72:75]
 v_mfma_f32_16x16x32_bf16 v[76:79], a[228:231], v[124:127], v[76:79]
 v_mfma_f32_16x16x32_bf16 v[104:107], a[36:39], v[124:127], v[104:107]
 v_mfma_f32_16x16x32_bf16 v[108:111], a[100:103], v[124:127], v[108:111]
 v_mfma_f32_16x16x32_bf16 v[84:87], v[124:127], v[164:167], v[84:87]
 v_mfma_f32_16x16x32_bf16 v[92:95], v[124:127], v[228:231], v[92:95]
 ds_read_b128 v[124:127], v11 offset:26624
 s_waitcnt lgkmcnt(2)
 v_mfma_f32_16x16x32_bf16 v[64:67], a[168:171], v[112:115], v[64:67]
 v_mfma_f32_16x16x32_bf16 v[68:71], a[232:235], v[112:115], v[68:71]
 v_mfma_f32_16x16x32_bf16 v[96:99], a[40:43], v[112:115], v[96:99]
 v_mfma_f32_16x16x32_bf16 v[100:103], a[104:107], v[112:115], v[100:103]
 v_mfma_f32_16x16x32_bf16 v[80:83], v[112:115], v[168:171], v[80:83]
 v_mfma_f32_16x16x32_bf16 v[88:91], v[112:115], v[232:235], v[88:91]
 ds_read_b128 v[112:115], v0 offset:12288
 v_mfma_f32_16x16x32_bf16 v[72:75], a[168:171], v[116:119], v[72:75]
 v_mfma_f32_16x16x32_bf16 v[76:79], a[232:235], v[116:119], v[76:79]
 v_mfma_f32_16x16x32_bf16 v[104:107], a[40:43], v[116:119], v[104:107]
 v_mfma_f32_16x16x32_bf16 v[108:111], a[104:107], v[116:119], v[108:111]
 v_mfma_f32_16x16x32_bf16 v[84:87], v[116:119], v[168:171], v[84:87]
 v_mfma_f32_16x16x32_bf16 v[92:95], v[116:119], v[232:235], v[92:95]
 ds_read_b128 v[116:119], v0 offset:28672
 s_waitcnt lgkmcnt(2)
 v_mfma_f32_16x16x32_bf16 v[64:67], a[172:175], v[120:123], v[64:67]
 v_mfma_f32_16x16x32_bf16 v[68:71], a[236:239], v[120:123], v[68:71]
 v_mfma_f32_16x16x32_bf16 v[96:99], a[44:47], v[120:123], v[96:99]
 v_mfma_f32_16x16x32_bf16 v[100:103], a[108:111], v[120:123], v[100:103]
 v_mfma_f32_16x16x32_bf16 v[80:83], v[120:123], v[172:175], v[80:83]
 v_mfma_f32_16x16x32_bf16 v[88:91], v[120:123], v[236:239], v[88:91]
 ds_read_b128 v[120:123], v11 offset:12288
 v_mfma_f32_16x16x32_bf16 v[72:75], a[172:175], v[124:127], v[72:75]
 v_mfma_f32_16x16x32_bf16 v[76:79], a[236:239], v[124:127], v[76:79]
 v_mfma_f32_16x16x32_bf16 v[104:107], a[44:47], v[124:127], v[104:107]
 v_mfma_f32_16x16x32_bf16 v[108:111], a[108:111], v[124:127], v[108:111]
 v_mfma_f32_16x16x32_bf16 v[84:87], v[124:127], v[172:175], v[84:87]
 v_mfma_f32_16x16x32_bf16 v[92:95], v[124:127], v[236:239], v[92:95]
 ds_read_b128 v[124:127], v11 offset:28672
 s_waitcnt lgkmcnt(2)
 v_mfma_f32_16x16x32_bf16 v[64:67], a[176:179], v[112:115], v[64:67]
 v_mfma_f32_16x16x32_bf16 v[68:71], a[240:243], v[112:115], v[68:71]
 v_mfma_f32_16x16x32_bf16 v[96:99], a[48:51], v[112:115], v[96:99]
 v_mfma_f32_16x16x32_bf16 v[100:103], a[112:115], v[112:115], v[100:103]
 v_mfma_f32_16x16x32_bf16 v[80:83], v[112:115], v[176:179], v[80:83]
 v_mfma_f32_16x16x32_bf16 v[88:91], v[112:115], v[240:243], v[88:91]
 ds_read_b128 v[112:115], v0 offset:14336
 v_mfma_f32_16x16x32_bf16 v[72:75], a[176:179], v[116:119], v[72:75]
 v_mfma_f32_16x16x32_bf16 v[76:79], a[240:243], v[116:119], v[76:79]
 v_mfma_f32_16x16x32_bf16 v[104:107], a[48:51], v[116:119], v[104:107]
 v_mfma_f32_16x16x32_bf16 v[108:111], a[112:115], v[116:119], v[108:111]
 v_mfma_f32_16x16x32_bf16 v[84:87], v[116:119], v[176:179], v[84:87]
 v_mfma_f32_16x16x32_bf16 v[92:95], v[116:119], v[240:243], v[92:95]
 ds_read_b128 v[116:119], v0 offset:30720
 s_waitcnt lgkmcnt(2)
 v_mfma_f32_16x16x32_bf16 v[64:67], a[180:183], v[120:123], v[64:67]
 v_mfma_f32_16x16x32_bf16 v[68:71], a[244:247], v[120:123], v[68:71]
 v_mfma_f32_16x16x32_bf16 v[96:99], a[52:55], v[120:123], v[96:99]
 v_mfma_f32_16x16x32_bf16 v[100:103], a[116:119], v[120:123], v[100:103]
 v_mfma_f32_16x16x32_bf16 v[80:83], v[120:123], v[180:183], v[80:83]
 v_mfma_f32_16x16x32_bf16 v[88:91], v[120:123], v[244:247], v[88:91]
 ds_read_b128 v[120:123], v11 offset:14336
 v_mfma_f32_16x16x32_bf16 v[72:75], a[180:183], v[124:127], v[72:75]
 v_mfma_f32_16x16x32_bf16 v[76:79], a[244:247], v[124:127], v[76:79]
 v_mfma_f32_16x16x32_bf16 v[104:107], a[52:55], v[124:127], v[104:107]
 v_mfma_f32_16x16x32_bf16 v[108:111], a[116:119], v[124:127], v[108:111]
 v_mfma_f32_16x16x32_bf16 v[84:87], v[124:127], v[180:183], v[84:87]
 v_mfma_f32_16x16x32_bf16 v[92:95], v[124:127], v[244:247], v[92:95]
 ds_read_b128 v[124:127], v11 offset:30720
 s_waitcnt lgkmcnt(2)
 v_mfma_f32_16x16x32_bf16 v[64:67], a[184:187], v[112:115], v[64:67]
 v_mfma_f32_16x16x32_bf16 v[68:71], a[248:251], v[112:115], v[68:71]
 v_mfma_f32_16x16x32_bf16 v[96:99], a[56:59], v[112:115], v[96:99]
 v_mfma_f32_16x16x32_bf16 v[100:103], a[120:123], v[112:115], v[100:103]
 v_mfma_f32_16x16x32_bf16 v[80:83], v[112:115], v[184:187], v[80:83]
 v_mfma_f32_16x16x32_bf16 v[88:91], v[112:115], v[248:251], v[88:91]
 v_mfma_f32_16x16x32_bf16 v[72:75], a[184:187], v[116:119], v[72:75]
 v_mfma_f32_16x16x32_bf16 v[76:79], a[248:251], v[116:119], v[76:79]
 v_mfma_f32_16x16x32_bf16 v[104:107], a[56:59], v[116:119], v[104:107]
 v_mfma_f32_16x16x32_bf16 v[108:111], a[120:123], v[116:119], v[108:111]
 v_mfma_f32_16x16x32_bf16 v[84:87], v[116:119], v[184:187], v[84:87]
 v_mfma_f32_16x16x32_bf16 v[92:95], v[116:119], v[248:251], v[92:95]
 s_waitcnt lgkmcnt(0)
 v_mfma_f32_16x16x32_bf16 v[64:67], a[188:191], v[120:123], v[64:67]
 v_mfma_f32_16x16x32_bf16 v[68:71], a[252:255], v[120:123], v[68:71]
 v_mfma_f32_16x16x32_bf16 v[96:99], a[60:63], v[120:123], v[96:99]
 v_mfma_f32_16x16x32_bf16 v[100:103], a[124:127], v[120:123], v[100:103]
 v_mfma_f32_16x16x32_bf16 v[80:83], v[120:123], v[188:191], v[80:83]
 v_mfma_f32_16x16x32_bf16 v[88:91], v[120:123], v[252:255], v[88:91]
 v_mfma_f32_16x16x32_bf16 v[72:75], a[188:191], v[124:127], v[72:75]
 v_mfma_f32_16x16x32_bf16 v[76:79], a[252:255], v[124:127], v[76:79]
 v_mfma_f32_16x16x32_bf16 v[104:107], a[60:63], v[124:127], v[104:107]
 v_mfma_f32_16x16x32_bf16 v[108:111], a[124:127], v[124:127], v[108:111]
 v_mfma_f32_16x16x32_bf16 v[84:87], v[124:127], v[188:191], v[84:87]
 v_mfma_f32_16x16x32_bf16 v[92:95], v[124:127], v[252:255], v[92:95]
 s_lshl_b32 s24, s17, 10
 s_add_u32 s24, s24, s40
 s_add_u32 s25, s24, 4096
 s_lshl_b32 s26, s17, 11
 s_add_u32 s26, s26, s40
 s_add_u32 s26, s26, 8192
 s_nop 1
 v_cvt_pk_bf16_f32 v16, v64, v65
 v_cvt_pk_bf16_f32 v17, v66, v67
 v_cvt_pk_bf16_f32 v18, v68, v69
 v_cvt_pk_bf16_f32 v19, v70, v71
 buffer_store_dwordx4 v[16:19], v1, s[4:7], s24 offen offset:0 sc1
 v_cvt_pk_bf16_f32 v32, v96, v97
 v_cvt_pk_bf16_f32 v33, v98, v99
 v_cvt_pk_bf16_f32 v34, v100, v101
 v_cvt_pk_bf16_f32 v35, v102, v103
 v_cvt_pk_bf16_f32 v20, v72, v73
 v_cvt_pk_bf16_f32 v21, v74, v75
 v_cvt_pk_bf16_f32 v22, v76, v77
 v_cvt_pk_bf16_f32 v23, v78, v79
 buffer_store_dwordx4 v[20:23], v1, s[4:7], s25 offen offset:0 sc1
 v_cvt_pk_bf16_f32 v36, v104, v105
 v_cvt_pk_bf16_f32 v37, v106, v107
 v_cvt_pk_bf16_f32 v38, v108, v109
 v_cvt_pk_bf16_f32 v39, v110, v111
 v_cvt_pk_bf16_f32 v24, v80, v81
 v_cvt_pk_bf16_f32 v25, v82, v83
 v_cvt_pk_bf16_f32 v26, v84, v85
 v_cvt_pk_bf16_f32 v27, v86, v87
 buffer_store_dwordx4 v[24:27], v1, s[4:7], s26 offen offset:0 sc1
 v_cvt_pk_bf16_f32 v28, v88, v89
 v_cvt_pk_bf16_f32 v29, v90, v91
 v_cvt_pk_bf16_f32 v30, v92, v93
 v_cvt_pk_bf16_f32 v31, v94, v95
 buffer_store_dwordx4 v[28:31], v1, s[4:7], s26 offen offset:1024 sc1
 s_waitcnt vmcnt(0)
 s_barrier
 s_cmp_eq_u32 s17, 0
 s_cbranch_scc0 L_kvf_33
 s_mov_b64 exec, 1
 v_mov_b32 v10, 2
 buffer_store_dword v10, off, s[4:7], s41 sc1
 s_mov_b64 exec, -1
L_kvf_33:
 v_mov_b64 v[40:41], v[16:17]
 v_mov_b64 v[42:43], v[18:19]
 v_mov_b64 v[44:45], v[20:21]
 v_mov_b64 v[46:47], v[22:23]
 v_mov_b64 v[48:49], v[24:25]
 v_mov_b64 v[50:51], v[26:27]
 v_mov_b64 v[52:53], v[28:29]
 v_mov_b64 v[54:55], v[30:31]
 v_mov_b64 v[56:57], v[32:33]
 v_mov_b64 v[58:59], v[34:35]
 v_mov_b64 v[60:61], v[36:37]
 v_mov_b64 v[62:63], v[38:39]
 s_add_u32 s36, s36, 4
 s_lshl_b32 s37, s36, 15
 s_lshl_b32 s24, s17, 8
 s_add_u32 s37, s37, s24
 s_add_u32 s37, s37, 0x200000
 s_lshl_b32 s24, s36, 5
 s_add_u32 s24, s24, s19
 s_lshl_b32 s41, s24, 2
 s_mul_i32 s40, s19, 65
 s_add_u32 s40, s40, s36
 s_lshl_b32 s40, s40, 14
 s_add_u32 s40, s40, 0x1c00000
 s_mul_i32 s42, s19, 129
 s_add_u32 s42, s42, s36
 s_lshl_b32 s42, s42, 12
 s_add_u32 s42, s42, 0x801000
 s_add_u32 s41, s41, 0x110000
 s_lshl_b32 s43, s36, 7
 s_add_u32 s43, s43, 0x114000
 s_mov_b32 s23, 0
L_wline_34:
 buffer_load_dword v9, v7, s[4:7], s43 offen sc1
 s_add_u32 s23, s23, 1
 s_cmp_gt_u32 s23, 262144
 s_cbranch_scc1 L_bail
 s_waitcnt vmcnt(0)
 v_cmp_gt_u32 vcc, 1, v9
 s_cbranch_vccz L_wline_34_ok
 s_sleep 2
 s_branch L_wline_34
L_wline_34_ok:
 s_barrier
 s_add_u32 m0, s38, 0
 s_add_u32 s24, s37, 0
 buffer_load_dwordx4 v2, s[4:7], s24 offen sc1 lds
 s_add_u32 m0, s38, 1024
 s_add_u32 s24, s37, 0
 buffer_load_dwordx4 v8, s[4:7], s24 offen sc1 lds
 s_add_u32 m0, s38, 2048
 s_add_u32 s24, s37, 128
 buffer_load_dwordx4 v2, s[4:7], s24 offen sc1 lds
 s_add_u32 m0, s38, 3072
 s_add_u32 s24, s37, 128
 buffer_load_dwordx4 v8, s[4:7], s24 offen sc1 lds
 s_add_u32 m0, s38, 16384
 s_add_u32 s24, s37, 16384
 buffer_load_dwordx4 v2, s[4:7], s24 offen sc1 lds
 s_add_u32 m0, s38, 17408
 s_add_u32 s24, s37, 16384
 buffer_load_dwordx4 v8, s[4:7], s24 offen sc1 lds
 s_add_u32 m0, s38, 18432
 s_add_u32 s24, s37, 16512
 buffer_load_dwordx4 v2, s[4:7], s24 offen sc1 lds
 s_add_u32 m0, s38, 19456
 s_add_u32 s24, s37, 16512
 buffer_load_dwordx4 v8, s[4:7], s24 offen sc1 lds
 s_waitcnt vmcnt(0)
 s_barrier
 v_xor_b32 v11, 64, v0
 ds_read_b128 v[112:115], v0 offset:0
 ds_read_b128 v[116:119], v0 offset:16384
 ds_read_b128 v[120:123], v11 offset:0
 ds_read_b128 v[124:127], v11 offset:16384
 v_mov_b32 v16, s39
 v_mov_b32 v17, s39
 v_mov_b32 v18, s39
 v_mov_b32 v19, s39
 s_lshl_b32 s24, s17, 10
 s_add_u32 s24, s24, s42
 buffer_store_dwordx4 v[16:19], v1, s[4:7], s24 offen sc1
 s_waitcnt lgkmcnt(2)
 v_mfma_f32_16x16x32_bf16 v[64:67], a[128:131], v[112:115], 0
 v_mfma_f32_16x16x32_bf16 v[68:71], a[192:195], v[112:115], 0
 v_mfma_f32_16x16x32_bf16 v[96:99], a[0:3], v[112:115], 0
 v_mfma_f32_16x16x32_bf16 v[100:103], a[64:67], v[112:115], 0
 v_mfma_f32_16x16x32_bf16 v[80:83], v[112:115], v[128:131], 0
 v_mfma_f32_16x16x32_bf16 v[88:91], v[112:115], v[192:195], 0
 ds_read_b128 v[112:115], v0 offset:2048
 v_mfma_f32_16x16x32_bf16 v[72:75], a[128:131], v[116:119], 0
 v_mfma_f32_16x16x32_bf16 v[76:79], a[192:195], v[116:119], 0
 v_mfma_f32_16x16x32_bf16 v[104:107], a[0:3], v[116:119], 0
 v_mfma_f32_16x16x32_bf16 v[108:111], a[64:67], v[116:119], 0
 v_mfma_f32_16x16x32_bf16 v[84:87], v[116:119], v[128:131], 0
 v_mfma_f32_16x16x32_bf16 v[92:95], v[116:119], v[192:195], 0
 ds_read_b128 v[116:119], v0 offset:18432
 s_waitcnt lgkmcnt(2)
 v_mfma_f32_16x16x32_bf16 v[64:67], a[132:135], v[120:123], v[64:67]
 v_mfma_f32_16x16x32_bf16 v[68:71], a[196:199], v[120:123], v[68:71]
 v_mfma_f32_16x16x32_bf16 v[96:99], a[4:7], v[120:123], v[96:99]
 v_mfma_f32_16x16x32_bf16 v[100:103], a[68:71], v[120:123], v[100:103]
 v_mfma_f32_16x16x32_bf16 v[80:83], v[120:123], v[132:135], v[80:83]
 v_mfma_f32_16x16x32_bf16 v[88:91], v[120:123], v[196:199], v[88:91]
 ds_read_b128 v[120:123], v11 offset:2048
 v_mfma_f32_16x16x32_bf16 v[72:75], a[132:135], v[124:127], v[72:75]
 v_mfma_f32_16x16x32_bf16 v[76:79], a[196:199], v[124:127], v[76:79]
 v_mfma_f32_16x16x32_bf16 v[104:107], a[4:7], v[124:127], v[104:107]
 v_mfma_f32_16x16x32_bf16 v[108:111], a[68:71], v[124:127], v[108:111]
 v_mfma_f32_16x16x32_bf16 v[84:87], v[124:127], v[132:135], v[84:87]
 v_mfma_f32_16x16x32_bf16 v[92:95], v[124:127], v[196:199], v[92:95]
 ds_read_b128 v[124:127], v11 offset:18432
 s_waitcnt lgkmcnt(2)
 v_mfma_f32_16x16x32_bf16 v[64:67], a[136:139], v[112:115], v[64:67]
 v_mfma_f32_16x16x32_bf16 v[68:71], a[200:203], v[112:115], v[68:71]
 v_mfma_f32_16x16x32_bf16 v[96:99], a[8:11], v[112:115], v[96:99]
 v_mfma_f32_16x16x32_bf16 v[100:103], a[72:75], v[112:115], v[100:103]
 v_mfma_f32_16x16x32_bf16 v[80:83], v[112:115], v[136:139], v[80:83]
 v_mfma_f32_16x16x32_bf16 v[88:91], v[112:115], v[200:203], v[88:91]
 ds_read_b128 v[112:115], v0 offset:4096
 v_mfma_f32_16x16x32_bf16 v[72:75], a[136:139], v[116:119], v[72:75]
 v_mfma_f32_16x16x32_bf16 v[76:79], a[200:203], v[116:119], v[76:79]
 v_mfma_f32_16x16x32_bf16 v[104:107], a[8:11], v[116:119], v[104:107]
 v_mfma_f32_16x16x32_bf16 v[108:111], a[72:75], v[116:119], v[108:111]
 v_mfma_f32_16x16x32_bf16 v[84:87], v[116:119], v[136:139], v[84:87]
 v_mfma_f32_16x16x32_bf16 v[92:95], v[116:119], v[200:203], v[92:95]
 ds_read_b128 v[116:119], v0 offset:20480
 s_waitcnt lgkmcnt(2)
 v_mfma_f32_16x16x32_bf16 v[64:67], a[140:143], v[120:123], v[64:67]
 v_mfma_f32_16x16x32_bf16 v[68:71], a[204:207], v[120:123], v[68:71]
 v_mfma_f32_16x16x32_bf16 v[96:99], a[12:15], v[120:123], v[96:99]
 v_mfma_f32_16x16x32_bf16 v[100:103], a[76:79], v[120:123], v[100:103]
 v_mfma_f32_16x16x32_bf16 v[80:83], v[120:123], v[140:143], v[80:83]
 v_mfma_f32_16x16x32_bf16 v[88:91], v[120:123], v[204:207], v[88:91]
 ds_read_b128 v[120:123], v11 offset:4096
 v_mfma_f32_16x16x32_bf16 v[72:75], a[140:143], v[124:127], v[72:75]
 v_mfma_f32_16x16x32_bf16 v[76:79], a[204:207], v[124:127], v[76:79]
 v_mfma_f32_16x16x32_bf16 v[104:107], a[12:15], v[124:127], v[104:107]
 v_mfma_f32_16x16x32_bf16 v[108:111], a[76:79], v[124:127], v[108:111]
 v_mfma_f32_16x16x32_bf16 v[84:87], v[124:127], v[140:143], v[84:87]
 v_mfma_f32_16x16x32_bf16 v[92:95], v[124:127], v[204:207], v[92:95]
 ds_read_b128 v[124:127], v11 offset:20480
 s_waitcnt lgkmcnt(2)
 v_mfma_f32_16x16x32_bf16 v[64:67], a[144:147], v[112:115], v[64:67]
 v_mfma_f32_16x16x32_bf16 v[68:71], a[208:211], v[112:115], v[68:71]
 v_mfma_f32_16x16x32_bf16 v[96:99], a[16:19], v[112:115], v[96:99]
 v_mfma_f32_16x16x32_bf16 v[100:103], a[80:83], v[112:115], v[100:103]
 v_mfma_f32_16x16x32_bf16 v[80:83], v[112:115], v[144:147], v[80:83]
 v_mfma_f32_16x16x32_bf16 v[88:91], v[112:115], v[208:211], v[88:91]
 ds_read_b128 v[112:115], v0 offset:6144
 v_mfma_f32_16x16x32_bf16 v[72:75], a[144:147], v[116:119], v[72:75]
 v_mfma_f32_16x16x32_bf16 v[76:79], a[208:211], v[116:119], v[76:79]
 v_mfma_f32_16x16x32_bf16 v[104:107], a[16:19], v[116:119], v[104:107]
 v_mfma_f32_16x16x32_bf16 v[108:111], a[80:83], v[116:119], v[108:111]
 v_mfma_f32_16x16x32_bf16 v[84:87], v[116:119], v[144:147], v[84:87]
 v_mfma_f32_16x16x32_bf16 v[92:95], v[116:119], v[208:211], v[92:95]
 ds_read_b128 v[116:119], v0 offset:22528
 s_waitcnt lgkmcnt(2)
 v_mfma_f32_16x16x32_bf16 v[64:67], a[148:151], v[120:123], v[64:67]
 v_mfma_f32_16x16x32_bf16 v[68:71], a[212:215], v[120:123], v[68:71]
 v_mfma_f32_16x16x32_bf16 v[96:99], a[20:23], v[120:123], v[96:99]
 v_mfma_f32_16x16x32_bf16 v[100:103], a[84:87], v[120:123], v[100:103]
 v_mfma_f32_16x16x32_bf16 v[80:83], v[120:123], v[148:151], v[80:83]
 v_mfma_f32_16x16x32_bf16 v[88:91], v[120:123], v[212:215], v[88:91]
 ds_read_b128 v[120:123], v11 offset:6144
 v_mfma_f32_16x16x32_bf16 v[72:75], a[148:151], v[124:127], v[72:75]
 v_mfma_f32_16x16x32_bf16 v[76:79], a[212:215], v[124:127], v[76:79]
 v_mfma_f32_16x16x32_bf16 v[104:107], a[20:23], v[124:127], v[104:107]
 v_mfma_f32_16x16x32_bf16 v[108:111], a[84:87], v[124:127], v[108:111]
 v_mfma_f32_16x16x32_bf16 v[84:87], v[124:127], v[148:151], v[84:87]
 v_mfma_f32_16x16x32_bf16 v[92:95], v[124:127], v[212:215], v[92:95]
 ds_read_b128 v[124:127], v11 offset:22528
 s_waitcnt lgkmcnt(2)
 v_mfma_f32_16x16x32_bf16 v[64:67], a[152:155], v[112:115], v[64:67]
 v_mfma_f32_16x16x32_bf16 v[68:71], a[216:219], v[112:115], v[68:71]
 v_mfma_f32_16x16x32_bf16 v[96:99], a[24:27], v[112:115], v[96:99]
 v_mfma_f32_16x16x32_bf16 v[100:103], a[88:91], v[112:115], v[100:103]
 v_mfma_f32_16x16x32_bf16 v[80:83], v[112:115], v[152:155], v[80:83]
 v_mfma_f32_16x16x32_bf16 v[88:91], v[112:115], v[216:219], v[88:91]
 ds_read_b128 v[112:115], v0 offset:8192
 v_mfma_f32_16x16x32_bf16 v[72:75], a[152:155], v[116:119], v[72:75]
 v_mfma_f32_16x16x32_bf16 v[76:79], a[216:219], v[116:119], v[76:79]
 v_mfma_f32_16x16x32_bf16 v[104:107], a[24:27], v[116:119], v[104:107]
 v_mfma_f32_16x16x32_bf16 v[108:111], a[88:91], v[116:119], v[108:111]
 v_mfma_f32_16x16x32_bf16 v[84:87], v[116:119], v[152:155], v[84:87]
 v_mfma_f32_16x16x32_bf16 v[92:95], v[116:119], v[216:219], v[92:95]
 ds_read_b128 v[116:119], v0 offset:24576
 s_waitcnt lgkmcnt(2)
 v_mfma_f32_16x16x32_bf16 v[64:67], a[156:159], v[120:123], v[64:67]
 v_mfma_f32_16x16x32_bf16 v[68:71], a[220:223], v[120:123], v[68:71]
 v_mfma_f32_16x16x32_bf16 v[96:99], a[28:31], v[120:123], v[96:99]
 v_mfma_f32_16x16x32_bf16 v[100:103], a[92:95], v[120:123], v[100:103]
 v_mfma_f32_16x16x32_bf16 v[80:83], v[120:123], v[156:159], v[80:83]
 v_mfma_f32_16x16x32_bf16 v[88:91], v[120:123], v[220:223], v[88:91]
 ds_read_b128 v[120:123], v11 offset:8192
 v_mfma_f32_16x16x32_bf16 v[72:75], a[156:159], v[124:127], v[72:75]
 v_mfma_f32_16x16x32_bf16 v[76:79], a[220:223], v[124:127], v[76:79]
 v_mfma_f32_16x16x32_bf16 v[104:107], a[28:31], v[124:127], v[104:107]
 v_mfma_f32_16x16x32_bf16 v[108:111], a[92:95], v[124:127], v[108:111]
 v_mfma_f32_16x16x32_bf16 v[84:87], v[124:127], v[156:159], v[84:87]
 v_mfma_f32_16x16x32_bf16 v[92:95], v[124:127], v[220:223], v[92:95]
 ds_read_b128 v[124:127], v11 offset:24576
 s_waitcnt lgkmcnt(2)
 v_mfma_f32_16x16x32_bf16 v[64:67], a[160:163], v[112:115], v[64:67]
 v_mfma_f32_16x16x32_bf16 v[68:71], a[224:227], v[112:115], v[68:71]
 v_mfma_f32_16x16x32_bf16 v[96:99], a[32:35], v[112:115], v[96:99]
 v_mfma_f32_16x16x32_bf16 v[100:103], a[96:99], v[112:115], v[100:103]
 v_mfma_f32_16x16x32_bf16 v[80:83], v[112:115], v[160:163], v[80:83]
 v_mfma_f32_16x16x32_bf16 v[88:91], v[112:115], v[224:227], v[88:91]
 ds_read_b128 v[112:115], v0 offset:10240
 v_mfma_f32_16x16x32_bf16 v[72:75], a[160:163], v[116:119], v[72:75]
 v_mfma_f32_16x16x32_bf16 v[76:79], a[224:227], v[116:119], v[76:79]
 v_mfma_f32_16x16x32_bf16 v[104:107], a[32:35], v[116:119], v[104:107]
 v_mfma_f32_16x16x32_bf16 v[108:111], a[96:99], v[116:119], v[108:111]
 v_mfma_f32_16x16x32_bf16 v[84:87], v[116:119], v[160:163], v[84:87]
 v_mfma_f32_16x16x32_bf16 v[92:95], v[116:119], v[224:227], v[92:95]
 ds_read_b128 v[116:119], v0 offset:26624
 s_waitcnt lgkmcnt(2)
 v_mfma_f32_16x16x32_bf16 v[64:67], a[164:167], v[120:123], v[64:67]
 v_mfma_f32_16x16x32_bf16 v[68:71], a[228:231], v[120:123], v[68:71]
 v_mfma_f32_16x16x32_bf16 v[96:99], a[36:39], v[120:123], v[96:99]
 v_mfma_f32_16x16x32_bf16 v[100:103], a[100:103], v[120:123], v[100:103]
 v_mfma_f32_16x16x32_bf16 v[80:83], v[120:123], v[164:167], v[80:83]
 v_mfma_f32_16x16x32_bf16 v[88:91], v[120:123], v[228:231], v[88:91]
 ds_read_b128 v[120:123], v11 offset:10240
 v_mfma_f32_16x16x32_bf16 v[72:75], a[164:167], v[124:127], v[72:75]
 v_mfma_f32_16x16x32_bf16 v[76:79], a[228:231], v[124:127], v[76:79]
 v_mfma_f32_16x16x32_bf16 v[104:107], a[36:39], v[124:127], v[104:107]
 v_mfma_f32_16x16x32_bf16 v[108:111], a[100:103], v[124:127], v[108:111]
 v_mfma_f32_16x16x32_bf16 v[84:87], v[124:127], v[164:167], v[84:87]
 v_mfma_f32_16x16x32_bf16 v[92:95], v[124:127], v[228:231], v[92:95]
 ds_read_b128 v[124:127], v11 offset:26624
 s_waitcnt lgkmcnt(2)
 v_mfma_f32_16x16x32_bf16 v[64:67], a[168:171], v[112:115], v[64:67]
 v_mfma_f32_16x16x32_bf16 v[68:71], a[232:235], v[112:115], v[68:71]
 v_mfma_f32_16x16x32_bf16 v[96:99], a[40:43], v[112:115], v[96:99]
 v_mfma_f32_16x16x32_bf16 v[100:103], a[104:107], v[112:115], v[100:103]
 v_mfma_f32_16x16x32_bf16 v[80:83], v[112:115], v[168:171], v[80:83]
 v_mfma_f32_16x16x32_bf16 v[88:91], v[112:115], v[232:235], v[88:91]
 ds_read_b128 v[112:115], v0 offset:12288
 v_mfma_f32_16x16x32_bf16 v[72:75], a[168:171], v[116:119], v[72:75]
 v_mfma_f32_16x16x32_bf16 v[76:79], a[232:235], v[116:119], v[76:79]
 v_mfma_f32_16x16x32_bf16 v[104:107], a[40:43], v[116:119], v[104:107]
 v_mfma_f32_16x16x32_bf16 v[108:111], a[104:107], v[116:119], v[108:111]
 v_mfma_f32_16x16x32_bf16 v[84:87], v[116:119], v[168:171], v[84:87]
 v_mfma_f32_16x16x32_bf16 v[92:95], v[116:119], v[232:235], v[92:95]
 ds_read_b128 v[116:119], v0 offset:28672
 s_waitcnt lgkmcnt(2)
 v_mfma_f32_16x16x32_bf16 v[64:67], a[172:175], v[120:123], v[64:67]
 v_mfma_f32_16x16x32_bf16 v[68:71], a[236:239], v[120:123], v[68:71]
 v_mfma_f32_16x16x32_bf16 v[96:99], a[44:47], v[120:123], v[96:99]
 v_mfma_f32_16x16x32_bf16 v[100:103], a[108:111], v[120:123], v[100:103]
 v_mfma_f32_16x16x32_bf16 v[80:83], v[120:123], v[172:175], v[80:83]
 v_mfma_f32_16x16x32_bf16 v[88:91], v[120:123], v[236:239], v[88:91]
 ds_read_b128 v[120:123], v11 offset:12288
 v_mfma_f32_16x16x32_bf16 v[72:75], a[172:175], v[124:127], v[72:75]
 v_mfma_f32_16x16x32_bf16 v[76:79], a[236:239], v[124:127], v[76:79]
 v_mfma_f32_16x16x32_bf16 v[104:107], a[44:47], v[124:127], v[104:107]
 v_mfma_f32_16x16x32_bf16 v[108:111], a[108:111], v[124:127], v[108:111]
 v_mfma_f32_16x16x32_bf16 v[84:87], v[124:127], v[172:175], v[84:87]
 v_mfma_f32_16x16x32_bf16 v[92:95], v[124:127], v[236:239], v[92:95]
 ds_read_b128 v[124:127], v11 offset:28672
 s_waitcnt lgkmcnt(2)
 v_mfma_f32_16x16x32_bf16 v[64:67], a[176:179], v[112:115], v[64:67]
 v_mfma_f32_16x16x32_bf16 v[68:71], a[240:243], v[112:115], v[68:71]
 v_mfma_f32_16x16x32_bf16 v[96:99], a[48:51], v[112:115], v[96:99]
 v_mfma_f32_16x16x32_bf16 v[100:103], a[112:115], v[112:115], v[100:103]
 v_mfma_f32_16x16x32_bf16 v[80:83], v[112:115], v[176:179], v[80:83]
 v_mfma_f32_16x16x32_bf16 v[88:91], v[112:115], v[240:243], v[88:91]
 ds_read_b128 v[112:115], v0 offset:14336
 v_mfma_f32_16x16x32_bf16 v[72:75], a[176:179], v[116:119], v[72:75]
 v_mfma_f32_16x16x32_bf16 v[76:79], a[240:243], v[116:119], v[76:79]
 v_mfma_f32_16x16x32_bf16 v[104:107], a[48:51], v[116:119], v[104:107]
 v_mfma_f32_16x16x32_bf16 v[108:111], a[112:115], v[116:119], v[108:111]
 v_mfma_f32_16x16x32_bf16 v[84:87], v[116:119], v[176:179], v[84:87]
 v_mfma_f32_16x16x32_bf16 v[92:95], v[116:119], v[240:243], v[92:95]
 ds_read_b128 v[116:119], v0 offset:30720
 s_waitcnt lgkmcnt(2)
 v_mfma_f32_16x16x32_bf16 v[64:67], a[180:183], v[120:123], v[64:67]
 v_mfma_f32_16x16x32_bf16 v[68:71], a[244:247], v[120:123], v[68:71]
 v_mfma_f32_16x16x32_bf16 v[96:99], a[52:55], v[120:123], v[96:99]
 v_mfma_f32_16x16x32_bf16 v[100:103], a[116:119], v[120:123], v[100:103]
 v_mfma_f32_16x16x32_bf16 v[80:83], v[120:123], v[180:183], v[80:83]
 v_mfma_f32_16x16x32_bf16 v[88:91], v[120:123], v[244:247], v[88:91]
 ds_read_b128 v[120:123], v11 offset:14336
 v_mfma_f32_16x16x32_bf16 v[72:75], a[180:183], v[124:127], v[72:75]
 v_mfma_f32_16x16x32_bf16 v[76:79], a[244:247], v[124:127], v[76:79]
 v_mfma_f32_16x16x32_bf16 v[104:107], a[52:55], v[124:127], v[104:107]
 v_mfma_f32_16x16x32_bf16 v[108:111], a[116:119], v[124:127], v[108:111]
 v_mfma_f32_16x16x32_bf16 v[84:87], v[124:127], v[180:183], v[84:87]
 v_mfma_f32_16x16x32_bf16 v[92:95], v[124:127], v[244:247], v[92:95]
 ds_read_b128 v[124:127], v11 offset:30720
 s_waitcnt lgkmcnt(2)
 v_mfma_f32_16x16x32_bf16 v[64:67], a[184:187], v[112:115], v[64:67]
 v_mfma_f32_16x16x32_bf16 v[68:71], a[248:251], v[112:115], v[68:71]
 v_mfma_f32_16x16x32_bf16 v[96:99], a[56:59], v[112:115], v[96:99]
 v_mfma_f32_16x16x32_bf16 v[100:103], a[120:123], v[112:115], v[100:103]
 v_mfma_f32_16x16x32_bf16 v[80:83], v[112:115], v[184:187], v[80:83]
 v_mfma_f32_16x16x32_bf16 v[88:91], v[112:115], v[248:251], v[88:91]
 v_mfma_f32_16x16x32_bf16 v[72:75], a[184:187], v[116:119], v[72:75]
 v_mfma_f32_16x16x32_bf16 v[76:79], a[248:251], v[116:119], v[76:79]
 v_mfma_f32_16x16x32_bf16 v[104:107], a[56:59], v[116:119], v[104:107]
 v_mfma_f32_16x16x32_bf16 v[108:111], a[120:123], v[116:119], v[108:111]
 v_mfma_f32_16x16x32_bf16 v[84:87], v[116:119], v[184:187], v[84:87]
 v_mfma_f32_16x16x32_bf16 v[92:95], v[116:119], v[248:251], v[92:95]
 s_waitcnt lgkmcnt(0)
 v_mfma_f32_16x16x32_bf16 v[64:67], a[188:191], v[120:123], v[64:67]
 v_mfma_f32_16x16x32_bf16 v[68:71], a[252:255], v[120:123], v[68:71]
 v_mfma_f32_16x16x32_bf16 v[96:99], a[60:63], v[120:123], v[96:99]
 v_mfma_f32_16x16x32_bf16 v[100:103], a[124:127], v[120:123], v[100:103]
 v_mfma_f32_16x16x32_bf16 v[80:83], v[120:123], v[188:191], v[80:83]
 v_mfma_f32_16x16x32_bf16 v[88:91], v[120:123], v[252:255], v[88:91]
 v_mfma_f32_16x16x32_bf16 v[72:75], a[188:191], v[124:127], v[72:75]
 v_mfma_f32_16x16x32_bf16 v[76:79], a[252:255], v[124:127], v[76:79]
 v_mfma_f32_16x16x32_bf16 v[104:107], a[60:63], v[124:127], v[104:107]
 v_mfma_f32_16x16x32_bf16 v[108:111], a[124:127], v[124:127], v[108:111]
 v_mfma_f32_16x16x32_bf16 v[84:87], v[124:127], v[188:191], v[84:87]
 v_mfma_f32_16x16x32_bf16 v[92:95], v[124:127], v[252:255], v[92:95]
 s_lshl_b32 s24, s17, 10
 s_add_u32 s24, s24, s40
 s_add_u32 s25, s24, 4096
 s_lshl_b32 s26, s17, 11
 s_add_u32 s26, s26, s40
 s_add_u32 s26, s26, 8192
 s_nop 1
 v_cvt_pk_bf16_f32 v16, v64, v65
 v_cvt_pk_bf16_f32 v17, v66, v67
 v_cvt_pk_bf16_f32 v18, v68, v69
 v_cvt_pk_bf16_f32 v19, v70, v71
 buffer_store_dwordx4 v[16:19], v1, s[4:7], s24 offen offset:0 sc1
 v_cvt_pk_bf16_f32 v32, v96, v97
 v_cvt_pk_bf16_f32 v33, v98, v99
 v_cvt_pk_bf16_f32 v34, v100, v101
 v_cvt_pk_bf16_f32 v35, v102, v103
 v_cvt_pk_bf16_f32 v20, v72, v73
 v_cvt_pk_bf16_f32 v21, v74, v75
 v_cvt_pk_bf16_f32 v22, v76, v77
 v_cvt_pk_bf16_f32 v23, v78, v79
 buffer_store_dwordx4 v[20:23], v1, s[4:7], s25 offen offset:0 sc1
 v_cvt_pk_bf16_f32 v36, v104, v105
 v_cvt_pk_bf16_f32 v37, v106, v107
 v_cvt_pk_bf16_f32 v38, v108, v109
 v_cvt_pk_bf16_f32 v39, v110, v111
 v_cvt_pk_bf16_f32 v24, v80, v81
 v_cvt_pk_bf16_f32 v25, v82, v83
 v_cvt_pk_bf16_f32 v26, v84, v85
 v_cvt_pk_bf16_f32 v27, v86, v87
 buffer_store_dwordx4 v[24:27], v1, s[4:7], s26 offen offset:0 sc1
 v_cvt_pk_bf16_f32 v28, v88, v89
 v_cvt_pk_bf16_f32 v29, v90, v91
 v_cvt_pk_bf16_f32 v30, v92, v93
 v_cvt_pk_bf16_f32 v31, v94, v95
 buffer_store_dwordx4 v[28:31], v1, s[4:7], s26 offen offset:1024 sc1
 s_add_u32 m0, s47, 0
 s_mov_b32 s24, 0x0
 buffer_load_dwordx4 v14, s[88:91], s24 offen lds
 s_add_u32 m0, s47, 1024
 s_mov_b32 s24, 0x1000
 buffer_load_dwordx4 v14, s[88:91], s24 offen lds
 s_add_u32 m0, s47, 2048
 s_mov_b32 s24, 0x2000
 buffer_load_dwordx4 v14, s[88:91], s24 offen lds
 s_add_u32 m0, s47, 3072
 s_mov_b32 s24, 0x3000
 buffer_load_dwordx4 v14, s[88:91], s24 offen lds
 s_add_u32 m0, s47, 4096
 s_mov_b32 s24, 0x4000
 buffer_load_dwordx4 v14, s[88:91], s24 offen lds
 s_add_u32 m0, s47, 5120
 s_mov_b32 s24, 0x5000
 buffer_load_dwordx4 v14, s[88:91], s24 offen lds
 s_add_u32 m0, s47, 6144
 s_mov_b32 s24, 0x6000
 buffer_load_dwordx4 v14, s[88:91], s24 offen lds
 s_add_u32 m0, s47, 7168
 s_mov_b32 s24, 0x7000
 buffer_load_dwordx4 v14, s[88:91], s24 offen lds
 s_add_u32 m0, s47, 8192
 s_mov_b32 s24, 0x8000
 buffer_load_dwordx4 v14, s[88:91], s24 offen lds
 s_add_u32 m0, s47, 9216
 s_mov_b32 s24, 0x9000
 buffer_load_dwordx4 v14, s[88:91], s24 offen lds
 s_add_u32 m0, s47, 10240
 s_mov_b32 s24, 0xa000
 buffer_load_dwordx4 v14, s[88:91], s24 offen lds
 s_add_u32 m0, s47, 11264
 s_mov_b32 s24, 0xb000
 buffer_load_dwordx4 v14, s[88:91], s24 offen lds
 s_add_u32 m0, s47, 12288
 s_mov_b32 s24, 0xc000
 buffer_load_dwordx4 v14, s[88:91], s24 offen lds
 s_add_u32 m0, s47, 13312
 s_mov_b32 s24, 0xd000
 buffer_load_dwordx4 v14, s[88:91], s24 offen lds
 s_add_u32 m0, s47, 14336
 s_mov_b32 s24, 0xe000
 buffer_load_dwordx4 v14, s[88:91], s24 offen lds
 s_add_u32 m0, s47, 15360
 s_mov_b32 s24, 0xf000
 buffer_load_dwordx4 v14, s[88:91], s24 offen lds
 s_add_u32 m0, s47, 16384
 s_mov_b32 s24, 0x10000
 buffer_load_dwordx4 v14, s[88:91], s24 offen lds
 s_add_u32 m0, s47, 17408
 s_mov_b32 s24, 0x11000
 buffer_load_dwordx4 v14, s[88:91], s24 offen lds
 s_add_u32 m0, s47, 18432
 s_mov_b32 s24, 0x12000
 buffer_load_dwordx4 v14, s[88:91], s24 offen lds
 s_add_u32 m0, s47, 19456
 s_mov_b32 s24, 0x13000
 buffer_load_dwordx4 v14, s[88:91], s24 offen lds
 s_add_u32 m0, s47, 20480
 s_mov_b32 s24, 0x14000
 buffer_load_dwordx4 v14, s[88:91], s24 offen lds
 s_add_u32 m0, s47, 21504
 s_mov_b32 s24, 0x15000
 buffer_load_dwordx4 v14, s[88:91], s24 offen lds
 s_add_u32 m0, s47, 22528
 s_mov_b32 s24, 0x16000
 buffer_load_dwordx4 v14, s[88:91], s24 offen lds
 s_add_u32 m0, s47, 23552
 s_mov_b32 s24, 0x17000
 buffer_load_dwordx4 v14, s[88:91], s24 offen lds
 s_add_u32 m0, s47, 24576
 s_mov_b32 s24, 0x18000
 buffer_load_dwordx4 v14, s[88:91], s24 offen lds
 s_add_u32 m0, s47, 25600
 s_mov_b32 s24, 0x19000
 buffer_load_dwordx4 v14, s[88:91], s24 offen lds
 s_add_u32 m0, s47, 26624
 s_mov_b32 s24, 0x1a000
 buffer_load_dwordx4 v14, s[88:91], s24 offen lds
 s_add_u32 m0, s47, 27648
 s_mov_b32 s24, 0x1b000
 buffer_load_dwordx4 v14, s[88:91], s24 offen lds
 s_add_u32 m0, s47, 28672
 s_mov_b32 s24, 0x1c000
 buffer_load_dwordx4 v14, s[88:91], s24 offen lds
 s_add_u32 m0, s47, 29696
 s_mov_b32 s24, 0x1d000
 buffer_load_dwordx4 v14, s[88:91], s24 offen lds
 s_add_u32 m0, s47, 30720
 s_mov_b32 s24, 0x1e000
 buffer_load_dwordx4 v14, s[88:91], s24 offen lds
 s_add_u32 m0, s47, 31744
 s_mov_b32 s24, 0x1f000
 buffer_load_dwordx4 v14, s[88:91], s24 offen lds
 s_waitcnt vmcnt(32)
 s_barrier
 s_cmp_eq_u32 s17, 0
 s_cbranch_scc0 L_kvf_37
 s_mov_b64 exec, 1
 v_mov_b32 v10, 2
 buffer_store_dword v10, off, s[4:7], s41 sc1
 s_mov_b64 exec, -1
L_kvf_37:
 s_waitcnt vmcnt(0)
 ds_read_b64_tr_b16 v[64:65], v15 offset:0
 ds_read_b64_tr_b16 v[66:67], v15 offset:4096
 ds_read_b64_tr_b16 v[68:69], v15 offset:8
 ds_read_b64_tr_b16 v[70:71], v15 offset:4104
 ds_read_b64_tr_b16 v[72:73], v15 offset:64
 ds_read_b64_tr_b16 v[74:75], v15 offset:4160
 ds_read_b64_tr_b16 v[76:77], v15 offset:72
 ds_read_b64_tr_b16 v[78:79], v15 offset:4168
 s_waitcnt lgkmcnt(0)
 ds_read_b64_tr_b16 v[80:81], v15 offset:128
 ds_read_b64_tr_b16 v[82:83], v15 offset:4224
 ds_read_b64_tr_b16 v[84:85], v15 offset:136
 ds_read_b64_tr_b16 v[86:87], v15 offset:4232
 ds_read_b64_tr_b16 v[88:89], v15 offset:192
 ds_read_b64_tr_b16 v[90:91], v15 offset:4288
 ds_read_b64_tr_b16 v[92:93], v15 offset:200
 ds_read_b64_tr_b16 v[94:95], v15 offset:4296
 s_waitcnt lgkmcnt(0)
 ds_write_b128 v3, v[64:67] offset:0
 ds_write_b128 v3, v[68:71] offset:1024
 ds_write_b128 v3, v[72:75] offset:2048
 ds_write_b128 v3, v[76:79] offset:3072
 ds_write_b128 v3, v[80:83] offset:4096
 ds_write_b128 v3, v[84:87] offset:5120
 ds_write_b128 v3, v[88:91] offset:6144
 ds_write_b128 v3, v[92:95] offset:7168
 s_waitcnt lgkmcnt(0)
 ds_read_b64_tr_b16 v[64:65], v15 offset:8192
 ds_read_b64_tr_b16 v[66:67], v15 offset:12288
 ds_read_b64_tr_b16 v[68:69], v15 offset:8200
 ds_read_b64_tr_b16 v[70:71], v15 offset:12296
 ds_read_b64_tr_b16 v[72:73], v15 offset:8256
 ds_read_b64_tr_b16 v[74:75], v15 offset:12352
 ds_read_b64_tr_b16 v[76:77], v15 offset:8264
 ds_read_b64_tr_b16 v[78:79], v15 offset:12360
 s_waitcnt lgkmcnt(0)
 ds_read_b64_tr_b16 v[80:81], v15 offset:8320
 ds_read_b64_tr_b16 v[82:83], v15 offset:12416
 ds_read_b64_tr_b16 v[84:85], v15 offset:8328
 ds_read_b64_tr_b16 v[86:87], v15 offset:12424
 ds_read_b64_tr_b16 v[88:89], v15 offset:8384
 ds_read_b64_tr_b16 v[90:91], v15 offset:12480
 ds_read_b64_tr_b16 v[92:93], v15 offset:8392
 ds_read_b64_tr_b16 v[94:95], v15 offset:12488
 s_waitcnt lgkmcnt(0)
 ds_write_b128 v3, v[64:67] offset:8192
 ds_write_b128 v3, v[68:71] offset:9216
 ds_write_b128 v3, v[72:75] offset:10240
 ds_write_b128 v3, v[76:79] offset:11264
 ds_write_b128 v3, v[80:83] offset:12288
 ds_write_b128 v3, v[84:87] offset:13312
 ds_write_b128 v3, v[88:91] offset:14336
 ds_write_b128 v3, v[92:95] offset:15360
 s_waitcnt lgkmcnt(0)
 ds_read_b64_tr_b16 v[64:65], v15 offset:16384
 ds_read_b64_tr_b16 v[66:67], v15 offset:20480
 ds_read_b64_tr_b16 v[68:69], v15 offset:16392
 ds_read_b64_tr_b16 v[70:71], v15 offset:20488
 ds_read_b64_tr_b16 v[72:73], v15 offset:16448
 ds_read_b64_tr_b16 v[74:75], v15 offset:20544
 ds_read_b64_tr_b16 v[76:77], v15 offset:16456
 ds_read_b64_tr_b16 v[78:79], v15 offset:20552
 s_waitcnt lgkmcnt(0)
 ds_read_b64_tr_b16 v[80:81], v15 offset:16512
 ds_read_b64_tr_b16 v[82:83], v15 offset:20608
 ds_read_b64_tr_b16 v[84:85], v15 offset:16520
 ds_read_b64_tr_b16 v[86:87], v15 offset:20616
 ds_read_b64_tr_b16 v[88:89], v15 offset:16576
 ds_read_b64_tr_b16 v[90:91], v15 offset:20672
 ds_read_b64_tr_b16 v[92:93], v15 offset:16584
 ds_read_b64_tr_b16 v[94:95], v15 offset:20680
 s_waitcnt lgkmcnt(0)
 ds_write_b128 v3, v[64:67] offset:16384
 ds_write_b128 v3, v[68:71] offset:17408
 ds_write_b128 v3, v[72:75] offset:18432
 ds_write_b128 v3, v[76:79] offset:19456
 ds_write_b128 v3, v[80:83] offset:20480
 ds_write_b128 v3, v[84:87] offset:21504
 ds_write_b128 v3, v[88:91] offset:22528
 ds_write_b128 v3, v[92:95] offset:23552
 s_waitcnt lgkmcnt(0)
 ds_read_b64_tr_b16 v[64:65], v15 offset:24576
 ds_read_b64_tr_b16 v[66:67], v15 offset:28672
 ds_read_b64_tr_b16 v[68:69], v15 offset:24584
 ds_read_b64_tr_b16 v[70:71], v15 offset:28680
 ds_read_b64_tr_b16 v[72:73], v15 offset:24640
 ds_read_b64_tr_b16 v[74:75], v15 offset:28736
 ds_read_b64_tr_b16 v[76:77], v15 offset:24648
 ds_read_b64_tr_b16 v[78:79], v15 offset:28744
 s_waitcnt lgkmcnt(0)
 ds_read_b64_tr_b16 v[80:81], v15 offset:24704
 ds_read_b64_tr_b16 v[82:83], v15 offset:28800
 ds_read_b64_tr_b16 v[84:85], v15 offset:24712
 ds_read_b64_tr_b16 v[86:87], v15 offset:28808
 ds_read_b64_tr_b16 v[88:89], v15 offset:24768
 ds_read_b64_tr_b16 v[90:91], v15 offset:28864
 ds_read_b64_tr_b16 v[92:93], v15 offset:24776
 ds_read_b64_tr_b16 v[94:95], v15 offset:28872
 s_waitcnt lgkmcnt(0)
 ds_write_b128 v3, v[64:67] offset:24576
 ds_write_b128 v3, v[68:71] offset:25600
 ds_write_b128 v3, v[72:75] offset:26624
 ds_write_b128 v3, v[76:79] offset:27648
 ds_write_b128 v3, v[80:83] offset:28672
 ds_write_b128 v3, v[84:87] offset:29696
 ds_write_b128 v3, v[88:91] offset:30720
 ds_write_b128 v3, v[92:95] offset:31744
 s_waitcnt lgkmcnt(0)
 s_branch L_tent_36
L_tloop_35:
 v_xor_b32 v11, 64, v0
 ds_read_b128 v[112:115], v0 offset:0
 ds_read_b128 v[116:119], v0 offset:16384
 ds_read_b128 v[120:123], v11 offset:0
 ds_read_b128 v[124:127], v11 offset:16384
 v_mov_b32 v16, s39
 v_mov_b32 v17, s39
 v_mov_b32 v18, s39
 v_mov_b32 v19, s39
 s_lshl_b32 s24, s17, 10
 s_add_u32 s24, s24, s42
 buffer_store_dwordx4 v[16:19], v1, s[4:7], s24 offen sc1
 s_waitcnt lgkmcnt(2)
 v_mfma_f32_16x16x32_bf16 v[64:67], a[128:131], v[112:115], 0
 v_mfma_f32_16x16x32_bf16 v[68:71], a[192:195], v[112:115], 0
 v_mfma_f32_16x16x32_bf16 v[96:99], a[0:3], v[112:115], 0
 v_mfma_f32_16x16x32_bf16 v[100:103], a[64:67], v[112:115], 0
 v_mfma_f32_16x16x32_bf16 v[80:83], v[112:115], v[128:131], 0
 v_mfma_f32_16x16x32_bf16 v[88:91], v[112:115], v[192:195], 0
 ds_read_b128 v[112:115], v0 offset:2048
 v_mfma_f32_16x16x32_bf16 v[72:75], a[128:131], v[116:119], 0
 v_mfma_f32_16x16x32_bf16 v[76:79], a[192:195], v[116:119], 0
 v_mfma_f32_16x16x32_bf16 v[104:107], a[0:3], v[116:119], 0
 v_mfma_f32_16x16x32_bf16 v[108:111], a[64:67], v[116:119], 0
 v_mfma_f32_16x16x32_bf16 v[84:87], v[116:119], v[128:131], 0
 v_mfma_f32_16x16x32_bf16 v[92:95], v[116:119], v[192:195], 0
 ds_read_b128 v[116:119], v0 offset:18432
 s_waitcnt lgkmcnt(2)
 v_mfma_f32_16x16x32_bf16 v[64:67], a[132:135], v[120:123], v[64:67]
 v_mfma_f32_16x16x32_bf16 v[68:71], a[196:199], v[120:123], v[68:71]
 v_mfma_f32_16x16x32_bf16 v[96:99], a[4:7], v[120:123], v[96:99]
 v_mfma_f32_16x16x32_bf16 v[100:103], a[68:71], v[120:123], v[100:103]
 v_mfma_f32_16x16x32_bf16 v[80:83], v[120:123], v[132:135], v[80:83]
 v_mfma_f32_16x16x32_bf16 v[88:91], v[120:123], v[196:199], v[88:91]
 ds_read_b128 v[120:123], v11 offset:2048
 v_mfma_f32_16x16x32_bf16 v[72:75], a[132:135], v[124:127], v[72:75]
 v_mfma_f32_16x16x32_bf16 v[76:79], a[196:199], v[124:127], v[76:79]
 v_mfma_f32_16x16x32_bf16 v[104:107], a[4:7], v[124:127], v[104:107]
 v_mfma_f32_16x16x32_bf16 v[108:111], a[68:71], v[124:127], v[108:111]
 v_mfma_f32_16x16x32_bf16 v[84:87], v[124:127], v[132:135], v[84:87]
 v_mfma_f32_16x16x32_bf16 v[92:95], v[124:127], v[196:199], v[92:95]
 ds_read_b128 v[124:127], v11 offset:18432
 s_waitcnt lgkmcnt(2)
 v_mfma_f32_16x16x32_bf16 v[64:67], a[136:139], v[112:115], v[64:67]
 v_mfma_f32_16x16x32_bf16 v[68:71], a[200:203], v[112:115], v[68:71]
 v_mfma_f32_16x16x32_bf16 v[96:99], a[8:11], v[112:115], v[96:99]
 v_mfma_f32_16x16x32_bf16 v[100:103], a[72:75], v[112:115], v[100:103]
 v_mfma_f32_16x16x32_bf16 v[80:83], v[112:115], v[136:139], v[80:83]
 v_mfma_f32_16x16x32_bf16 v[88:91], v[112:115], v[200:203], v[88:91]
 ds_read_b128 v[112:115], v0 offset:4096
 v_mfma_f32_16x16x32_bf16 v[72:75], a[136:139], v[116:119], v[72:75]
 v_mfma_f32_16x16x32_bf16 v[76:79], a[200:203], v[116:119], v[76:79]
 v_mfma_f32_16x16x32_bf16 v[104:107], a[8:11], v[116:119], v[104:107]
 v_mfma_f32_16x16x32_bf16 v[108:111], a[72:75], v[116:119], v[108:111]
 v_mfma_f32_16x16x32_bf16 v[84:87], v[116:119], v[136:139], v[84:87]
 v_mfma_f32_16x16x32_bf16 v[92:95], v[116:119], v[200:203], v[92:95]
 ds_read_b128 v[116:119], v0 offset:20480
 s_waitcnt lgkmcnt(2)
 v_mfma_f32_16x16x32_bf16 v[64:67], a[140:143], v[120:123], v[64:67]
 v_mfma_f32_16x16x32_bf16 v[68:71], a[204:207], v[120:123], v[68:71]
 v_mfma_f32_16x16x32_bf16 v[96:99], a[12:15], v[120:123], v[96:99]
 v_mfma_f32_16x16x32_bf16 v[100:103], a[76:79], v[120:123], v[100:103]
 v_mfma_f32_16x16x32_bf16 v[80:83], v[120:123], v[140:143], v[80:83]
 v_mfma_f32_16x16x32_bf16 v[88:91], v[120:123], v[204:207], v[88:91]
 ds_read_b128 v[120:123], v11 offset:4096
 v_mfma_f32_16x16x32_bf16 v[72:75], a[140:143], v[124:127], v[72:75]
 v_mfma_f32_16x16x32_bf16 v[76:79], a[204:207], v[124:127], v[76:79]
 v_mfma_f32_16x16x32_bf16 v[104:107], a[12:15], v[124:127], v[104:107]
 v_mfma_f32_16x16x32_bf16 v[108:111], a[76:79], v[124:127], v[108:111]
 v_mfma_f32_16x16x32_bf16 v[84:87], v[124:127], v[140:143], v[84:87]
 v_mfma_f32_16x16x32_bf16 v[92:95], v[124:127], v[204:207], v[92:95]
 ds_read_b128 v[124:127], v11 offset:20480
 s_waitcnt lgkmcnt(2)
 v_mfma_f32_16x16x32_bf16 v[64:67], a[144:147], v[112:115], v[64:67]
 v_mfma_f32_16x16x32_bf16 v[68:71], a[208:211], v[112:115], v[68:71]
 v_mfma_f32_16x16x32_bf16 v[96:99], a[16:19], v[112:115], v[96:99]
 v_mfma_f32_16x16x32_bf16 v[100:103], a[80:83], v[112:115], v[100:103]
 v_mfma_f32_16x16x32_bf16 v[80:83], v[112:115], v[144:147], v[80:83]
 v_mfma_f32_16x16x32_bf16 v[88:91], v[112:115], v[208:211], v[88:91]
 ds_read_b128 v[112:115], v0 offset:6144
 v_mfma_f32_16x16x32_bf16 v[72:75], a[144:147], v[116:119], v[72:75]
 v_mfma_f32_16x16x32_bf16 v[76:79], a[208:211], v[116:119], v[76:79]
 v_mfma_f32_16x16x32_bf16 v[104:107], a[16:19], v[116:119], v[104:107]
 v_mfma_f32_16x16x32_bf16 v[108:111], a[80:83], v[116:119], v[108:111]
 v_mfma_f32_16x16x32_bf16 v[84:87], v[116:119], v[144:147], v[84:87]
 v_mfma_f32_16x16x32_bf16 v[92:95], v[116:119], v[208:211], v[92:95]
 ds_read_b128 v[116:119], v0 offset:22528
 s_waitcnt lgkmcnt(2)
 v_mfma_f32_16x16x32_bf16 v[64:67], a[148:151], v[120:123], v[64:67]
 v_mfma_f32_16x16x32_bf16 v[68:71], a[212:215], v[120:123], v[68:71]
 v_mfma_f32_16x16x32_bf16 v[96:99], a[20:23], v[120:123], v[96:99]
 v_mfma_f32_16x16x32_bf16 v[100:103], a[84:87], v[120:123], v[100:103]
 v_mfma_f32_16x16x32_bf16 v[80:83], v[120:123], v[148:151], v[80:83]
 v_mfma_f32_16x16x32_bf16 v[88:91], v[120:123], v[212:215], v[88:91]
 ds_read_b128 v[120:123], v11 offset:6144
 v_mfma_f32_16x16x32_bf16 v[72:75], a[148:151], v[124:127], v[72:75]
 v_mfma_f32_16x16x32_bf16 v[76:79], a[212:215], v[124:127], v[76:79]
 v_mfma_f32_16x16x32_bf16 v[104:107], a[20:23], v[124:127], v[104:107]
 v_mfma_f32_16x16x32_bf16 v[108:111], a[84:87], v[124:127], v[108:111]
 v_mfma_f32_16x16x32_bf16 v[84:87], v[124:127], v[148:151], v[84:87]
 v_mfma_f32_16x16x32_bf16 v[92:95], v[124:127], v[212:215], v[92:95]
 ds_read_b128 v[124:127], v11 offset:22528
 s_waitcnt lgkmcnt(2)
 v_mfma_f32_16x16x32_bf16 v[64:67], a[152:155], v[112:115], v[64:67]
 v_mfma_f32_16x16x32_bf16 v[68:71], a[216:219], v[112:115], v[68:71]
 v_mfma_f32_16x16x32_bf16 v[96:99], a[24:27], v[112:115], v[96:99]
 v_mfma_f32_16x16x32_bf16 v[100:103], a[88:91], v[112:115], v[100:103]
 v_mfma_f32_16x16x32_bf16 v[80:83], v[112:115], v[152:155], v[80:83]
 v_mfma_f32_16x16x32_bf16 v[88:91], v[112:115], v[216:219], v[88:91]
 ds_read_b128 v[112:115], v0 offset:8192
 v_mfma_f32_16x16x32_bf16 v[72:75], a[152:155], v[116:119], v[72:75]
 v_mfma_f32_16x16x32_bf16 v[76:79], a[216:219], v[116:119], v[76:79]
 v_mfma_f32_16x16x32_bf16 v[104:107], a[24:27], v[116:119], v[104:107]
 v_mfma_f32_16x16x32_bf16 v[108:111], a[88:91], v[116:119], v[108:111]
 v_mfma_f32_16x16x32_bf16 v[84:87], v[116:119], v[152:155], v[84:87]
 v_mfma_f32_16x16x32_bf16 v[92:95], v[116:119], v[216:219], v[92:95]
 ds_read_b128 v[116:119], v0 offset:24576
 s_waitcnt lgkmcnt(2)
 v_mfma_f32_16x16x32_bf16 v[64:67], a[156:159], v[120:123], v[64:67]
 v_mfma_f32_16x16x32_bf16 v[68:71], a[220:223], v[120:123], v[68:71]
 v_mfma_f32_16x16x32_bf16 v[96:99], a[28:31], v[120:123], v[96:99]
 v_mfma_f32_16x16x32_bf16 v[100:103], a[92:95], v[120:123], v[100:103]
 v_mfma_f32_16x16x32_bf16 v[80:83], v[120:123], v[156:159], v[80:83]
 v_mfma_f32_16x16x32_bf16 v[88:91], v[120:123], v[220:223], v[88:91]
 ds_read_b128 v[120:123], v11 offset:8192
 v_mfma_f32_16x16x32_bf16 v[72:75], a[156:159], v[124:127], v[72:75]
 v_mfma_f32_16x16x32_bf16 v[76:79], a[220:223], v[124:127], v[76:79]
 v_mfma_f32_16x16x32_bf16 v[104:107], a[28:31], v[124:127], v[104:107]
 v_mfma_f32_16x16x32_bf16 v[108:111], a[92:95], v[124:127], v[108:111]
 v_mfma_f32_16x16x32_bf16 v[84:87], v[124:127], v[156:159], v[84:87]
 v_mfma_f32_16x16x32_bf16 v[92:95], v[124:127], v[220:223], v[92:95]
 ds_read_b128 v[124:127], v11 offset:24576
 s_waitcnt lgkmcnt(2)
 v_mfma_f32_16x16x32_bf16 v[64:67], a[160:163], v[112:115], v[64:67]
 v_mfma_f32_16x16x32_bf16 v[68:71], a[224:227], v[112:115], v[68:71]
 v_mfma_f32_16x16x32_bf16 v[96:99], a[32:35], v[112:115], v[96:99]
 v_mfma_f32_16x16x32_bf16 v[100:103], a[96:99], v[112:115], v[100:103]
 v_mfma_f32_16x16x32_bf16 v[80:83], v[112:115], v[160:163], v[80:83]
 v_mfma_f32_16x16x32_bf16 v[88:91], v[112:115], v[224:227], v[88:91]
 ds_read_b128 v[112:115], v0 offset:10240
 v_mfma_f32_16x16x32_bf16 v[72:75], a[160:163], v[116:119], v[72:75]
 v_mfma_f32_16x16x32_bf16 v[76:79], a[224:227], v[116:119], v[76:79]
 v_mfma_f32_16x16x32_bf16 v[104:107], a[32:35], v[116:119], v[104:107]
 v_mfma_f32_16x16x32_bf16 v[108:111], a[96:99], v[116:119], v[108:111]
 v_mfma_f32_16x16x32_bf16 v[84:87], v[116:119], v[160:163], v[84:87]
 v_mfma_f32_16x16x32_bf16 v[92:95], v[116:119], v[224:227], v[92:95]
 ds_read_b128 v[116:119], v0 offset:26624
 s_waitcnt lgkmcnt(2)
 v_mfma_f32_16x16x32_bf16 v[64:67], a[164:167], v[120:123], v[64:67]
 v_mfma_f32_16x16x32_bf16 v[68:71], a[228:231], v[120:123], v[68:71]
 v_mfma_f32_16x16x32_bf16 v[96:99], a[36:39], v[120:123], v[96:99]
 v_mfma_f32_16x16x32_bf16 v[100:103], a[100:103], v[120:123], v[100:103]
 v_mfma_f32_16x16x32_bf16 v[80:83], v[120:123], v[164:167], v[80:83]
 v_mfma_f32_16x16x32_bf16 v[88:91], v[120:123], v[228:231], v[88:91]
 ds_read_b128 v[120:123], v11 offset:10240
 v_mfma_f32_16x16x32_bf16 v[72:75], a[164:167], v[124:127], v[72:75]
 v_mfma_f32_16x16x32_bf16 v[76:79], a[228:231], v[124:127], v[76:79]
 v_mfma_f32_16x16x32_bf16 v[104:107], a[36:39], v[124:127], v[104:107]
 v_mfma_f32_16x16x32_bf16 v[108:111], a[100:103], v[124:127], v[108:111]
 v_mfma_f32_16x16x32_bf16 v[84:87], v[124:127], v[164:167], v[84:87]
 v_mfma_f32_16x16x32_bf16 v[92:95], v[124:127], v[228:231], v[92:95]
 ds_read_b128 v[124:127], v11 offset:26624
 s_waitcnt lgkmcnt(2)
 v_mfma_f32_16x16x32_bf16 v[64:67], a[168:171], v[112:115], v[64:67]
 v_mfma_f32_16x16x32_bf16 v[68:71], a[232:235], v[112:115], v[68:71]
 v_mfma_f32_16x16x32_bf16 v[96:99], a[40:43], v[112:115], v[96:99]
 v_mfma_f32_16x16x32_bf16 v[100:103], a[104:107], v[112:115], v[100:103]
 v_mfma_f32_16x16x32_bf16 v[80:83], v[112:115], v[168:171], v[80:83]
 v_mfma_f32_16x16x32_bf16 v[88:91], v[112:115], v[232:235], v[88:91]
 ds_read_b128 v[112:115], v0 offset:12288
 v_mfma_f32_16x16x32_bf16 v[72:75], a[168:171], v[116:119], v[72:75]
 v_mfma_f32_16x16x32_bf16 v[76:79], a[232:235], v[116:119], v[76:79]
 v_mfma_f32_16x16x32_bf16 v[104:107], a[40:43], v[116:119], v[104:107]
 v_mfma_f32_16x16x32_bf16 v[108:111], a[104:107], v[116:119], v[108:111]
 v_mfma_f32_16x16x32_bf16 v[84:87], v[116:119], v[168:171], v[84:87]
 v_mfma_f32_16x16x32_bf16 v[92:95], v[116:119], v[232:235], v[92:95]
 ds_read_b128 v[116:119], v0 offset:28672
 s_waitcnt lgkmcnt(2)
 v_mfma_f32_16x16x32_bf16 v[64:67], a[172:175], v[120:123], v[64:67]
 v_mfma_f32_16x16x32_bf16 v[68:71], a[236:239], v[120:123], v[68:71]
 v_mfma_f32_16x16x32_bf16 v[96:99], a[44:47], v[120:123], v[96:99]
 v_mfma_f32_16x16x32_bf16 v[100:103], a[108:111], v[120:123], v[100:103]
 v_mfma_f32_16x16x32_bf16 v[80:83], v[120:123], v[172:175], v[80:83]
 v_mfma_f32_16x16x32_bf16 v[88:91], v[120:123], v[236:239], v[88:91]
 ds_read_b128 v[120:123], v11 offset:12288
 v_mfma_f32_16x16x32_bf16 v[72:75], a[172:175], v[124:127], v[72:75]
 v_mfma_f32_16x16x32_bf16 v[76:79], a[236:239], v[124:127], v[76:79]
 v_mfma_f32_16x16x32_bf16 v[104:107], a[44:47], v[124:127], v[104:107]
 v_mfma_f32_16x16x32_bf16 v[108:111], a[108:111], v[124:127], v[108:111]
 v_mfma_f32_16x16x32_bf16 v[84:87], v[124:127], v[172:175], v[84:87]
 v_mfma_f32_16x16x32_bf16 v[92:95], v[124:127], v[236:239], v[92:95]
 ds_read_b128 v[124:127], v11 offset:28672
 s_waitcnt lgkmcnt(2)
 v_mfma_f32_16x16x32_bf16 v[64:67], a[176:179], v[112:115], v[64:67]
 v_mfma_f32_16x16x32_bf16 v[68:71], a[240:243], v[112:115], v[68:71]
 v_mfma_f32_16x16x32_bf16 v[96:99], a[48:51], v[112:115], v[96:99]
 v_mfma_f32_16x16x32_bf16 v[100:103], a[112:115], v[112:115], v[100:103]
 v_mfma_f32_16x16x32_bf16 v[80:83], v[112:115], v[176:179], v[80:83]
 v_mfma_f32_16x16x32_bf16 v[88:91], v[112:115], v[240:243], v[88:91]
 ds_read_b128 v[112:115], v0 offset:14336
 v_mfma_f32_16x16x32_bf16 v[72:75], a[176:179], v[116:119], v[72:75]
 v_mfma_f32_16x16x32_bf16 v[76:79], a[240:243], v[116:119], v[76:79]
 v_mfma_f32_16x16x32_bf16 v[104:107], a[48:51], v[116:119], v[104:107]
 v_mfma_f32_16x16x32_bf16 v[108:111], a[112:115], v[116:119], v[108:111]
 v_mfma_f32_16x16x32_bf16 v[84:87], v[116:119], v[176:179], v[84:87]
 v_mfma_f32_16x16x32_bf16 v[92:95], v[116:119], v[240:243], v[92:95]
 ds_read_b128 v[116:119], v0 offset:30720
 s_waitcnt lgkmcnt(2)
 v_mfma_f32_16x16x32_bf16 v[64:67], a[180:183], v[120:123], v[64:67]
 v_mfma_f32_16x16x32_bf16 v[68:71], a[244:247], v[120:123], v[68:71]
 v_mfma_f32_16x16x32_bf16 v[96:99], a[52:55], v[120:123], v[96:99]
 v_mfma_f32_16x16x32_bf16 v[100:103], a[116:119], v[120:123], v[100:103]
 v_mfma_f32_16x16x32_bf16 v[80:83], v[120:123], v[180:183], v[80:83]
 v_mfma_f32_16x16x32_bf16 v[88:91], v[120:123], v[244:247], v[88:91]
 ds_read_b128 v[120:123], v11 offset:14336
 v_mfma_f32_16x16x32_bf16 v[72:75], a[180:183], v[124:127], v[72:75]
 v_mfma_f32_16x16x32_bf16 v[76:79], a[244:247], v[124:127], v[76:79]
 v_mfma_f32_16x16x32_bf16 v[104:107], a[52:55], v[124:127], v[104:107]
 v_mfma_f32_16x16x32_bf16 v[108:111], a[116:119], v[124:127], v[108:111]
 v_mfma_f32_16x16x32_bf16 v[84:87], v[124:127], v[180:183], v[84:87]
 v_mfma_f32_16x16x32_bf16 v[92:95], v[124:127], v[244:247], v[92:95]
 ds_read_b128 v[124:127], v11 offset:30720
 s_waitcnt lgkmcnt(2)
 v_mfma_f32_16x16x32_bf16 v[64:67], a[184:187], v[112:115], v[64:67]
 v_mfma_f32_16x16x32_bf16 v[68:71], a[248:251], v[112:115], v[68:71]
 v_mfma_f32_16x16x32_bf16 v[96:99], a[56:59], v[112:115], v[96:99]
 v_mfma_f32_16x16x32_bf16 v[100:103], a[120:123], v[112:115], v[100:103]
 v_mfma_f32_16x16x32_bf16 v[80:83], v[112:115], v[184:187], v[80:83]
 v_mfma_f32_16x16x32_bf16 v[88:91], v[112:115], v[248:251], v[88:91]
 v_mfma_f32_16x16x32_bf16 v[72:75], a[184:187], v[116:119], v[72:75]
 v_mfma_f32_16x16x32_bf16 v[76:79], a[248:251], v[116:119], v[76:79]
 v_mfma_f32_16x16x32_bf16 v[104:107], a[56:59], v[116:119], v[104:107]
 v_mfma_f32_16x16x32_bf16 v[108:111], a[120:123], v[116:119], v[108:111]
 v_mfma_f32_16x16x32_bf16 v[84:87], v[116:119], v[184:187], v[84:87]
 v_mfma_f32_16x16x32_bf16 v[92:95], v[116:119], v[248:251], v[92:95]
 s_waitcnt lgkmcnt(0)
 v_mfma_f32_16x16x32_bf16 v[64:67], a[188:191], v[120:123], v[64:67]
 v_mfma_f32_16x16x32_bf16 v[68:71], a[252:255], v[120:123], v[68:71]
 v_mfma_f32_16x16x32_bf16 v[96:99], a[60:63], v[120:123], v[96:99]
 v_mfma_f32_16x16x32_bf16 v[100:103], a[124:127], v[120:123], v[100:103]
 v_mfma_f32_16x16x32_bf16 v[80:83], v[120:123], v[188:191], v[80:83]
 v_mfma_f32_16x16x32_bf16 v[88:91], v[120:123], v[252:255], v[88:91]
 v_mfma_f32_16x16x32_bf16 v[72:75], a[188:191], v[124:127], v[72:75]
 v_mfma_f32_16x16x32_bf16 v[76:79], a[252:255], v[124:127], v[76:79]
 v_mfma_f32_16x16x32_bf16 v[104:107], a[60:63], v[124:127], v[104:107]
 v_mfma_f32_16x16x32_bf16 v[108:111], a[124:127], v[124:127], v[108:111]
 v_mfma_f32_16x16x32_bf16 v[84:87], v[124:127], v[188:191], v[84:87]
 v_mfma_f32_16x16x32_bf16 v[92:95], v[124:127], v[252:255], v[92:95]
 s_lshl_b32 s24, s17, 10
 s_add_u32 s24, s24, s40
 s_add_u32 s25, s24, 4096
 s_lshl_b32 s26, s17, 11
 s_add_u32 s26, s26, s40
 s_add_u32 s26, s26, 8192
 s_nop 1
 v_cvt_pk_bf16_f32 v16, v64, v65
 v_cvt_pk_bf16_f32 v17, v66, v67
 v_cvt_pk_bf16_f32 v18, v68, v69
 v_cvt_pk_bf16_f32 v19, v70, v71
 buffer_store_dwordx4 v[16:19], v1, s[4:7], s24 offen offset:0 sc1
 v_cvt_pk_bf16_f32 v32, v96, v97
 v_cvt_pk_bf16_f32 v33, v98, v99
 v_cvt_pk_bf16_f32 v34, v100, v101
 v_cvt_pk_bf16_f32 v35, v102, v103
 v_cvt_pk_bf16_f32 v20, v72, v73
 v_cvt_pk_bf16_f32 v21, v74, v75
 v_cvt_pk_bf16_f32 v22, v76, v77
 v_cvt_pk_bf16_f32 v23, v78, v79
 buffer_store_dwordx4 v[20:23], v1, s[4:7], s25 offen offset:0 sc1
 v_cvt_pk_bf16_f32 v36, v104, v105
 v_cvt_pk_bf16_f32 v37, v106, v107
 v_cvt_pk_bf16_f32 v38, v108, v109
 v_cvt_pk_bf16_f32 v39, v110, v111
 v_cvt_pk_bf16_f32 v24, v80, v81
 v_cvt_pk_bf16_f32 v25, v82, v83
 v_cvt_pk_bf16_f32 v26, v84, v85
 v_cvt_pk_bf16_f32 v27, v86, v87
 buffer_store_dwordx4 v[24:27], v1, s[4:7], s26 offen offset:0 sc1
 v_cvt_pk_bf16_f32 v28, v88, v89
 v_cvt_pk_bf16_f32 v29, v90, v91
 v_cvt_pk_bf16_f32 v30, v92, v93
 v_cvt_pk_bf16_f32 v31, v94, v95
 buffer_store_dwordx4 v[28:31], v1, s[4:7], s26 offen offset:1024 sc1
L_tent_36:
 s_lshl_b32 s24, s18, 5
 s_add_u32 s24, s24, s19
 s_mul_i32 s32, s19, 129
 s_add_u32 s32, s32, s18
 s_lshl_b32 s32, s32, 12
 s_add_u32 s32, s32, 0x801000
 s_lshl_b32 s35, s24, 2
 s_add_u32 s35, s35, 0x116000
 s_lshl_b32 s34, s18, 20
 s_add_u32 s34, s34, 0x4000000
 s_lshl_b32 s24, s17, 10
 v_add_u32 v10, s24, v1
 v_add_u32 v11, s24, v10
 s_barrier
 ds_write_b128 v10, v[56:59] offset:0
 ds_write_b128 v10, v[40:43] offset:8192
 ds_write_b128 v11, v[48:51] offset:16384
 ds_write_b128 v10, v[60:63] offset:4096
 ds_write_b128 v10, v[44:47] offset:12288
 ds_write_b128 v11, v[52:55] offset:17408
 s_and_b32 s24, s17, 1
 s_lshl_b32 s24, s24, 12
 v_add_u32 v10, s24, v1
 s_lshr_b32 s24, s17, 1
 s_lshl_b32 s24, s24, 12
 v_add_u32 v11, s24, v1
 s_waitcnt lgkmcnt(0)
 s_barrier
 ds_read_b128 v[40:43], v10 offset:0
 ds_read_b128 v[64:67], v1 offset:8192
 ds_read_b128 v[80:83], v1 offset:12288
 ds_read_b128 v[44:47], v10 offset:1024
 ds_read_b128 v[68:71], v1 offset:9216
 ds_read_b128 v[84:87], v1 offset:13312
 ds_read_b128 v[48:51], v10 offset:2048
 ds_read_b128 v[72:75], v1 offset:10240
 ds_read_b128 v[88:91], v1 offset:14336
 ds_read_b128 v[52:55], v10 offset:3072
 ds_read_b128 v[76:79], v1 offset:11264
 ds_read_b128 v[92:95], v1 offset:15360
 s_waitcnt lgkmcnt(10)
 v_mfma_f32_16x16x32_bf16 v[96:99], v[64:67], v[40:43], 0
 s_waitcnt lgkmcnt(9)
 v_mfma_f32_16x16x32_bf16 v[100:103], v[80:83], v[40:43], 0
 ds_read_b128 v[108:111], v11 offset:16384
 s_waitcnt lgkmcnt(8)
 v_mfma_f32_16x16x32_bf16 v[96:99], v[68:71], v[44:47], v[96:99]
 s_waitcnt lgkmcnt(7)
 v_mfma_f32_16x16x32_bf16 v[100:103], v[84:87], v[44:47], v[100:103]
 ds_read_b128 v[112:115], v11 offset:17408
 s_waitcnt lgkmcnt(6)
 v_mfma_f32_16x16x32_bf16 v[96:99], v[72:75], v[48:51], v[96:99]
 s_waitcnt lgkmcnt(5)
 v_mfma_f32_16x16x32_bf16 v[100:103], v[88:91], v[48:51], v[100:103]
 ds_read_b128 v[116:119], v11 offset:18432
 s_waitcnt lgkmcnt(4)
 v_mfma_f32_16x16x32_bf16 v[96:99], v[76:79], v[52:55], v[96:99]
 s_waitcnt lgkmcnt(3)
 v_mfma_f32_16x16x32_bf16 v[100:103], v[92:95], v[52:55], v[100:103]
 ds_read_b128 v[120:123], v11 offset:19456
 s_lshl_b32 s25, s17, 10
 s_add_u32 s25, s25, s32
 s_lshr_b32 s26, s17, 1
 s_lshl_b32 s26, s26, 11
 s_add_u32 s26, s26, s32
 v_mov_b32 v12, 0xff800000
 s_waitcnt vmcnt(0)
 s_barrier
 s_cmp_eq_u32 s17, 0
 s_cbranch_scc0 L_kvf_38
 s_mov_b64 exec, 1
 v_mov_b32 v10, 2
 buffer_store_dword v10, off, s[4:7], s41 sc1
 s_mov_b64 exec, -1
L_kvf_38:
 s_add_u32 s36, s36, 4
 s_min_u32 s27, s36, 63
 s_lshl_b32 s27, s27, 7
 s_add_u32 s27, s27, 0x114000
 buffer_load_dword v9, v7, s[4:7], s27 offen sc1
 v_cndmask_b32 v96, v12, v96, s[60:61]
 v_cndmask_b32 v100, v12, v100, s[68:69]
 v_cndmask_b32 v97, v12, v97, s[62:63]
 v_cndmask_b32 v101, v12, v101, s[70:71]
 v_cndmask_b32 v98, v12, v98, s[64:65]
 v_cndmask_b32 v102, v12, v102, s[72:73]
 v_cndmask_b32 v99, v12, v99, s[66:67]
 v_cndmask_b32 v103, v12, v103, s[74:75]
 v_max3_f32 v14, v96, v97, v98
 v_max3_f32 v15, v100, v101, v102
 v_max3_f32 v14, v14, v99, v103
 v_mov_b32 v88, 0x3f803f80
 v_mov_b32 v89, 0x3f803f80
 v_mov_b32 v90, 0x3f803f80
 v_mov_b32 v91, 0x3f803f80
 v_mov_b32 v92, 0x3f003f00
 v_mov_b32 v93, 0x3f003f00
 s_mov_b32 s23, 0
L_km_39:
 buffer_load_dwordx2 v[56:57], v1, s[4:7], s25 offen sc1
 buffer_load_dwordx2 v[58:59], v1, s[4:7], s26 offen offset:8 sc1
 buffer_load_dwordx2 v[60:61], v1, s[4:7], s26 offen offset:1032 sc1
 s_add_u32 s23, s23, 1
 s_cmp_gt_u32 s23, 262144
 s_cbranch_scc1 L_bail
 s_waitcnt vmcnt(0)
 ds_write_b64 v5, v[56:57]
 v_cmp_eq_u32 s[92:93], s39, v56
 v_cmp_eq_u32 vcc, s39, v57
 s_or_b64 s[92:93], s[92:93], vcc
 v_cmp_eq_u32 vcc, s39, v58
 s_or_b64 s[92:93], s[92:93], vcc
 v_cmp_eq_u32 vcc, s39, v59
 s_or_b64 s[92:93], s[92:93], vcc
 v_cmp_eq_u32 vcc, s39, v60
 s_or_b64 s[92:93], s[92:93], vcc
 v_cmp_eq_u32 vcc, s39, v61
 s_or_b64 s[92:93], s[92:93], vcc
 s_cbranch_scc0 L_km_39_ok
 s_sleep 1
 s_branch L_km_39
L_km_39_ok:
 v_cndmask_b32 v80, 0, v58, s[28:29]
 v_cndmask_b32 v82, 0, v58, s[30:31]
 v_cndmask_b32 v81, 0, v59, s[28:29]
 v_cndmask_b32 v83, 0, v59, s[30:31]
 v_cndmask_b32 v84, 0, v60, s[28:29]
 v_cndmask_b32 v86, 0, v60, s[30:31]
 v_cndmask_b32 v85, 0, v61, s[28:29]
 v_cndmask_b32 v87, 0, v61, s[30:31]
 s_waitcnt lgkmcnt(0)
 s_barrier
 ds_read_b64_tr_b16 v[64:65], v6 offset:0
 ds_read_b64_tr_b16 v[66:67], v6 offset:32
 ds_read_b64_tr_b16 v[68:69], v6 offset:256
 ds_read_b64_tr_b16 v[70:71], v6 offset:288
 ds_read_b64_tr_b16 v[72:73], v6 offset:512
 ds_read_b64_tr_b16 v[74:75], v6 offset:544
 ds_read_b64_tr_b16 v[76:77], v6 offset:768
 ds_read_b64_tr_b16 v[78:79], v6 offset:800
 s_and_b32 s24, s17, 1
 s_lshl_b32 s24, s24, 12
 s_lshr_b32 s25, s17, 1
 s_lshl_b32 s25, s25, 11
 s_add_u32 s24, s24, s25
 v_add_u32 v10, s24, v1
 s_waitcnt lgkmcnt(6)
 v_mfma_f32_16x16x32_bf16 v[104:107], v[64:67], v[40:43], 0
 s_waitcnt lgkmcnt(4)
 v_mfma_f32_16x16x32_bf16 v[104:107], v[68:71], v[44:47], v[104:107]
 s_waitcnt lgkmcnt(2)
 v_mfma_f32_16x16x32_bf16 v[104:107], v[72:75], v[48:51], v[104:107]
 s_waitcnt lgkmcnt(0)
 v_mfma_f32_16x16x32_bf16 v[104:107], v[76:79], v[52:55], v[104:107]
 s_nop 7
 v_max3_f32 v15, v15, v104, v105
 v_max3_f32 v14, v14, v106, v107
 v_max_f32 v14, v14, v15
 v_mov_b32 v15, v14
 s_nop 1
 v_permlane16_swap_b32 v15, v14
 v_max_f32 v14, v14, v15
 v_mov_b32 v15, v14
 s_nop 1
 v_permlane32_swap_b32 v15, v14
 v_max_f32 v14, v14, v15
 v_mul_f32 v14, s33, v14
 v_fma_f32 v96, v96, s33, -v14
 v_fma_f32 v97, v97, s33, -v14
 v_fma_f32 v98, v98, s33, -v14
 v_fma_f32 v99, v99, s33, -v14
 v_fma_f32 v100, v100, s33, -v14
 v_fma_f32 v101, v101, s33, -v14
 v_fma_f32 v102, v102, s33, -v14
 v_fma_f32 v103, v103, s33, -v14
 v_fma_f32 v104, v104, s33, -v14
 v_fma_f32 v105, v105, s33, -v14
 v_fma_f32 v106, v106, s33, -v14
 v_fma_f32 v107, v107, s33, -v14
 v_exp_f32 v96, v96
 v_exp_f32 v97, v97
 v_exp_f32 v98, v98
 v_exp_f32 v99, v99
 v_exp_f32 v100, v100
 v_exp_f32 v101, v101
 v_exp_f32 v102, v102
 v_exp_f32 v103, v103
 v_exp_f32 v104, v104
 v_exp_f32 v105, v105
 v_exp_f32 v106, v106
 v_exp_f32 v107, v107
 v_cvt_pk_bf16_f32 v40, v96, v97
 v_cvt_pk_bf16_f32 v41, v98, v99
 v_cvt_pk_bf16_f32 v42, v100, v101
 v_cvt_pk_bf16_f32 v43, v102, v103
 v_cvt_pk_bf16_f32 v44, v104, v105
 v_cvt_pk_bf16_f32 v45, v106, v107
 s_nop 1
 v_mfma_f32_16x16x32_bf16 v[48:51], v[88:91], v[40:43], 0
 v_mfma_f32_16x16x32_bf16 v[64:67], v[108:111], v[40:43], 0
 v_mfma_f32_16x16x32_bf16 v[68:71], v[112:115], v[40:43], 0
 v_mfma_f32_16x16x32_bf16 v[72:75], v[116:119], v[40:43], 0
 v_mfma_f32_16x16x32_bf16 v[76:79], v[120:123], v[40:43], 0
 s_nop 1
 v_mfma_f32_16x16x16_bf16 v[48:51], v[92:93], v[44:45], v[48:51]
 v_mfma_f32_16x16x16_bf16 v[64:67], v[80:81], v[44:45], v[64:67]
 v_mfma_f32_16x16x16_bf16 v[68:71], v[82:83], v[44:45], v[68:71]
 v_mfma_f32_16x16x16_bf16 v[72:75], v[84:85], v[44:45], v[72:75]
 v_mfma_f32_16x16x16_bf16 v[76:79], v[86:87], v[44:45], v[76:79]
 ds_read_b128 v[104:107], v3 offset:0
 ds_read_b128 v[108:111], v3 offset:1024
 ds_read_b128 v[112:115], v3 offset:8192
 s_nop 0
 v_rcp_f32 v48, v48
 s_nop 0
 v_mul_f32 v64, v64, v48
 v_mul_f32 v65, v65, v48
 v_mul_f32 v66, v66, v48
 v_mul_f32 v67, v67, v48
 v_mul_f32 v68, v68, v48
 v_mul_f32 v69, v69, v48
 v_mul_f32 v70, v70, v48
 v_mul_f32 v71, v71, v48
 v_cvt_pk_bf16_f32 v52, v64, v65
 v_cvt_pk_bf16_f32 v53, v66, v67
 v_cvt_pk_bf16_f32 v54, v68, v69
 v_cvt_pk_bf16_f32 v55, v70, v71
 ds_write_b128 v10, v[52:55] offset:0
 v_mul_f32 v72, v72, v48
 v_mul_f32 v73, v73, v48
 v_mul_f32 v74, v74, v48
 v_mul_f32 v75, v75, v48
 v_mul_f32 v76, v76, v48
 v_mul_f32 v77, v77, v48
 v_mul_f32 v78, v78, v48
 v_mul_f32 v79, v79, v48
 v_cvt_pk_bf16_f32 v56, v72, v73
 v_cvt_pk_bf16_f32 v57, v74, v75
 v_cvt_pk_bf16_f32 v58, v76, v77
 v_cvt_pk_bf16_f32 v59, v78, v79
 ds_write_b128 v10, v[56:59] offset:1024
 s_waitcnt lgkmcnt(0)
 s_barrier
 ds_read_b128 v[40:43], v1 offset:0
 ds_read_b128 v[56:59], v1 offset:4096
 ds_read_b128 v[44:47], v1 offset:1024
 ds_read_b128 v[60:63], v1 offset:5120
 ds_read_b128 v[48:51], v1 offset:2048
 ds_read_b128 v[64:67], v1 offset:6144
 ds_read_b128 v[52:55], v1 offset:3072
 ds_read_b128 v[68:71], v1 offset:7168
 s_waitcnt lgkmcnt(6)
 v_mfma_f32_16x16x32_bf16 v[72:75], v[104:107], v[40:43], 0
 ds_read_b128 v[116:119], v3 offset:9216
 v_mfma_f32_16x16x32_bf16 v[80:83], v[104:107], v[56:59], 0
 v_mfma_f32_16x16x32_bf16 v[76:79], v[108:111], v[40:43], 0
 ds_read_b128 v[104:107], v3 offset:16384
 v_mfma_f32_16x16x32_bf16 v[84:87], v[108:111], v[56:59], 0
 s_waitcnt lgkmcnt(6)
 v_mfma_f32_16x16x32_bf16 v[72:75], v[112:115], v[44:47], v[72:75]
 ds_read_b128 v[108:111], v3 offset:17408
 v_mfma_f32_16x16x32_bf16 v[80:83], v[112:115], v[60:63], v[80:83]
 s_waitcnt lgkmcnt(2)
 v_mfma_f32_16x16x32_bf16 v[76:79], v[116:119], v[44:47], v[76:79]
 ds_read_b128 v[112:115], v3 offset:24576
 v_mfma_f32_16x16x32_bf16 v[84:87], v[116:119], v[60:63], v[84:87]
 s_waitcnt lgkmcnt(2)
 v_mfma_f32_16x16x32_bf16 v[72:75], v[104:107], v[48:51], v[72:75]
 ds_read_b128 v[116:119], v3 offset:25600
 v_mfma_f32_16x16x32_bf16 v[80:83], v[104:107], v[64:67], v[80:83]
 s_waitcnt lgkmcnt(2)
 v_mfma_f32_16x16x32_bf16 v[76:79], v[108:111], v[48:51], v[76:79]
 ds_read_b128 v[104:107], v3 offset:2048
 v_mfma_f32_16x16x32_bf16 v[84:87], v[108:111], v[64:67], v[84:87]
 s_waitcnt lgkmcnt(2)
 v_mfma_f32_16x16x32_bf16 v[72:75], v[112:115], v[52:55], v[72:75]
 ds_read_b128 v[108:111], v3 offset:3072
 v_mfma_f32_16x16x32_bf16 v[80:83], v[112:115], v[68:71], v[80:83]
 s_waitcnt lgkmcnt(2)
 v_mfma_f32_16x16x32_bf16 v[76:79], v[116:119], v[52:55], v[76:79]
 ds_read_b128 v[112:115], v3 offset:10240
 v_mfma_f32_16x16x32_bf16 v[84:87], v[116:119], v[68:71], v[84:87]
 s_waitcnt lgkmcnt(2)
 v_mfma_f32_16x16x32_bf16 v[88:91], v[104:107], v[40:43], 0
 ds_read_b128 v[116:119], v3 offset:11264
 s_barrier
 s_lshl_b32 s37, s36, 15
 s_lshl_b32 s24, s17, 8
 s_add_u32 s37, s37, s24
 s_add_u32 s37, s37, 0x200000
 s_lshl_b32 s24, s36, 5
 s_add_u32 s24, s24, s19
 s_lshl_b32 s41, s24, 2
 s_mul_i32 s40, s19, 65
 s_add_u32 s40, s40, s36
 s_lshl_b32 s40, s40, 14
 s_add_u32 s40, s40, 0x1c00000
 s_mul_i32 s42, s19, 129
 s_add_u32 s42, s42, s36
 s_lshl_b32 s42, s42, 12
 s_add_u32 s42, s42, 0x801000
 s_add_u32 s41, s41, 0x110000
 s_lshl_b32 s43, s36, 7
 s_add_u32 s43, s43, 0x114000
 s_cmp_lt_u32 s36, 64
 s_cselect_b32 s46, 1, 0
 s_cbranch_scc0 L_h1ok_41
 v_cmp_eq_u32 vcc, 0, v9
 s_cbranch_vccz L_h1ok_41
 s_mov_b32 s23, 0
L_wline_42:
 buffer_load_dword v9, v7, s[4:7], s43 offen sc1
 s_add_u32 s23, s23, 1
 s_cmp_gt_u32 s23, 262144
 s_cbranch_scc1 L_bail
 s_waitcnt vmcnt(0)
 v_cmp_gt_u32 vcc, 1, v9
 s_cbranch_vccz L_wline_42_ok
 s_sleep 2
 s_branch L_wline_42
L_wline_42_ok:
L_h1ok_41:
 v_mfma_f32_16x16x32_bf16 v[96:99], v[104:107], v[56:59], 0
 s_waitcnt lgkmcnt(2)
 v_mfma_f32_16x16x32_bf16 v[92:95], v[108:111], v[40:43], 0
 ds_read_b128 v[104:107], v3 offset:18432
 v_cvt_pk_bf16_f32 v120, v72, v73
 v_mfma_f32_16x16x32_bf16 v[100:103], v[108:111], v[56:59], 0
 v_cvt_pk_bf16_f32 v121, v74, v75
 s_waitcnt lgkmcnt(2)
 v_mfma_f32_16x16x32_bf16 v[88:91], v[112:115], v[44:47], v[88:91]
 ds_read_b128 v[108:111], v3 offset:19456
 v_cvt_pk_bf16_f32 v122, v76, v77
 v_mfma_f32_16x16x32_bf16 v[96:99], v[112:115], v[60:63], v[96:99]
 v_cvt_pk_bf16_f32 v123, v78, v79
 s_waitcnt lgkmcnt(2)
 v_mfma_f32_16x16x32_bf16 v[92:95], v[116:119], v[44:47], v[92:95]
 ds_read_b128 v[112:115], v3 offset:26624
 s_add_u32 s27, s34, 0
 buffer_store_dwordx4 v[120:123], v4, s[4:7], s27 offen offset:0 sc1
 v_mfma_f32_16x16x32_bf16 v[100:103], v[116:119], v[60:63], v[100:103]
 v_cvt_pk_bf16_f32 v124, v80, v81
 s_waitcnt lgkmcnt(2)
 v_mfma_f32_16x16x32_bf16 v[88:91], v[104:107], v[48:51], v[88:91]
 ds_read_b128 v[116:119], v3 offset:27648
 v_cvt_pk_bf16_f32 v125, v82, v83
 v_mfma_f32_16x16x32_bf16 v[96:99], v[104:107], v[64:67], v[96:99]
 v_cvt_pk_bf16_f32 v126, v84, v85
 s_waitcnt lgkmcnt(2)
 v_mfma_f32_16x16x32_bf16 v[92:95], v[108:111], v[48:51], v[92:95]
 ds_read_b128 v[104:107], v3 offset:4096
 v_cvt_pk_bf16_f32 v127, v86, v87
 v_mfma_f32_16x16x32_bf16 v[100:103], v[108:111], v[64:67], v[100:103]
 s_add_u32 s27, s34, 524288
 buffer_store_dwordx4 v[124:127], v4, s[4:7], s27 offen offset:0 sc1
 s_waitcnt lgkmcnt(2)
 v_mfma_f32_16x16x32_bf16 v[88:91], v[112:115], v[52:55], v[88:91]
 ds_read_b128 v[108:111], v3 offset:5120
 s_cmp_eq_u32 s46, 1
 s_cbranch_scc0 L_sd_43
 s_add_u32 m0, s38, 0
 s_add_u32 s24, s37, 0
 buffer_load_dwordx4 v2, s[4:7], s24 offen sc1 lds
L_sd_43:
 v_mfma_f32_16x16x32_bf16 v[96:99], v[112:115], v[68:71], v[96:99]
 s_waitcnt lgkmcnt(2)
 v_mfma_f32_16x16x32_bf16 v[92:95], v[116:119], v[52:55], v[92:95]
 ds_read_b128 v[112:115], v3 offset:12288
 s_cmp_eq_u32 s46, 1
 s_cbranch_scc0 L_sd_44
 s_add_u32 m0, s38, 1024
 s_add_u32 s24, s37, 0
 buffer_load_dwordx4 v8, s[4:7], s24 offen sc1 lds
L_sd_44:
 v_mfma_f32_16x16x32_bf16 v[100:103], v[116:119], v[68:71], v[100:103]
 s_waitcnt lgkmcnt(2)
 v_mfma_f32_16x16x32_bf16 v[72:75], v[104:107], v[40:43], 0
 ds_read_b128 v[116:119], v3 offset:13312
 v_mfma_f32_16x16x32_bf16 v[80:83], v[104:107], v[56:59], 0
 s_waitcnt lgkmcnt(2)
 v_mfma_f32_16x16x32_bf16 v[76:79], v[108:111], v[40:43], 0
 ds_read_b128 v[104:107], v3 offset:20480
 v_cvt_pk_bf16_f32 v120, v88, v89
 v_mfma_f32_16x16x32_bf16 v[84:87], v[108:111], v[56:59], 0
 v_cvt_pk_bf16_f32 v121, v90, v91
 s_waitcnt lgkmcnt(2)
 v_mfma_f32_16x16x32_bf16 v[72:75], v[112:115], v[44:47], v[72:75]
 ds_read_b128 v[108:111], v3 offset:21504
 v_cvt_pk_bf16_f32 v122, v92, v93
 v_mfma_f32_16x16x32_bf16 v[80:83], v[112:115], v[60:63], v[80:83]
 v_cvt_pk_bf16_f32 v123, v94, v95
 s_waitcnt lgkmcnt(2)
 v_mfma_f32_16x16x32_bf16 v[76:79], v[116:119], v[44:47], v[76:79]
 ds_read_b128 v[112:115], v3 offset:28672
 s_add_u32 s27, s34, 0
 buffer_store_dwordx4 v[120:123], v4, s[4:7], s27 offen offset:64 sc1
 v_mfma_f32_16x16x32_bf16 v[84:87], v[116:119], v[60:63], v[84:87]
 v_cvt_pk_bf16_f32 v124, v96, v97
 s_waitcnt lgkmcnt(2)
 v_mfma_f32_16x16x32_bf16 v[72:75], v[104:107], v[48:51], v[72:75]
 ds_read_b128 v[116:119], v3 offset:29696
 v_cvt_pk_bf16_f32 v125, v98, v99
 v_mfma_f32_16x16x32_bf16 v[80:83], v[104:107], v[64:67], v[80:83]
 v_cvt_pk_bf16_f32 v126, v100, v101
 s_waitcnt lgkmcnt(2)
 v_mfma_f32_16x16x32_bf16 v[76:79], v[108:111], v[48:51], v[76:79]
 ds_read_b128 v[104:107], v3 offset:6144
 v_cvt_pk_bf16_f32 v127, v102, v103
 v_mfma_f32_16x16x32_bf16 v[84:87], v[108:111], v[64:67], v[84:87]
 s_add_u32 s27, s34, 524288
 buffer_store_dwordx4 v[124:127], v4, s[4:7], s27 offen offset:64 sc1
 s_waitcnt lgkmcnt(2)
 v_mfma_f32_16x16x32_bf16 v[72:75], v[112:115], v[52:55], v[72:75]
 ds_read_b128 v[108:111], v3 offset:7168
 s_cmp_eq_u32 s46, 1
 s_cbranch_scc0 L_sd_45
 s_add_u32 m0, s38, 2048
 s_add_u32 s24, s37, 128
 buffer_load_dwordx4 v2, s[4:7], s24 offen sc1 lds
L_sd_45:
 v_mfma_f32_16x16x32_bf16 v[80:83], v[112:115], v[68:71], v[80:83]
 s_cmp_eq_u32 s46, 1
 s_cbranch_scc0 L_sd_46
 s_add_u32 m0, s38, 3072
 s_add_u32 s24, s37, 128
 buffer_load_dwordx4 v8, s[4:7], s24 offen sc1 lds
L_sd_46:
 s_waitcnt lgkmcnt(2)
 v_mfma_f32_16x16x32_bf16 v[76:79], v[116:119], v[52:55], v[76:79]
 ds_read_b128 v[112:115], v3 offset:14336
 s_cmp_eq_u32 s46, 1
 s_cbranch_scc0 L_sd_47
 s_add_u32 m0, s38, 16384
 s_add_u32 s24, s37, 16384
 buffer_load_dwordx4 v2, s[4:7], s24 offen sc1 lds
L_sd_47:
 v_mfma_f32_16x16x32_bf16 v[84:87], v[116:119], v[68:71], v[84:87]
 s_cmp_eq_u32 s46, 1
 s_cbranch_scc0 L_sd_48
 s_add_u32 m0, s38, 17408
 s_add_u32 s24, s37, 16384
 buffer_load_dwordx4 v8, s[4:7], s24 offen sc1 lds
L_sd_48:
 s_waitcnt lgkmcnt(2)
 v_mfma_f32_16x16x32_bf16 v[88:91], v[104:107], v[40:43], 0
 ds_read_b128 v[116:119], v3 offset:15360
 s_cmp_eq_u32 s46, 1
 s_cbranch_scc0 L_sd_49
 s_add_u32 m0, s38, 18432
 s_add_u32 s24, s37, 16512
 buffer_load_dwordx4 v2, s[4:7], s24 offen sc1 lds
L_sd_49:
 v_mfma_f32_16x16x32_bf16 v[96:99], v[104:107], v[56:59], 0
 s_cmp_eq_u32 s46, 1
 s_cbranch_scc0 L_sd_50
 s_add_u32 m0, s38, 19456
 s_add_u32 s24, s37, 16512
 buffer_load_dwordx4 v8, s[4:7], s24 offen sc1 lds
L_sd_50:
 s_waitcnt lgkmcnt(2)
 v_mfma_f32_16x16x32_bf16 v[92:95], v[108:111], v[40:43], 0
 ds_read_b128 v[104:107], v3 offset:22528
 v_cvt_pk_bf16_f32 v120, v72, v73
 v_mfma_f32_16x16x32_bf16 v[100:103], v[108:111], v[56:59], 0
 v_cvt_pk_bf16_f32 v121, v74, v75
 s_waitcnt lgkmcnt(2)
 v_mfma_f32_16x16x32_bf16 v[88:91], v[112:115], v[44:47], v[88:91]
 ds_read_b128 v[108:111], v3 offset:23552
 v_cvt_pk_bf16_f32 v122, v76, v77
 v_mfma_f32_16x16x32_bf16 v[96:99], v[112:115], v[60:63], v[96:99]
 v_cvt_pk_bf16_f32 v123, v78, v79
 s_waitcnt lgkmcnt(2)
 v_mfma_f32_16x16x32_bf16 v[92:95], v[116:119], v[44:47], v[92:95]
 ds_read_b128 v[112:115], v3 offset:30720
 s_add_u32 s27, s34, 0
 buffer_store_dwordx4 v[120:123], v4, s[4:7], s27 offen offset:128 sc1
 v_mfma_f32_16x16x32_bf16 v[100:103], v[116:119], v[60:63], v[100:103]
 v_cvt_pk_bf16_f32 v124, v80, v81
 s_waitcnt lgkmcnt(2)
 v_mfma_f32_16x16x32_bf16 v[88:91], v[104:107], v[48:51], v[88:91]
 ds_read_b128 v[116:119], v3 offset:31744
 v_cvt_pk_bf16_f32 v125, v82, v83
 v_mfma_f32_16x16x32_bf16 v[96:99], v[104:107], v[64:67], v[96:99]
 v_cvt_pk_bf16_f32 v126, v84, v85
 s_waitcnt lgkmcnt(2)
 v_mfma_f32_16x16x32_bf16 v[92:95], v[108:111], v[48:51], v[92:95]
 v_cvt_pk_bf16_f32 v127, v86, v87
 v_mfma_f32_16x16x32_bf16 v[100:103], v[108:111], v[64:67], v[100:103]
 s_add_u32 s27, s34, 524288
 buffer_store_dwordx4 v[124:127], v4, s[4:7], s27 offen offset:128 sc1
 s_waitcnt lgkmcnt(1)
 v_mfma_f32_16x16x32_bf16 v[88:91], v[112:115], v[52:55], v[88:91]
 v_mfma_f32_16x16x32_bf16 v[96:99], v[112:115], v[68:71], v[96:99]
 s_waitcnt lgkmcnt(0)
 v_mfma_f32_16x16x32_bf16 v[92:95], v[116:119], v[52:55], v[92:95]
 v_mfma_f32_16x16x32_bf16 v[100:103], v[116:119], v[68:71], v[100:103]
 s_nop 7
 v_cvt_pk_bf16_f32 v120, v88, v89
 v_cvt_pk_bf16_f32 v121, v90, v91
 v_cvt_pk_bf16_f32 v122, v92, v93
 v_cvt_pk_bf16_f32 v123, v94, v95
 s_add_u32 s27, s34, 0
 buffer_store_dwordx4 v[120:123], v4, s[4:7], s27 offen offset:192 sc1
 v_cvt_pk_bf16_f32 v124, v96, v97
 v_cvt_pk_bf16_f32 v125, v98, v99
 v_cvt_pk_bf16_f32 v126, v100, v101
 v_cvt_pk_bf16_f32 v127, v102, v103
 s_add_u32 s27, s34, 524288
 buffer_store_dwordx4 v[124:127], v4, s[4:7], s27 offen offset:192 sc1
 v_mov_b64 v[40:41], v[16:17]
 v_mov_b64 v[42:43], v[18:19]
 v_mov_b64 v[44:45], v[20:21]
 v_mov_b64 v[46:47], v[22:23]
 v_mov_b64 v[48:49], v[24:25]
 v_mov_b64 v[50:51], v[26:27]
 v_mov_b64 v[52:53], v[28:29]
 v_mov_b64 v[54:55], v[30:31]
 v_mov_b64 v[56:57], v[32:33]
 v_mov_b64 v[58:59], v[34:35]
 v_mov_b64 v[60:61], v[36:37]
 v_mov_b64 v[62:63], v[38:39]
 s_waitcnt vmcnt(0)
 s_barrier
 s_cmp_eq_u32 s17, 0
 s_cbranch_scc0 L_p2f_51
 s_mov_b64 exec, 1
 v_mov_b32 v10, 2
 buffer_store_dword v10, off, s[4:7], s35 sc1
 s_mov_b64 exec, -1
L_p2f_51:
 s_add_u32 s18, s18, 4
 s_cmp_lt_u32 s36, 64
 s_cbranch_scc1 L_tloop_35
 s_lshl_b32 s24, s18, 5
 s_add_u32 s24, s24, s19
 s_mul_i32 s32, s19, 129
 s_add_u32 s32, s32, s18
 s_lshl_b32 s32, s32, 12
 s_add_u32 s32, s32, 0x801000
 s_lshl_b32 s35, s24, 2
 s_add_u32 s35, s35, 0x116000
 s_lshl_b32 s34, s18, 20
 s_add_u32 s34, s34, 0x4000000
 s_lshl_b32 s24, s17, 10
 v_add_u32 v10, s24, v1
 v_add_u32 v11, s24, v10
 s_barrier
 ds_write_b128 v10, v[56:59] offset:0
 ds_write_b128 v10, v[40:43] offset:8192
 ds_write_b128 v11, v[48:51] offset:16384
 ds_write_b128 v10, v[60:63] offset:4096
 ds_write_b128 v10, v[44:47] offset:12288
 ds_write_b128 v11, v[52:55] offset:17408
 s_and_b32 s24, s17, 1
 s_lshl_b32 s24, s24, 12
 v_add_u32 v10, s24, v1
 s_lshr_b32 s24, s17, 1
 s_lshl_b32 s24, s24, 12
 v_add_u32 v11, s24, v1
 s_waitcnt lgkmcnt(0)
 s_barrier
 ds_read_b128 v[40:43], v10 offset:0
 ds_read_b128 v[64:67], v1 offset:8192
 ds_read_b128 v[80:83], v1 offset:12288
 ds_read_b128 v[44:47], v10 offset:1024
 ds_read_b128 v[68:71], v1 offset:9216
 ds_read_b128 v[84:87], v1 offset:13312
 ds_read_b128 v[48:51], v10 offset:2048
 ds_read_b128 v[72:75], v1 offset:10240
 ds_read_b128 v[88:91], v1 offset:14336
 ds_read_b128 v[52:55], v10 offset:3072
 ds_read_b128 v[76:79], v1 offset:11264
 ds_read_b128 v[92:95], v1 offset:15360
 s_waitcnt lgkmcnt(10)
 v_mfma_f32_16x16x32_bf16 v[96:99], v[64:67], v[40:43], 0
 s_waitcnt lgkmcnt(9)
 v_mfma_f32_16x16x32_bf16 v[100:103], v[80:83], v[40:43], 0
 ds_read_b128 v[108:111], v11 offset:16384
 s_waitcnt lgkmcnt(8)
 v_mfma_f32_16x16x32_bf16 v[96:99], v[68:71], v[44:47], v[96:99]
 s_waitcnt lgkmcnt(7)
 v_mfma_f32_16x16x32_bf16 v[100:103], v[84:87], v[44:47], v[100:103]
 ds_read_b128 v[112:115], v11 offset:17408
 s_waitcnt lgkmcnt(6)
 v_mfma_f32_16x16x32_bf16 v[96:99], v[72:75], v[48:51], v[96:99]
 s_waitcnt lgkmcnt(5)
 v_mfma_f32_16x16x32_bf16 v[100:103], v[88:91], v[48:51], v[100:103]
 ds_read_b128 v[116:119], v11 offset:18432
 s_waitcnt lgkmcnt(4)
 v_mfma_f32_16x16x32_bf16 v[96:99], v[76:79], v[52:55], v[96:99]
 s_waitcnt lgkmcnt(3)
 v_mfma_f32_16x16x32_bf16 v[100:103], v[92:95], v[52:55], v[100:103]
 ds_read_b128 v[120:123], v11 offset:19456
 s_lshl_b32 s25, s17, 10
 s_add_u32 s25, s25, s32
 s_lshr_b32 s26, s17, 1
 s_lshl_b32 s26, s26, 11
 s_add_u32 s26, s26, s32
 v_mov_b32 v12, 0xff800000
 s_nop 4
 v_cndmask_b32 v96, v12, v96, s[60:61]
 v_cndmask_b32 v100, v12, v100, s[68:69]
 v_cndmask_b32 v97, v12, v97, s[62:63]
 v_cndmask_b32 v101, v12, v101, s[70:71]
 v_cndmask_b32 v98, v12, v98, s[64:65]
 v_cndmask_b32 v102, v12, v102, s[72:73]
 v_cndmask_b32 v99, v12, v99, s[66:67]
 v_cndmask_b32 v103, v12, v103, s[74:75]
 v_max3_f32 v14, v96, v97, v98
 v_max3_f32 v15, v100, v101, v102
 v_max3_f32 v14, v14, v99, v103
 v_mov_b32 v88, 0x3f803f80
 v_mov_b32 v89, 0x3f803f80
 v_mov_b32 v90, 0x3f803f80
 v_mov_b32 v91, 0x3f803f80
 v_mov_b32 v92, 0x3f003f00
 v_mov_b32 v93, 0x3f003f00
 s_mov_b32 s23, 0
L_km_52:
 buffer_load_dwordx2 v[56:57], v1, s[4:7], s25 offen sc1
 buffer_load_dwordx2 v[58:59], v1, s[4:7], s26 offen offset:8 sc1
 buffer_load_dwordx2 v[60:61], v1, s[4:7], s26 offen offset:1032 sc1
 s_add_u32 s23, s23, 1
 s_cmp_gt_u32 s23, 262144
 s_cbranch_scc1 L_bail
 s_waitcnt vmcnt(0)
 ds_write_b64 v5, v[56:57]
 v_cmp_eq_u32 s[92:93], s39, v56
 v_cmp_eq_u32 vcc, s39, v57
 s_or_b64 s[92:93], s[92:93], vcc
 v_cmp_eq_u32 vcc, s39, v58
 s_or_b64 s[92:93], s[92:93], vcc
 v_cmp_eq_u32 vcc, s39, v59
 s_or_b64 s[92:93], s[92:93], vcc
 v_cmp_eq_u32 vcc, s39, v60
 s_or_b64 s[92:93], s[92:93], vcc
 v_cmp_eq_u32 vcc, s39, v61
 s_or_b64 s[92:93], s[92:93], vcc
 s_cbranch_scc0 L_km_52_ok
 s_sleep 1
 s_branch L_km_52
L_km_52_ok:
 v_cndmask_b32 v80, 0, v58, s[28:29]
 v_cndmask_b32 v82, 0, v58, s[30:31]
 v_cndmask_b32 v81, 0, v59, s[28:29]
 v_cndmask_b32 v83, 0, v59, s[30:31]
 v_cndmask_b32 v84, 0, v60, s[28:29]
 v_cndmask_b32 v86, 0, v60, s[30:31]
 v_cndmask_b32 v85, 0, v61, s[28:29]
 v_cndmask_b32 v87, 0, v61, s[30:31]
 s_waitcnt lgkmcnt(0)
 s_barrier
 ds_read_b64_tr_b16 v[64:65], v6 offset:0
 ds_read_b64_tr_b16 v[66:67], v6 offset:32
 ds_read_b64_tr_b16 v[68:69], v6 offset:256
 ds_read_b64_tr_b16 v[70:71], v6 offset:288
 ds_read_b64_tr_b16 v[72:73], v6 offset:512
 ds_read_b64_tr_b16 v[74:75], v6 offset:544
 ds_read_b64_tr_b16 v[76:77], v6 offset:768
 ds_read_b64_tr_b16 v[78:79], v6 offset:800
 s_and_b32 s24, s17, 1
 s_lshl_b32 s24, s24, 12
 s_lshr_b32 s25, s17, 1
 s_lshl_b32 s25, s25, 11
 s_add_u32 s24, s24, s25
 v_add_u32 v10, s24, v1
 s_waitcnt lgkmcnt(6)
 v_mfma_f32_16x16x32_bf16 v[104:107], v[64:67], v[40:43], 0
 s_waitcnt lgkmcnt(4)
 v_mfma_f32_16x16x32_bf16 v[104:107], v[68:71], v[44:47], v[104:107]
 s_waitcnt lgkmcnt(2)
 v_mfma_f32_16x16x32_bf16 v[104:107], v[72:75], v[48:51], v[104:107]
 s_waitcnt lgkmcnt(0)
 v_mfma_f32_16x16x32_bf16 v[104:107], v[76:79], v[52:55], v[104:107]
 s_nop 7
 v_max3_f32 v15, v15, v104, v105
 v_max3_f32 v14, v14, v106, v107
 v_max_f32 v14, v14, v15
 v_mov_b32 v15, v14
 s_nop 1
 v_permlane16_swap_b32 v15, v14
 v_max_f32 v14, v14, v15
 v_mov_b32 v15, v14
 s_nop 1
 v_permlane32_swap_b32 v15, v14
 v_max_f32 v14, v14, v15
 v_mul_f32 v14, s33, v14
 v_fma_f32 v96, v96, s33, -v14
 v_fma_f32 v97, v97, s33, -v14
 v_fma_f32 v98, v98, s33, -v14
 v_fma_f32 v99, v99, s33, -v14
 v_fma_f32 v100, v100, s33, -v14
 v_fma_f32 v101, v101, s33, -v14
 v_fma_f32 v102, v102, s33, -v14
 v_fma_f32 v103, v103, s33, -v14
 v_fma_f32 v104, v104, s33, -v14
 v_fma_f32 v105, v105, s33, -v14
 v_fma_f32 v106, v106, s33, -v14
 v_fma_f32 v107, v107, s33, -v14
 v_exp_f32 v96, v96
 v_exp_f32 v97, v97
 v_exp_f32 v98, v98
 v_exp_f32 v99, v99
 v_exp_f32 v100, v100
 v_exp_f32 v101, v101
 v_exp_f32 v102, v102
 v_exp_f32 v103, v103
 v_exp_f32 v104, v104
 v_exp_f32 v105, v105
 v_exp_f32 v106, v106
 v_exp_f32 v107, v107
 v_cvt_pk_bf16_f32 v40, v96, v97
 v_cvt_pk_bf16_f32 v41, v98, v99
 v_cvt_pk_bf16_f32 v42, v100, v101
 v_cvt_pk_bf16_f32 v43, v102, v103
 v_cvt_pk_bf16_f32 v44, v104, v105
 v_cvt_pk_bf16_f32 v45, v106, v107
 s_nop 1
 v_mfma_f32_16x16x32_bf16 v[48:51], v[88:91], v[40:43], 0
 v_mfma_f32_16x16x32_bf16 v[64:67], v[108:111], v[40:43], 0
 v_mfma_f32_16x16x32_bf16 v[68:71], v[112:115], v[40:43], 0
 v_mfma_f32_16x16x32_bf16 v[72:75], v[116:119], v[40:43], 0
 v_mfma_f32_16x16x32_bf16 v[76:79], v[120:123], v[40:43], 0
 s_nop 1
 v_mfma_f32_16x16x16_bf16 v[48:51], v[92:93], v[44:45], v[48:51]
 v_mfma_f32_16x16x16_bf16 v[64:67], v[80:81], v[44:45], v[64:67]
 v_mfma_f32_16x16x16_bf16 v[68:71], v[82:83], v[44:45], v[68:71]
 v_mfma_f32_16x16x16_bf16 v[72:75], v[84:85], v[44:45], v[72:75]
 v_mfma_f32_16x16x16_bf16 v[76:79], v[86:87], v[44:45], v[76:79]
 ds_read_b128 v[104:107], v3 offset:0
 ds_read_b128 v[108:111], v3 offset:1024
 ds_read_b128 v[112:115], v3 offset:8192
 s_nop 0
 v_rcp_f32 v48, v48
 s_nop 0
 v_mul_f32 v64, v64, v48
 v_mul_f32 v65, v65, v48
 v_mul_f32 v66, v66, v48
 v_mul_f32 v67, v67, v48
 v_mul_f32 v68, v68, v48
 v_mul_f32 v69, v69, v48
 v_mul_f32 v70, v70, v48
 v_mul_f32 v71, v71, v48
 v_cvt_pk_bf16_f32 v52, v64, v65
 v_cvt_pk_bf16_f32 v53, v66, v67
 v_cvt_pk_bf16_f32 v54, v68, v69
 v_cvt_pk_bf16_f32 v55, v70, v71
 ds_write_b128 v10, v[52:55] offset:0
 v_mul_f32 v72, v72, v48
 v_mul_f32 v73, v73, v48
 v_mul_f32 v74, v74, v48
 v_mul_f32 v75, v75, v48
 v_mul_f32 v76, v76, v48
 v_mul_f32 v77, v77, v48
 v_mul_f32 v78, v78, v48
 v_mul_f32 v79, v79, v48
 v_cvt_pk_bf16_f32 v56, v72, v73
 v_cvt_pk_bf16_f32 v57, v74, v75
 v_cvt_pk_bf16_f32 v58, v76, v77
 v_cvt_pk_bf16_f32 v59, v78, v79
 ds_write_b128 v10, v[56:59] offset:1024
 s_waitcnt lgkmcnt(0)
 s_barrier
 ds_read_b128 v[40:43], v1 offset:0
 ds_read_b128 v[56:59], v1 offset:4096
 ds_read_b128 v[44:47], v1 offset:1024
 ds_read_b128 v[60:63], v1 offset:5120
 ds_read_b128 v[48:51], v1 offset:2048
 ds_read_b128 v[64:67], v1 offset:6144
 ds_read_b128 v[52:55], v1 offset:3072
 ds_read_b128 v[68:71], v1 offset:7168
 s_waitcnt lgkmcnt(6)
 v_mfma_f32_16x16x32_bf16 v[72:75], v[104:107], v[40:43], 0
 ds_read_b128 v[116:119], v3 offset:9216
 v_mfma_f32_16x16x32_bf16 v[80:83], v[104:107], v[56:59], 0
 v_mfma_f32_16x16x32_bf16 v[76:79], v[108:111], v[40:43], 0
 ds_read_b128 v[104:107], v3 offset:16384
 v_mfma_f32_16x16x32_bf16 v[84:87], v[108:111], v[56:59], 0
 s_waitcnt lgkmcnt(6)
 v_mfma_f32_16x16x32_bf16 v[72:75], v[112:115], v[44:47], v[72:75]
 ds_read_b128 v[108:111], v3 offset:17408
 v_mfma_f32_16x16x32_bf16 v[80:83], v[112:115], v[60:63], v[80:83]
 s_waitcnt lgkmcnt(2)
 v_mfma_f32_16x16x32_bf16 v[76:79], v[116:119], v[44:47], v[76:79]
 ds_read_b128 v[112:115], v3 offset:24576
 v_mfma_f32_16x16x32_bf16 v[84:87], v[116:119], v[60:63], v[84:87]
 s_waitcnt lgkmcnt(2)
 v_mfma_f32_16x16x32_bf16 v[72:75], v[104:107], v[48:51], v[72:75]
 ds_read_b128 v[116:119], v3 offset:25600
 v_mfma_f32_16x16x32_bf16 v[80:83], v[104:107], v[64:67], v[80:83]
 s_waitcnt lgkmcnt(2)
 v_mfma_f32_16x16x32_bf16 v[76:79], v[108:111], v[48:51], v[76:79]
 ds_read_b128 v[104:107], v3 offset:2048
 v_mfma_f32_16x16x32_bf16 v[84:87], v[108:111], v[64:67], v[84:87]
 s_waitcnt lgkmcnt(2)
 v_mfma_f32_16x16x32_bf16 v[72:75], v[112:115], v[52:55], v[72:75]
 ds_read_b128 v[108:111], v3 offset:3072
 v_mfma_f32_16x16x32_bf16 v[80:83], v[112:115], v[68:71], v[80:83]
 s_waitcnt lgkmcnt(2)
 v_mfma_f32_16x16x32_bf16 v[76:79], v[116:119], v[52:55], v[76:79]
 ds_read_b128 v[112:115], v3 offset:10240
 v_mfma_f32_16x16x32_bf16 v[84:87], v[116:119], v[68:71], v[84:87]
 s_waitcnt lgkmcnt(2)
 v_mfma_f32_16x16x32_bf16 v[88:91], v[104:107], v[40:43], 0
 ds_read_b128 v[116:119], v3 offset:11264
 v_mfma_f32_16x16x32_bf16 v[96:99], v[104:107], v[56:59], 0
 s_waitcnt lgkmcnt(2)
 v_mfma_f32_16x16x32_bf16 v[92:95], v[108:111], v[40:43], 0
 ds_read_b128 v[104:107], v3 offset:18432
 v_cvt_pk_bf16_f32 v120, v72, v73
 v_mfma_f32_16x16x32_bf16 v[100:103], v[108:111], v[56:59], 0
 v_cvt_pk_bf16_f32 v121, v74, v75
 s_waitcnt lgkmcnt(2)
 v_mfma_f32_16x16x32_bf16 v[88:91], v[112:115], v[44:47], v[88:91]
 ds_read_b128 v[108:111], v3 offset:19456
 v_cvt_pk_bf16_f32 v122, v76, v77
 v_mfma_f32_16x16x32_bf16 v[96:99], v[112:115], v[60:63], v[96:99]
 v_cvt_pk_bf16_f32 v123, v78, v79
 s_waitcnt lgkmcnt(2)
 v_mfma_f32_16x16x32_bf16 v[92:95], v[116:119], v[44:47], v[92:95]
 ds_read_b128 v[112:115], v3 offset:26624
 s_add_u32 s27, s34, 0
 buffer_store_dwordx4 v[120:123], v4, s[4:7], s27 offen offset:0 sc1
 v_mfma_f32_16x16x32_bf16 v[100:103], v[116:119], v[60:63], v[100:103]
 v_cvt_pk_bf16_f32 v124, v80, v81
 s_waitcnt lgkmcnt(2)
 v_mfma_f32_16x16x32_bf16 v[88:91], v[104:107], v[48:51], v[88:91]
 ds_read_b128 v[116:119], v3 offset:27648
 v_cvt_pk_bf16_f32 v125, v82, v83
 v_mfma_f32_16x16x32_bf16 v[96:99], v[104:107], v[64:67], v[96:99]
 v_cvt_pk_bf16_f32 v126, v84, v85
 s_waitcnt lgkmcnt(2)
 v_mfma_f32_16x16x32_bf16 v[92:95], v[108:111], v[48:51], v[92:95]
 ds_read_b128 v[104:107], v3 offset:4096
 v_cvt_pk_bf16_f32 v127, v86, v87
 v_mfma_f32_16x16x32_bf16 v[100:103], v[108:111], v[64:67], v[100:103]
 s_add_u32 s27, s34, 524288
 buffer_store_dwordx4 v[124:127], v4, s[4:7], s27 offen offset:0 sc1
 s_waitcnt lgkmcnt(2)
 v_mfma_f32_16x16x32_bf16 v[88:91], v[112:115], v[52:55], v[88:91]
 ds_read_b128 v[108:111], v3 offset:5120
 v_mfma_f32_16x16x32_bf16 v[96:99], v[112:115], v[68:71], v[96:99]
 s_waitcnt lgkmcnt(2)
 v_mfma_f32_16x16x32_bf16 v[92:95], v[116:119], v[52:55], v[92:95]
 ds_read_b128 v[112:115], v3 offset:12288
 v_mfma_f32_16x16x32_bf16 v[100:103], v[116:119], v[68:71], v[100:103]
 s_waitcnt lgkmcnt(2)
 v_mfma_f32_16x16x32_bf16 v[72:75], v[104:107], v[40:43], 0
 ds_read_b128 v[116:119], v3 offset:13312
 v_mfma_f32_16x16x32_bf16 v[80:83], v[104:107], v[56:59], 0
 s_waitcnt lgkmcnt(2)
 v_mfma_f32_16x16x32_bf16 v[76:79], v[108:111], v[40:43], 0
 ds_read_b128 v[104:107], v3 offset:20480
 v_cvt_pk_bf16_f32 v120, v88, v89
 v_mfma_f32_16x16x32_bf16 v[84:87], v[108:111], v[56:59], 0
 v_cvt_pk_bf16_f32 v121, v90, v91
 s_waitcnt lgkmcnt(2)
 v_mfma_f32_16x16x32_bf16 v[72:75], v[112:115], v[44:47], v[72:75]
 ds_read_b128 v[108:111], v3 offset:21504
 v_cvt_pk_bf16_f32 v122, v92, v93
 v_mfma_f32_16x16x32_bf16 v[80:83], v[112:115], v[60:63], v[80:83]
 v_cvt_pk_bf16_f32 v123, v94, v95
 s_waitcnt lgkmcnt(2)
 v_mfma_f32_16x16x32_bf16 v[76:79], v[116:119], v[44:47], v[76:79]
 ds_read_b128 v[112:115], v3 offset:28672
 s_add_u32 s27, s34, 0
 buffer_store_dwordx4 v[120:123], v4, s[4:7], s27 offen offset:64 sc1
 v_mfma_f32_16x16x32_bf16 v[84:87], v[116:119], v[60:63], v[84:87]
 v_cvt_pk_bf16_f32 v124, v96, v97
 s_waitcnt lgkmcnt(2)
 v_mfma_f32_16x16x32_bf16 v[72:75], v[104:107], v[48:51], v[72:75]
 ds_read_b128 v[116:119], v3 offset:29696
 v_cvt_pk_bf16_f32 v125, v98, v99
 v_mfma_f32_16x16x32_bf16 v[80:83], v[104:107], v[64:67], v[80:83]
 v_cvt_pk_bf16_f32 v126, v100, v101
 s_waitcnt lgkmcnt(2)
 v_mfma_f32_16x16x32_bf16 v[76:79], v[108:111], v[48:51], v[76:79]
 ds_read_b128 v[104:107], v3 offset:6144
 v_cvt_pk_bf16_f32 v127, v102, v103
 v_mfma_f32_16x16x32_bf16 v[84:87], v[108:111], v[64:67], v[84:87]
 s_add_u32 s27, s34, 524288
 buffer_store_dwordx4 v[124:127], v4, s[4:7], s27 offen offset:64 sc1
 s_waitcnt lgkmcnt(2)
 v_mfma_f32_16x16x32_bf16 v[72:75], v[112:115], v[52:55], v[72:75]
 ds_read_b128 v[108:111], v3 offset:7168
 v_mfma_f32_16x16x32_bf16 v[80:83], v[112:115], v[68:71], v[80:83]
 s_waitcnt lgkmcnt(2)
 v_mfma_f32_16x16x32_bf16 v[76:79], v[116:119], v[52:55], v[76:79]
 ds_read_b128 v[112:115], v3 offset:14336
 v_mfma_f32_16x16x32_bf16 v[84:87], v[116:119], v[68:71], v[84:87]
 s_waitcnt lgkmcnt(2)
 v_mfma_f32_16x16x32_bf16 v[88:91], v[104:107], v[40:43], 0
 ds_read_b128 v[116:119], v3 offset:15360
 v_mfma_f32_16x16x32_bf16 v[96:99], v[104:107], v[56:59], 0
 s_waitcnt lgkmcnt(2)
 v_mfma_f32_16x16x32_bf16 v[92:95], v[108:111], v[40:43], 0
 ds_read_b128 v[104:107], v3 offset:22528
 v_cvt_pk_bf16_f32 v120, v72, v73
 v_mfma_f32_16x16x32_bf16 v[100:103], v[108:111], v[56:59], 0
 v_cvt_pk_bf16_f32 v121, v74, v75
 s_waitcnt lgkmcnt(2)
 v_mfma_f32_16x16x32_bf16 v[88:91], v[112:115], v[44:47], v[88:91]
 ds_read_b128 v[108:111], v3 offset:23552
 v_cvt_pk_bf16_f32 v122, v76, v77
 v_mfma_f32_16x16x32_bf16 v[96:99], v[112:115], v[60:63], v[96:99]
 v_cvt_pk_bf16_f32 v123, v78, v79
 s_waitcnt lgkmcnt(2)
 v_mfma_f32_16x16x32_bf16 v[92:95], v[116:119], v[44:47], v[92:95]
 ds_read_b128 v[112:115], v3 offset:30720
 s_add_u32 s27, s34, 0
 buffer_store_dwordx4 v[120:123], v4, s[4:7], s27 offen offset:128 sc1
 v_mfma_f32_16x16x32_bf16 v[100:103], v[116:119], v[60:63], v[100:103]
 v_cvt_pk_bf16_f32 v124, v80, v81
 s_waitcnt lgkmcnt(2)
 v_mfma_f32_16x16x32_bf16 v[88:91], v[104:107], v[48:51], v[88:91]
 ds_read_b128 v[116:119], v3 offset:31744
 v_cvt_pk_bf16_f32 v125, v82, v83
 v_mfma_f32_16x16x32_bf16 v[96:99], v[104:107], v[64:67], v[96:99]
 v_cvt_pk_bf16_f32 v126, v84, v85
 s_waitcnt lgkmcnt(2)
 v_mfma_f32_16x16x32_bf16 v[92:95], v[108:111], v[48:51], v[92:95]
 v_cvt_pk_bf16_f32 v127, v86, v87
 v_mfma_f32_16x16x32_bf16 v[100:103], v[108:111], v[64:67], v[100:103]
 s_add_u32 s27, s34, 524288
 buffer_store_dwordx4 v[124:127], v4, s[4:7], s27 offen offset:128 sc1
 s_waitcnt lgkmcnt(1)
 v_mfma_f32_16x16x32_bf16 v[88:91], v[112:115], v[52:55], v[88:91]
 v_mfma_f32_16x16x32_bf16 v[96:99], v[112:115], v[68:71], v[96:99]
 s_waitcnt lgkmcnt(0)
 v_mfma_f32_16x16x32_bf16 v[92:95], v[116:119], v[52:55], v[92:95]
 v_mfma_f32_16x16x32_bf16 v[100:103], v[116:119], v[68:71], v[100:103]
 s_nop 7
 v_cvt_pk_bf16_f32 v120, v88, v89
 v_cvt_pk_bf16_f32 v121, v90, v91
 v_cvt_pk_bf16_f32 v122, v92, v93
 v_cvt_pk_bf16_f32 v123, v94, v95
 s_add_u32 s27, s34, 0
 buffer_store_dwordx4 v[120:123], v4, s[4:7], s27 offen offset:192 sc1
 v_cvt_pk_bf16_f32 v124, v96, v97
 v_cvt_pk_bf16_f32 v125, v98, v99
 v_cvt_pk_bf16_f32 v126, v100, v101
 v_cvt_pk_bf16_f32 v127, v102, v103
 s_add_u32 s27, s34, 524288
 buffer_store_dwordx4 v[124:127], v4, s[4:7], s27 offen offset:192 sc1
 v_mov_b64 v[40:41], v[16:17]
 v_mov_b64 v[42:43], v[18:19]
 v_mov_b64 v[44:45], v[20:21]
 v_mov_b64 v[46:47], v[22:23]
 v_mov_b64 v[48:49], v[24:25]
 v_mov_b64 v[50:51], v[26:27]
 v_mov_b64 v[52:53], v[28:29]
 v_mov_b64 v[54:55], v[30:31]
 v_mov_b64 v[56:57], v[32:33]
 v_mov_b64 v[58:59], v[34:35]
 v_mov_b64 v[60:61], v[36:37]
 v_mov_b64 v[62:63], v[38:39]
 s_waitcnt vmcnt(0)
 s_barrier
 s_cmp_eq_u32 s17, 0
 s_cbranch_scc0 L_p2f_54
 s_mov_b64 exec, 1
 v_mov_b32 v10, 2
 buffer_store_dword v10, off, s[4:7], s35 sc1
 s_mov_b64 exec, -1
L_p2f_54:
 s_add_u32 s18, s18, 4
 s_waitcnt vmcnt(0)
 s_endpgm
L_R:
 s_mov_b32 s16, s45
 v_lshrrev_b32 v20, 6, v31
 v_and_b32 v21, 63, v31
 v_readfirstlane_b32 s17, v20
 v_and_b32 v22, 15, v21
 v_lshrrev_b32 v23, 4, v21
 v_lshlrev_b32 v1, 4, v21
 v_mov_b32 v24, 0x4444
 v_mov_b32 v25, 0xeeee
 v_cmp_gt_u32 vcc, 8, v22
 s_mov_b32 s28, -1
 s_mov_b32 s29, 0
 v_cndmask_b32 v0, v25, v24, vcc
 s_mov_b32 s30, 0
 s_mov_b32 s31, -1
 v_and_b32 v24, 1, v23
 v_lshl_add_u32 v24, v24, 2, v22
 v_and_b32 v24, 7, v24
 v_lshlrev_b32 v24, 4, v24
 v_lshl_add_u32 v24, v23, 7, v24
 v_lshl_add_u32 v25, v20, 9, v24
 v_add_u32 v10, 155648, v25
 v_add_u32 v2, 139264, v24
 v_bfe_u32 v24, v21, 2, 2
 v_bfe_u32 v25, v21, 4, 1
 v_and_b32 v26, 1, v24
 v_add_u32 v25, v25, v26
 v_and_b32 v26, 3, v21
 v_lshl_add_u32 v25, v25, 2, v26
 v_and_b32 v25, 7, v25
 v_lshlrev_b32 v25, 4, v25
 v_lshl_add_u32 v25, v24, 7, v25
 v_lshrrev_b32 v26, 5, v21
 v_lshl_add_u32 v25, v26, 9, v25
 v_lshl_add_u32 v25, v20, 11, v25
 v_add_u32 v3, 139264, v25
 v_lshrrev_b32 v24, 1, v23
 v_lshl_add_u32 v24, v24, 4, v22
 v_lshl_add_u32 v24, v20, 5, v24
 v_lshlrev_b32 v24, 3, v24
 v_and_b32 v25, 1, v23
 v_mul_u32_u24 v25, 1056, v25
 v_add_u32 v24, v24, v25
 v_add_u32 v4, 157696, v24
 v_bfe_u32 v24, v21, 2, 2
 v_lshl_add_u32 v24, v23, 3, v24
 v_lshlrev_b32 v24, 3, v24
 v_and_b32 v25, 1, v21
 v_mul_u32_u24 v25, 1056, v25
 v_add_u32 v24, v24, v25
 v_add_u32 v5, 157696, v24
 v_lshl_add_u32 v24, v20, 3, v23
 v_lshlrev_b32 v24, 13, v24
 v_lshl_add_u32 v24, v22, 3, v24
 s_lshl_b32 s24, s16, 8
 v_add_u32 v6, s24, v24
 s_lshr_b32 s24, s16, 2
 s_lshl_b32 s24, s24, 10
 s_and_b32 s25, s16, 1
 s_lshl_b32 s25, s25, 8
 s_add_u32 s24, s24, s25
 s_and_b32 s25, s16, 2
 s_lshl_b32 s25, s25, 6
 s_add_u32 s24, s24, s25
 v_lshrrev_b32 v24, 1, v23
 v_lshlrev_b32 v24, 9, v24
 v_and_b32 v25, 1, v23
 v_lshl_add_u32 v24, v25, 6, v24
 v_and_b32 v25, 3, v21
 v_lshl_add_u32 v24, v25, 4, v24
 v_bfe_u32 v25, v21, 2, 1
 v_lshl_add_u32 v24, v25, 3, v24
 v_add_u32 v7, s24, v24
 s_mul_i32 s24, s17, 32768
 s_add_u32 s24, s24, 8192
 v_add_u32 v8, s24, v1
 s_lshl_b32 s35, s17, 11
 s_add_u32 s34, s35, 147456
 v_add_u32 v11, s34, v1
 s_and_b32 s25, s17, 1
 s_lshl_b32 s38, s25, 12
 s_lshl_b32 s37, s16, 13
 s_mov_b32 s33, 0x3e0293ee
 s_mov_b32 s39, 0x7f817f81
 s_cmp_eq_u32 s17, 0
 s_cselect_b32 s84, -1, 0
 s_mov_b32 s85, 0
 s_cselect_b32 s44, -1, 0
 s_mov_b32 s45, s44
 s_mov_b32 s86, 0x7f817f81
 s_mov_b32 s87, 0x7f817f81
 s_lshl_b32 s88, s16, 10
 s_add_u32 s88, s88, 0x140000
 s_mov_b32 s56, 0x3f803f80
 s_mov_b32 s57, 0x3f803f80
 s_mov_b32 s58, 0x3f003f00
 s_mov_b32 s59, 0x3f003f00
 v_and_b32 v21, 63, v31
 v_bfe_u32 v18, v21, 4, 1
 v_and_b32 v23, 3, v21
 v_lshl_add_u32 v18, v18, 2, v23
 v_lshlrev_b32 v18, 10, v18
 v_bfe_u32 v23, v21, 2, 2
 v_lshl_add_u32 v18, v23, 4, v18
 v_lshrrev_b32 v23, 5, v21
 v_lshl_add_u32 v18, v23, 6, v18
 s_mul_i32 s24, s16, 1064960
 s_add_u32 s24, s24, s35
 s_add_u32 s21, s24, 0x1c00000
 s_add_u32 s32, s21, 8192
 s_mul_i32 s24, s16, 528384
 s_add_u32 s22, s24, 0x800000
 s_lshl_b32 s24, s16, 2
 s_add_u32 s36, s24, 0x110000
 s_mov_b32 s19, 0x0
 s_mov_b32 s20, 0x100000
 s_mov_b32 s90, 0
 s_mov_b32 s89, 0
 s_mov_b32 s8, s46
 s_and_b32 s9, s47, 0xffff
 s_mov_b32 s10, 0x2000
 s_mov_b32 s11, 0x20000
 v_and_b32 v21, 63, v31
 v_lshrrev_b32 v22, 2, v21
 v_and_b32 v23, 3, v21
 v_lshlrev_b32 v24, 13, v22
 v_lshl_add_u32 v24, v23, 4, v24
 s_lshl_b32 s24, s16, 8
 s_lshl_b32 s25, s17, 6
 s_add_u32 s24, s24, s25
 v_add_u32 v24, s24, v24
 v_lshrrev_b32 v28, 4, v21
 v_and_b32 v25, 15, v21
 v_lshlrev_b32 v25, 4, v25
 v_lshl_add_u32 v25, v28, 10, v25
 s_lshl_b32 s24, s16, 17
 s_lshl_b32 s25, s17, 8
 s_add_u32 s24, s24, s25
 v_add_u32 v25, s24, v25
 s_mul_i32 s26, s17, 32768
 s_add_u32 s26, s26, 8192
 v_bfe_u32 v29, v21, 2, 1
 v_bfe_u32 v30, v21, 3, 1
 v_lshlrev_b32 v30, 5, v30
 v_lshl_add_u32 v30, v23, 3, v30
 v_add_u32 v30, s26, v30
 v_lshl_add_u32 v26, v28, 2, v29
 v_lshl_add_u32 v26, v26, 6, v30
 v_and_b32 v27, 1, v28
 v_lshlrev_b32 v27, 4, v27
 v_lshrrev_b32 v22, 1, v28
 v_lshl_add_u32 v27, v22, 2, v27
 v_add_u32 v27, v27, v29
 v_lshl_add_u32 v27, v27, 8, v30

 s_mov_b32 s60, s48
 s_and_b32 s61, s49, 0xffff
 s_mov_b32 s62, 0x400000
 s_mov_b32 s63, 0x20000
 s_mov_b32 s64, s50
 s_and_b32 s65, s51, 0xffff
 s_mov_b32 s66, 0x400000
 s_mov_b32 s67, 0x20000
 s_mov_b32 s68, s52
 s_and_b32 s69, s53, 0xffff
 s_mov_b32 s70, 0x400000
 s_mov_b32 s71, 0x20000
 s_mov_b32 s72, s54
 s_and_b32 s73, s55, 0xffff
 s_mov_b32 s74, 0x400000
 s_mov_b32 s75, 0x20000
 v_and_b32 v22, 0x38, v21
 v_and_b32 v23, 3, v21
 v_lshl_add_u32 v22, v23, 1, v22
 v_bfe_u32 v23, v21, 2, 1
 v_add_u32 v22, v22, v23
 v_lshlrev_b32 v22, 4, v22
 v_add_u32 v22, s26, v22
 v_lshrrev_b32 v28, 4, v21
 v_and_b32 v29, 1, v28
 v_lshlrev_b32 v29, 2, v29
 v_and_b32 v30, 15, v21
 v_xor_b32 v30, v30, v29
 v_lshlrev_b32 v24, 13, v28
 v_lshl_add_u32 v24, v30, 4, v24
 s_lshl_b32 s24, s16, 8
 s_lshl_b32 s25, s17, 16
 s_add_u32 s24, s24, s25
 v_add_u32 v24, s24, v24
 v_xor_b32 v23, 128, v24
 v_add_u32 v23, 32768, v23
 v_bfe_u32 v29, v21, 2, 1
 v_and_b32 v30, 1, v28
 v_lshl_add_u32 v30, v30, 1, v29
 v_xor_b32 v30, s17, v30
 v_lshlrev_b32 v30, 6, v30
 v_bfe_u32 v26, v21, 3, 1
 v_lshl_add_u32 v30, v26, 5, v30
 v_and_b32 v26, 3, v21
 v_lshl_add_u32 v30, v26, 3, v30
 v_lshl_add_u32 v26, v28, 2, v29
 v_lshl_add_u32 v26, v26, 8, v30
 v_add_u32 v26, 8192, v26
 v_add_u32 v19, 65536, v26
 s_lshl_b32 s25, s17, 8
 v_subrev_u32 v25, s25, v25
 s_lshl_b32 s25, s17, 13
 v_add_u32 v25, s25, v25
 s_lshl_b32 s27, s17, 11
 s_add_u32 s27, s27, 8192
 s_and_b32 s52, s16, 3
 s_add_u32 m0, s27, 0
 s_mov_b32 s24, 0x0
 buffer_load_dwordx4 v24, s[64:67], s24 offen lds
 s_add_u32 m0, s27, 1024
 s_mov_b32 s24, 0x0
 buffer_load_dwordx4 v23, s[64:67], s24 offen lds
 s_add_u32 m0, s27, 32768
 s_mov_b32 s24, 0x40000
 buffer_load_dwordx4 v24, s[64:67], s24 offen lds
 s_add_u32 m0, s27, 33792
 s_mov_b32 s24, 0x40000
 buffer_load_dwordx4 v23, s[64:67], s24 offen lds
 s_add_u32 m0, s27, 65536
 s_mov_b32 s24, 0x80000
 buffer_load_dwordx4 v24, s[64:67], s24 offen lds
 s_add_u32 m0, s27, 66560
 s_mov_b32 s24, 0x80000
 buffer_load_dwordx4 v23, s[64:67], s24 offen lds
 s_add_u32 m0, s27, 98304
 s_mov_b32 s24, 0xc0000
 buffer_load_dwordx4 v24, s[64:67], s24 offen lds
 s_add_u32 m0, s27, 99328
 s_mov_b32 s24, 0xc0000
 buffer_load_dwordx4 v23, s[64:67], s24 offen lds
 s_add_u32 m0, s27, 8192
 s_mov_b32 s24, 0x100000
 buffer_load_dwordx4 v24, s[64:67], s24 offen lds
 s_add_u32 m0, s27, 9216
 s_mov_b32 s24, 0x100000
 buffer_load_dwordx4 v23, s[64:67], s24 offen lds
 s_add_u32 m0, s27, 40960
 s_mov_b32 s24, 0x140000
 buffer_load_dwordx4 v24, s[64:67], s24 offen lds
 s_add_u32 m0, s27, 41984
 s_mov_b32 s24, 0x140000
 buffer_load_dwordx4 v23, s[64:67], s24 offen lds
 s_add_u32 m0, s27, 73728
 s_mov_b32 s24, 0x180000
 buffer_load_dwordx4 v24, s[64:67], s24 offen lds
 s_add_u32 m0, s27, 74752
 s_mov_b32 s24, 0x180000
 buffer_load_dwordx4 v23, s[64:67], s24 offen lds
 s_add_u32 m0, s27, 106496
 s_mov_b32 s24, 0x1c0000
 buffer_load_dwordx4 v24, s[64:67], s24 offen lds
 s_add_u32 m0, s27, 107520
 s_mov_b32 s24, 0x1c0000
 buffer_load_dwordx4 v23, s[64:67], s24 offen lds
 s_add_u32 m0, s27, 16384
 s_mov_b32 s24, 0x200000
 buffer_load_dwordx4 v24, s[64:67], s24 offen lds
 s_add_u32 m0, s27, 17408
 s_mov_b32 s24, 0x200000
 buffer_load_dwordx4 v23, s[64:67], s24 offen lds
 s_add_u32 m0, s27, 49152
 s_mov_b32 s24, 0x240000
 buffer_load_dwordx4 v24, s[64:67], s24 offen lds
 s_add_u32 m0, s27, 50176
 s_mov_b32 s24, 0x240000
 buffer_load_dwordx4 v23, s[64:67], s24 offen lds
 s_add_u32 m0, s27, 81920
 s_mov_b32 s24, 0x280000
 buffer_load_dwordx4 v24, s[64:67], s24 offen lds
 s_add_u32 m0, s27, 82944
 s_mov_b32 s24, 0x280000
 buffer_load_dwordx4 v23, s[64:67], s24 offen lds
 s_add_u32 m0, s27, 114688
 s_mov_b32 s24, 0x2c0000
 buffer_load_dwordx4 v24, s[64:67], s24 offen lds
 s_add_u32 m0, s27, 115712
 s_mov_b32 s24, 0x2c0000
 buffer_load_dwordx4 v23, s[64:67], s24 offen lds
 s_add_u32 m0, s27, 24576
 s_mov_b32 s24, 0x300000
 buffer_load_dwordx4 v24, s[64:67], s24 offen lds
 s_add_u32 m0, s27, 25600
 s_mov_b32 s24, 0x300000
 buffer_load_dwordx4 v23, s[64:67], s24 offen lds
 s_add_u32 m0, s27, 57344
 s_mov_b32 s24, 0x340000
 buffer_load_dwordx4 v24, s[64:67], s24 offen lds
 s_add_u32 m0, s27, 58368
 s_mov_b32 s24, 0x340000
 buffer_load_dwordx4 v23, s[64:67], s24 offen lds
 s_add_u32 m0, s27, 90112
 s_mov_b32 s24, 0x380000
 buffer_load_dwordx4 v24, s[64:67], s24 offen lds
 s_add_u32 m0, s27, 91136
 s_mov_b32 s24, 0x380000
 buffer_load_dwordx4 v23, s[64:67], s24 offen lds
 v_mov_b32 v64, s39
 v_mov_b32 v65, s39
 v_mov_b32 v66, s39
 v_mov_b32 v67, s39
 s_lshl_b32 s24, s17, 18
 s_add_u32 s24, s24, s37
 s_add_u32 s24, s24, 0x0
 s_add_u32 s25, s24, 4096
 buffer_store_dwordx4 v[64:67], v1, s[4:7], s24 offen offset:0 sc1
 buffer_store_dwordx4 v[64:67], v1, s[4:7], s24 offen offset:1024 sc1
 buffer_store_dwordx4 v[64:67], v1, s[4:7], s24 offen offset:2048 sc1
 buffer_store_dwordx4 v[64:67], v1, s[4:7], s24 offen offset:3072 sc1
 buffer_store_dwordx4 v[64:67], v1, s[4:7], s25 offen offset:0 sc1
 buffer_store_dwordx4 v[64:67], v1, s[4:7], s25 offen offset:1024 sc1
 buffer_store_dwordx4 v[64:67], v1, s[4:7], s25 offen offset:2048 sc1
 buffer_store_dwordx4 v[64:67], v1, s[4:7], s25 offen offset:3072 sc1
 s_lshl_b32 s25, s17, 13
 s_add_u32 s25, s25, 0x100000
 buffer_store_dwordx2 v[64:65], v7, s[4:7], s25 offen sc1
 s_waitcnt vmcnt(37)
 s_barrier
 s_add_u32 m0, s27, 122880
 s_mov_b32 s24, 0x3c0000
 buffer_load_dwordx4 v24, s[64:67], s24 offen lds
 s_add_u32 m0, s27, 123904
 s_mov_b32 s24, 0x3c0000
 buffer_load_dwordx4 v23, s[64:67], s24 offen lds
 ds_read_b64_tr_b16 a[128:129], v26 offset:0
 ds_read_b64_tr_b16 a[130:131], v26 offset:512
 ds_read_b64_tr_b16 a[132:133], v26 offset:4096
 ds_read_b64_tr_b16 a[134:135], v26 offset:4608
 s_waitcnt lgkmcnt(0)
 s_waitcnt vmcnt(37)
 s_barrier
 s_add_u32 m0, s27, 0
 s_mov_b32 s24, 0x0
 buffer_load_dwordx4 v24, s[68:71], s24 offen lds
 s_add_u32 m0, s27, 1024
 s_mov_b32 s24, 0x0
 buffer_load_dwordx4 v23, s[68:71], s24 offen lds
 ds_read_b64_tr_b16 a[136:137], v26 offset:32768
 ds_read_b64_tr_b16 a[138:139], v26 offset:33280
 ds_read_b64_tr_b16 a[140:141], v26 offset:36864
 ds_read_b64_tr_b16 a[142:143], v26 offset:37376
 s_waitcnt lgkmcnt(0)
 s_waitcnt vmcnt(37)
 s_barrier
 s_add_u32 m0, s27, 32768
 s_mov_b32 s24, 0x40000
 buffer_load_dwordx4 v24, s[68:71], s24 offen lds
 s_add_u32 m0, s27, 33792
 s_mov_b32 s24, 0x40000
 buffer_load_dwordx4 v23, s[68:71], s24 offen lds
 s_lshl_b32 s24, s17, 8
 buffer_load_dwordx4 v[96:99], v18, s[8:11], s24 offen offset:0
 buffer_load_dwordx4 v[100:103], v18, s[8:11], s24 offen offset:128
 ds_read_b64_tr_b16 a[144:145], v19 offset:0
 ds_read_b64_tr_b16 a[146:147], v19 offset:512
 ds_read_b64_tr_b16 a[148:149], v19 offset:4096
 ds_read_b64_tr_b16 a[150:151], v19 offset:4608
 s_waitcnt lgkmcnt(0)
 s_waitcnt vmcnt(39)
 s_barrier
 s_add_u32 m0, s27, 65536
 s_mov_b32 s24, 0x80000
 buffer_load_dwordx4 v24, s[68:71], s24 offen lds
 s_add_u32 m0, s27, 66560
 s_mov_b32 s24, 0x80000
 buffer_load_dwordx4 v23, s[68:71], s24 offen lds
 ds_read_b64_tr_b16 a[152:153], v19 offset:32768
 ds_read_b64_tr_b16 a[154:155], v19 offset:33280
 ds_read_b64_tr_b16 a[156:157], v19 offset:36864
 ds_read_b64_tr_b16 a[158:159], v19 offset:37376
 s_waitcnt lgkmcnt(0)
 s_waitcnt vmcnt(39)
 s_barrier
 s_add_u32 m0, s27, 98304
 s_mov_b32 s24, 0xc0000
 buffer_load_dwordx4 v24, s[68:71], s24 offen lds
 s_add_u32 m0, s27, 99328
 s_mov_b32 s24, 0xc0000
 buffer_load_dwordx4 v23, s[68:71], s24 offen lds
 ds_read_b64_tr_b16 a[160:161], v26 offset:8192
 ds_read_b64_tr_b16 a[162:163], v26 offset:8704
 ds_read_b64_tr_b16 a[164:165], v26 offset:12288
 ds_read_b64_tr_b16 a[166:167], v26 offset:12800
 s_waitcnt lgkmcnt(0)
 s_waitcnt vmcnt(39)
 s_barrier
 s_add_u32 m0, s27, 8192
 s_mov_b32 s24, 0x100000
 buffer_load_dwordx4 v24, s[68:71], s24 offen lds
 s_add_u32 m0, s27, 9216
 s_mov_b32 s24, 0x100000
 buffer_load_dwordx4 v23, s[68:71], s24 offen lds
 ds_read_b64_tr_b16 a[168:169], v26 offset:40960
 ds_read_b64_tr_b16 a[170:171], v26 offset:41472
 ds_read_b64_tr_b16 a[172:173], v26 offset:45056
 ds_read_b64_tr_b16 a[174:175], v26 offset:45568
 s_waitcnt lgkmcnt(0)
 s_waitcnt vmcnt(39)
 s_barrier
 s_add_u32 m0, s27, 40960
 s_mov_b32 s24, 0x140000
 buffer_load_dwordx4 v24, s[68:71], s24 offen lds
 s_add_u32 m0, s27, 41984
 s_mov_b32 s24, 0x140000
 buffer_load_dwordx4 v23, s[68:71], s24 offen lds
 ds_read_b64_tr_b16 a[176:177], v19 offset:8192
 ds_read_b64_tr_b16 a[178:179], v19 offset:8704
 ds_read_b64_tr_b16 a[180:181], v19 offset:12288
 ds_read_b64_tr_b16 a[182:183], v19 offset:12800
 s_waitcnt lgkmcnt(0)
 s_waitcnt vmcnt(39)
 s_barrier
 s_add_u32 m0, s27, 73728
 s_mov_b32 s24, 0x180000
 buffer_load_dwordx4 v24, s[68:71], s24 offen lds
 s_add_u32 m0, s27, 74752
 s_mov_b32 s24, 0x180000
 buffer_load_dwordx4 v23, s[68:71], s24 offen lds
 ds_read_b64_tr_b16 a[184:185], v19 offset:40960
 ds_read_b64_tr_b16 a[186:187], v19 offset:41472
 ds_read_b64_tr_b16 a[188:189], v19 offset:45056
 ds_read_b64_tr_b16 a[190:191], v19 offset:45568
 s_waitcnt lgkmcnt(0)
 s_waitcnt vmcnt(39)
 s_barrier
 s_add_u32 m0, s27, 106496
 s_mov_b32 s24, 0x1c0000
 buffer_load_dwordx4 v24, s[68:71], s24 offen lds
 s_add_u32 m0, s27, 107520
 s_mov_b32 s24, 0x1c0000
 buffer_load_dwordx4 v23, s[68:71], s24 offen lds
 ds_read_b64_tr_b16 a[192:193], v26 offset:16384
 ds_read_b64_tr_b16 a[194:195], v26 offset:16896
 ds_read_b64_tr_b16 a[196:197], v26 offset:20480
 ds_read_b64_tr_b16 a[198:199], v26 offset:20992
 s_waitcnt lgkmcnt(0)
 s_waitcnt vmcnt(39)
 s_barrier
 s_add_u32 m0, s27, 16384
 s_mov_b32 s24, 0x200000
 buffer_load_dwordx4 v24, s[68:71], s24 offen lds
 s_add_u32 m0, s27, 17408
 s_mov_b32 s24, 0x200000
 buffer_load_dwordx4 v23, s[68:71], s24 offen lds
 ds_read_b64_tr_b16 a[200:201], v26 offset:49152
 ds_read_b64_tr_b16 a[202:203], v26 offset:49664
 ds_read_b64_tr_b16 a[204:205], v26 offset:53248
 ds_read_b64_tr_b16 a[206:207], v26 offset:53760
 s_waitcnt lgkmcnt(0)
 s_waitcnt vmcnt(39)
 s_barrier
 s_add_u32 m0, s27, 49152
 s_mov_b32 s24, 0x240000
 buffer_load_dwordx4 v24, s[68:71], s24 offen lds
 s_add_u32 m0, s27, 50176
 s_mov_b32 s24, 0x240000
 buffer_load_dwordx4 v23, s[68:71], s24 offen lds
 ds_read_b64_tr_b16 a[208:209], v19 offset:16384
 ds_read_b64_tr_b16 a[210:211], v19 offset:16896
 ds_read_b64_tr_b16 a[212:213], v19 offset:20480
 ds_read_b64_tr_b16 a[214:215], v19 offset:20992
 s_waitcnt lgkmcnt(0)
 s_waitcnt vmcnt(39)
 s_barrier
 s_add_u32 m0, s27, 81920
 s_mov_b32 s24, 0x280000
 buffer_load_dwordx4 v24, s[68:71], s24 offen lds
 s_add_u32 m0, s27, 82944
 s_mov_b32 s24, 0x280000
 buffer_load_dwordx4 v23, s[68:71], s24 offen lds
 ds_read_b64_tr_b16 a[216:217], v19 offset:49152
 ds_read_b64_tr_b16 a[218:219], v19 offset:49664
 ds_read_b64_tr_b16 a[220:221], v19 offset:53248
 ds_read_b64_tr_b16 a[222:223], v19 offset:53760
 s_waitcnt lgkmcnt(0)
 s_waitcnt vmcnt(39)
 s_barrier
 s_add_u32 m0, s27, 114688
 s_mov_b32 s24, 0x2c0000
 buffer_load_dwordx4 v24, s[68:71], s24 offen lds
 s_add_u32 m0, s27, 115712
 s_mov_b32 s24, 0x2c0000
 buffer_load_dwordx4 v23, s[68:71], s24 offen lds
 ds_read_b64_tr_b16 a[224:225], v26 offset:24576
 ds_read_b64_tr_b16 a[226:227], v26 offset:25088
 ds_read_b64_tr_b16 a[228:229], v26 offset:28672
 ds_read_b64_tr_b16 a[230:231], v26 offset:29184
 s_waitcnt lgkmcnt(0)
 s_waitcnt vmcnt(39)
 s_barrier
 s_add_u32 m0, s27, 24576
 s_mov_b32 s24, 0x300000
 buffer_load_dwordx4 v24, s[68:71], s24 offen lds
 s_add_u32 m0, s27, 25600
 s_mov_b32 s24, 0x300000
 buffer_load_dwordx4 v23, s[68:71], s24 offen lds
 ds_read_b64_tr_b16 a[232:233], v26 offset:57344
 ds_read_b64_tr_b16 a[234:235], v26 offset:57856
 ds_read_b64_tr_b16 a[236:237], v26 offset:61440
 ds_read_b64_tr_b16 a[238:239], v26 offset:61952
 s_waitcnt lgkmcnt(0)
 s_waitcnt vmcnt(39)
 s_barrier
 s_add_u32 m0, s27, 57344
 s_mov_b32 s24, 0x340000
 buffer_load_dwordx4 v24, s[68:71], s24 offen lds
 s_add_u32 m0, s27, 58368
 s_mov_b32 s24, 0x340000
 buffer_load_dwordx4 v23, s[68:71], s24 offen lds
 ds_read_b64_tr_b16 a[240:241], v19 offset:24576
 ds_read_b64_tr_b16 a[242:243], v19 offset:25088
 ds_read_b64_tr_b16 a[244:245], v19 offset:28672
 ds_read_b64_tr_b16 a[246:247], v19 offset:29184
 s_waitcnt lgkmcnt(0)
 s_waitcnt vmcnt(30)
 s_barrier
 s_add_u32 m0, s27, 90112
 s_mov_b32 s24, 0x380000
 buffer_load_dwordx4 v24, s[68:71], s24 offen lds
 s_add_u32 m0, s27, 91136
 s_mov_b32 s24, 0x380000
 buffer_load_dwordx4 v23, s[68:71], s24 offen lds
 ds_read_b64_tr_b16 a[248:249], v19 offset:57344
 ds_read_b64_tr_b16 a[250:251], v19 offset:57856
 ds_read_b64_tr_b16 a[252:253], v19 offset:61440
 ds_read_b64_tr_b16 a[254:255], v19 offset:61952
 s_waitcnt lgkmcnt(0)
 s_waitcnt vmcnt(30)
 s_barrier
 s_add_u32 m0, s27, 122880
 s_mov_b32 s24, 0x3c0000
 buffer_load_dwordx4 v24, s[68:71], s24 offen lds
 s_add_u32 m0, s27, 123904
 s_mov_b32 s24, 0x3c0000
 buffer_load_dwordx4 v23, s[68:71], s24 offen lds
 s_mov_b64 exec, 1
 v_mov_b32 v20, 1
 buffer_atomic_add v20, off, s[12:15], 0 offset:8
 s_mov_b64 exec, -1
 ds_read_b64_tr_b16 v[128:129], v26 offset:0
 ds_read_b64_tr_b16 v[130:131], v26 offset:512
 ds_read_b64_tr_b16 v[132:133], v26 offset:4096
 ds_read_b64_tr_b16 v[134:135], v26 offset:4608
 s_waitcnt lgkmcnt(0)
 s_waitcnt vmcnt(31)
 s_barrier
 s_add_u32 m0, s27, 0
 s_mov_b32 s24, 0x0
 buffer_load_dwordx4 v24, s[60:63], s24 offen lds
 s_add_u32 m0, s27, 1024
 s_mov_b32 s24, 0x0
 buffer_load_dwordx4 v23, s[60:63], s24 offen lds
 ds_read_b64_tr_b16 v[136:137], v26 offset:32768
 ds_read_b64_tr_b16 v[138:139], v26 offset:33280
 ds_read_b64_tr_b16 v[140:141], v26 offset:36864
 ds_read_b64_tr_b16 v[142:143], v26 offset:37376
 s_waitcnt lgkmcnt(0)
 s_waitcnt vmcnt(29)
 s_barrier
 s_add_u32 m0, s27, 32768
 s_mov_b32 s24, 0x40000
 buffer_load_dwordx4 v24, s[60:63], s24 offen lds
 s_add_u32 m0, s27, 33792
 s_mov_b32 s24, 0x40000
 buffer_load_dwordx4 v23, s[60:63], s24 offen lds
 ds_read_b64_tr_b16 v[144:145], v19 offset:0
 ds_read_b64_tr_b16 v[146:147], v19 offset:512
 ds_read_b64_tr_b16 v[148:149], v19 offset:4096
 ds_read_b64_tr_b16 v[150:151], v19 offset:4608
 s_waitcnt lgkmcnt(0)
 s_waitcnt vmcnt(29)
 s_barrier
 s_add_u32 m0, s27, 65536
 s_mov_b32 s24, 0x80000
 buffer_load_dwordx4 v24, s[60:63], s24 offen lds
 s_add_u32 m0, s27, 66560
 s_mov_b32 s24, 0x80000
 buffer_load_dwordx4 v23, s[60:63], s24 offen lds
 ds_read_b64_tr_b16 v[152:153], v19 offset:32768
 ds_read_b64_tr_b16 v[154:155], v19 offset:33280
 ds_read_b64_tr_b16 v[156:157], v19 offset:36864
 ds_read_b64_tr_b16 v[158:159], v19 offset:37376
 s_waitcnt lgkmcnt(0)
 s_waitcnt vmcnt(29)
 s_barrier
 s_add_u32 m0, s27, 98304
 s_mov_b32 s24, 0xc0000
 buffer_load_dwordx4 v24, s[60:63], s24 offen lds
 s_add_u32 m0, s27, 99328
 s_mov_b32 s24, 0xc0000
 buffer_load_dwordx4 v23, s[60:63], s24 offen lds
 ds_read_b64_tr_b16 v[160:161], v26 offset:8192
 ds_read_b64_tr_b16 v[162:163], v26 offset:8704
 ds_read_b64_tr_b16 v[164:165], v26 offset:12288
 ds_read_b64_tr_b16 v[166:167], v26 offset:12800
 s_waitcnt lgkmcnt(0)
 s_waitcnt vmcnt(29)
 s_barrier
 s_add_u32 m0, s27, 8192
 s_mov_b32 s24, 0x100000
 buffer_load_dwordx4 v24, s[60:63], s24 offen lds
 s_add_u32 m0, s27, 9216
 s_mov_b32 s24, 0x100000
 buffer_load_dwordx4 v23, s[60:63], s24 offen lds
 ds_read_b64_tr_b16 v[168:169], v26 offset:40960
 ds_read_b64_tr_b16 v[170:171], v26 offset:41472
 ds_read_b64_tr_b16 v[172:173], v26 offset:45056
 ds_read_b64_tr_b16 v[174:175], v26 offset:45568
 s_waitcnt lgkmcnt(0)
 s_waitcnt vmcnt(29)
 s_barrier
 s_add_u32 m0, s27, 40960
 s_mov_b32 s24, 0x140000
 buffer_load_dwordx4 v24, s[60:63], s24 offen lds
 s_add_u32 m0, s27, 41984
 s_mov_b32 s24, 0x140000
 buffer_load_dwordx4 v23, s[60:63], s24 offen lds
 ds_read_b64_tr_b16 v[176:177], v19 offset:8192
 ds_read_b64_tr_b16 v[178:179], v19 offset:8704
 ds_read_b64_tr_b16 v[180:181], v19 offset:12288
 ds_read_b64_tr_b16 v[182:183], v19 offset:12800
 s_waitcnt lgkmcnt(0)
 s_waitcnt vmcnt(29)
 s_barrier
 s_add_u32 m0, s27, 73728
 s_mov_b32 s24, 0x180000
 buffer_load_dwordx4 v24, s[60:63], s24 offen lds
 s_add_u32 m0, s27, 74752
 s_mov_b32 s24, 0x180000
 buffer_load_dwordx4 v23, s[60:63], s24 offen lds
 ds_read_b64_tr_b16 v[184:185], v19 offset:40960
 ds_read_b64_tr_b16 v[186:187], v19 offset:41472
 ds_read_b64_tr_b16 v[188:189], v19 offset:45056
 ds_read_b64_tr_b16 v[190:191], v19 offset:45568
 s_waitcnt lgkmcnt(0)
 s_waitcnt vmcnt(29)
 s_barrier
 s_add_u32 m0, s27, 106496
 s_mov_b32 s24, 0x1c0000
 buffer_load_dwordx4 v24, s[60:63], s24 offen lds
 s_add_u32 m0, s27, 107520
 s_mov_b32 s24, 0x1c0000
 buffer_load_dwordx4 v23, s[60:63], s24 offen lds
 ds_read_b64_tr_b16 v[192:193], v26 offset:16384
 ds_read_b64_tr_b16 v[194:195], v26 offset:16896
 ds_read_b64_tr_b16 v[196:197], v26 offset:20480
 ds_read_b64_tr_b16 v[198:199], v26 offset:20992
 s_waitcnt lgkmcnt(0)
 s_waitcnt vmcnt(29)
 s_barrier
 s_add_u32 m0, s27, 16384
 s_mov_b32 s24, 0x200000
 buffer_load_dwordx4 v24, s[60:63], s24 offen lds
 s_add_u32 m0, s27, 17408
 s_mov_b32 s24, 0x200000
 buffer_load_dwordx4 v23, s[60:63], s24 offen lds
 ds_read_b64_tr_b16 v[200:201], v26 offset:49152
 ds_read_b64_tr_b16 v[202:203], v26 offset:49664
 ds_read_b64_tr_b16 v[204:205], v26 offset:53248
 ds_read_b64_tr_b16 v[206:207], v26 offset:53760
 s_waitcnt lgkmcnt(0)
 s_waitcnt vmcnt(29)
 s_barrier
 s_add_u32 m0, s27, 49152
 s_mov_b32 s24, 0x240000
 buffer_load_dwordx4 v24, s[60:63], s24 offen lds
 s_add_u32 m0, s27, 50176
 s_mov_b32 s24, 0x240000
 buffer_load_dwordx4 v23, s[60:63], s24 offen lds
 ds_read_b64_tr_b16 v[208:209], v19 offset:16384
 ds_read_b64_tr_b16 v[210:211], v19 offset:16896
 ds_read_b64_tr_b16 v[212:213], v19 offset:20480
 ds_read_b64_tr_b16 v[214:215], v19 offset:20992
 s_waitcnt lgkmcnt(0)
 s_waitcnt vmcnt(29)
 s_barrier
 s_add_u32 m0, s27, 81920
 s_mov_b32 s24, 0x280000
 buffer_load_dwordx4 v24, s[60:63], s24 offen lds
 s_add_u32 m0, s27, 82944
 s_mov_b32 s24, 0x280000
 buffer_load_dwordx4 v23, s[60:63], s24 offen lds
 ds_read_b64_tr_b16 v[216:217], v19 offset:49152
 ds_read_b64_tr_b16 v[218:219], v19 offset:49664
 ds_read_b64_tr_b16 v[220:221], v19 offset:53248
 ds_read_b64_tr_b16 v[222:223], v19 offset:53760
 s_waitcnt lgkmcnt(0)
 s_waitcnt vmcnt(29)
 s_barrier
 s_add_u32 m0, s27, 114688
 s_mov_b32 s24, 0x2c0000
 buffer_load_dwordx4 v24, s[60:63], s24 offen lds
 s_add_u32 m0, s27, 115712
 s_mov_b32 s24, 0x2c0000
 buffer_load_dwordx4 v23, s[60:63], s24 offen lds
 ds_read_b64_tr_b16 v[224:225], v26 offset:24576
 ds_read_b64_tr_b16 v[226:227], v26 offset:25088
 ds_read_b64_tr_b16 v[228:229], v26 offset:28672
 ds_read_b64_tr_b16 v[230:231], v26 offset:29184
 s_waitcnt lgkmcnt(0)
 s_waitcnt vmcnt(29)
 s_barrier
 s_add_u32 m0, s27, 24576
 s_mov_b32 s24, 0x300000
 buffer_load_dwordx4 v24, s[60:63], s24 offen lds
 s_add_u32 m0, s27, 25600
 s_mov_b32 s24, 0x300000
 buffer_load_dwordx4 v23, s[60:63], s24 offen lds
 ds_read_b64_tr_b16 v[232:233], v26 offset:57344
 ds_read_b64_tr_b16 v[234:235], v26 offset:57856
 ds_read_b64_tr_b16 v[236:237], v26 offset:61440
 ds_read_b64_tr_b16 v[238:239], v26 offset:61952
 s_waitcnt lgkmcnt(0)
 s_waitcnt vmcnt(29)
 s_barrier
 s_add_u32 m0, s27, 57344
 s_mov_b32 s24, 0x340000
 buffer_load_dwordx4 v24, s[60:63], s24 offen lds
 s_add_u32 m0, s27, 58368
 s_mov_b32 s24, 0x340000
 buffer_load_dwordx4 v23, s[60:63], s24 offen lds
 ds_read_b64_tr_b16 v[240:241], v19 offset:24576
 ds_read_b64_tr_b16 v[242:243], v19 offset:25088
 ds_read_b64_tr_b16 v[244:245], v19 offset:28672
 ds_read_b64_tr_b16 v[246:247], v19 offset:29184
 s_waitcnt lgkmcnt(0)
 s_waitcnt vmcnt(29)
 s_barrier
 s_add_u32 m0, s27, 90112
 s_mov_b32 s24, 0x380000
 buffer_load_dwordx4 v24, s[60:63], s24 offen lds
 s_add_u32 m0, s27, 91136
 s_mov_b32 s24, 0x380000
 buffer_load_dwordx4 v23, s[60:63], s24 offen lds
 ds_read_b64_tr_b16 v[248:249], v19 offset:57344
 ds_read_b64_tr_b16 v[250:251], v19 offset:57856
 ds_read_b64_tr_b16 v[252:253], v19 offset:61440
 ds_read_b64_tr_b16 v[254:255], v19 offset:61952
 s_waitcnt lgkmcnt(0)
 s_waitcnt vmcnt(28)
 s_barrier
 s_add_u32 m0, s27, 122880
 s_mov_b32 s24, 0x3c0000
 buffer_load_dwordx4 v24, s[60:63], s24 offen lds
 s_add_u32 m0, s27, 123904
 s_mov_b32 s24, 0x3c0000
 buffer_load_dwordx4 v23, s[60:63], s24 offen lds
 ds_read_b64_tr_b16 a[0:1], v26 offset:0
 ds_read_b64_tr_b16 a[2:3], v26 offset:512
 ds_read_b64_tr_b16 a[4:5], v26 offset:4096
 ds_read_b64_tr_b16 a[6:7], v26 offset:4608
 s_waitcnt lgkmcnt(0)
 s_waitcnt vmcnt(28)
 s_barrier
 s_add_u32 m0, s27, 0
 s_mov_b32 s24, 0x0
 buffer_load_dwordx4 v25, s[72:75], s24 offen lds
 s_add_u32 m0, s27, 1024
 s_mov_b32 s24, 0x1000
 buffer_load_dwordx4 v25, s[72:75], s24 offen lds
 ds_read_b64_tr_b16 a[8:9], v26 offset:32768
 ds_read_b64_tr_b16 a[10:11], v26 offset:33280
 ds_read_b64_tr_b16 a[12:13], v26 offset:36864
 ds_read_b64_tr_b16 a[14:15], v26 offset:37376
 s_waitcnt lgkmcnt(0)
 s_waitcnt vmcnt(28)
 s_barrier
 s_add_u32 m0, s27, 32768
 s_mov_b32 s24, 0x8100
 buffer_load_dwordx4 v25, s[72:75], s24 offen lds
 s_add_u32 m0, s27, 33792
 s_mov_b32 s24, 0x9100
 buffer_load_dwordx4 v25, s[72:75], s24 offen lds
 ds_read_b64_tr_b16 a[16:17], v19 offset:0
 ds_read_b64_tr_b16 a[18:19], v19 offset:512
 ds_read_b64_tr_b16 a[20:21], v19 offset:4096
 ds_read_b64_tr_b16 a[22:23], v19 offset:4608
 s_waitcnt lgkmcnt(0)
 s_waitcnt vmcnt(28)
 s_barrier
 s_add_u32 m0, s27, 65536
 s_mov_b32 s24, 0x10200
 buffer_load_dwordx4 v25, s[72:75], s24 offen lds
 s_add_u32 m0, s27, 66560
 s_mov_b32 s24, 0x11200
 buffer_load_dwordx4 v25, s[72:75], s24 offen lds
 ds_read_b64_tr_b16 a[24:25], v19 offset:32768
 ds_read_b64_tr_b16 a[26:27], v19 offset:33280
 ds_read_b64_tr_b16 a[28:29], v19 offset:36864
 ds_read_b64_tr_b16 a[30:31], v19 offset:37376
 s_waitcnt lgkmcnt(0)
 s_waitcnt vmcnt(28)
 s_barrier
 s_add_u32 m0, s27, 98304
 s_mov_b32 s24, 0x18300
 buffer_load_dwordx4 v25, s[72:75], s24 offen lds
 s_add_u32 m0, s27, 99328
 s_mov_b32 s24, 0x19300
 buffer_load_dwordx4 v25, s[72:75], s24 offen lds
 ds_read_b64_tr_b16 a[32:33], v26 offset:8192
 ds_read_b64_tr_b16 a[34:35], v26 offset:8704
 ds_read_b64_tr_b16 a[36:37], v26 offset:12288
 ds_read_b64_tr_b16 a[38:39], v26 offset:12800
 s_waitcnt lgkmcnt(0)
 s_waitcnt vmcnt(28)
 s_barrier
 s_add_u32 m0, s27, 8192
 s_mov_b32 s24, 0x8000
 buffer_load_dwordx4 v25, s[72:75], s24 offen lds
 s_add_u32 m0, s27, 9216
 s_mov_b32 s24, 0x9000
 buffer_load_dwordx4 v25, s[72:75], s24 offen lds
 ds_read_b64_tr_b16 a[40:41], v26 offset:40960
 ds_read_b64_tr_b16 a[42:43], v26 offset:41472
 ds_read_b64_tr_b16 a[44:45], v26 offset:45056
 ds_read_b64_tr_b16 a[46:47], v26 offset:45568
 s_waitcnt lgkmcnt(0)
 s_waitcnt vmcnt(28)
 s_barrier
 s_add_u32 m0, s27, 40960
 s_mov_b32 s24, 0x100
 buffer_load_dwordx4 v25, s[72:75], s24 offen lds
 s_add_u32 m0, s27, 41984
 s_mov_b32 s24, 0x1100
 buffer_load_dwordx4 v25, s[72:75], s24 offen lds
 ds_read_b64_tr_b16 a[48:49], v19 offset:8192
 ds_read_b64_tr_b16 a[50:51], v19 offset:8704
 ds_read_b64_tr_b16 a[52:53], v19 offset:12288
 ds_read_b64_tr_b16 a[54:55], v19 offset:12800
 s_waitcnt lgkmcnt(0)
 s_waitcnt vmcnt(28)
 s_barrier
 s_add_u32 m0, s27, 73728
 s_mov_b32 s24, 0x18200
 buffer_load_dwordx4 v25, s[72:75], s24 offen lds
 s_add_u32 m0, s27, 74752
 s_mov_b32 s24, 0x19200
 buffer_load_dwordx4 v25, s[72:75], s24 offen lds
 ds_read_b64_tr_b16 a[56:57], v19 offset:40960
 ds_read_b64_tr_b16 a[58:59], v19 offset:41472
 ds_read_b64_tr_b16 a[60:61], v19 offset:45056
 ds_read_b64_tr_b16 a[62:63], v19 offset:45568
 s_waitcnt lgkmcnt(0)
 s_waitcnt vmcnt(28)
 s_barrier
 s_add_u32 m0, s27, 106496
 s_mov_b32 s24, 0x10300
 buffer_load_dwordx4 v25, s[72:75], s24 offen lds
 s_add_u32 m0, s27, 107520
 s_mov_b32 s24, 0x11300
 buffer_load_dwordx4 v25, s[72:75], s24 offen lds
 ds_read_b64_tr_b16 a[64:65], v26 offset:16384
 ds_read_b64_tr_b16 a[66:67], v26 offset:16896
 ds_read_b64_tr_b16 a[68:69], v26 offset:20480
 ds_read_b64_tr_b16 a[70:71], v26 offset:20992
 s_waitcnt lgkmcnt(0)
 s_waitcnt vmcnt(28)
 s_barrier
 s_add_u32 m0, s27, 16384
 s_mov_b32 s24, 0x10000
 buffer_load_dwordx4 v25, s[72:75], s24 offen lds
 s_add_u32 m0, s27, 17408
 s_mov_b32 s24, 0x11000
 buffer_load_dwordx4 v25, s[72:75], s24 offen lds
 ds_read_b64_tr_b16 a[72:73], v26 offset:49152
 ds_read_b64_tr_b16 a[74:75], v26 offset:49664
 ds_read_b64_tr_b16 a[76:77], v26 offset:53248
 ds_read_b64_tr_b16 a[78:79], v26 offset:53760
 s_waitcnt lgkmcnt(0)
 s_waitcnt vmcnt(28)
 s_barrier
 s_add_u32 m0, s27, 49152
 s_mov_b32 s24, 0x18100
 buffer_load_dwordx4 v25, s[72:75], s24 offen lds
 s_add_u32 m0, s27, 50176
 s_mov_b32 s24, 0x19100
 buffer_load_dwordx4 v25, s[72:75], s24 offen lds
 ds_read_b64_tr_b16 a[80:81], v19 offset:16384
 ds_read_b64_tr_b16 a[82:83], v19 offset:16896
 ds_read_b64_tr_b16 a[84:85], v19 offset:20480
 ds_read_b64_tr_b16 a[86:87], v19 offset:20992
 s_waitcnt lgkmcnt(0)
 s_waitcnt vmcnt(28)
 s_barrier
 s_add_u32 m0, s27, 81920
 s_mov_b32 s24, 0x200
 buffer_load_dwordx4 v25, s[72:75], s24 offen lds
 s_add_u32 m0, s27, 82944
 s_mov_b32 s24, 0x1200
 buffer_load_dwordx4 v25, s[72:75], s24 offen lds
 ds_read_b64_tr_b16 a[88:89], v19 offset:49152
 ds_read_b64_tr_b16 a[90:91], v19 offset:49664
 ds_read_b64_tr_b16 a[92:93], v19 offset:53248
 ds_read_b64_tr_b16 a[94:95], v19 offset:53760
 s_waitcnt lgkmcnt(0)
 s_waitcnt vmcnt(28)
 s_barrier
 s_add_u32 m0, s27, 114688
 s_mov_b32 s24, 0x8300
 buffer_load_dwordx4 v25, s[72:75], s24 offen lds
 s_add_u32 m0, s27, 115712
 s_mov_b32 s24, 0x9300
 buffer_load_dwordx4 v25, s[72:75], s24 offen lds
 ds_read_b64_tr_b16 a[96:97], v26 offset:24576
 ds_read_b64_tr_b16 a[98:99], v26 offset:25088
 ds_read_b64_tr_b16 a[100:101], v26 offset:28672
 ds_read_b64_tr_b16 a[102:103], v26 offset:29184
 s_waitcnt lgkmcnt(0)
 s_waitcnt vmcnt(28)
 s_barrier
 s_add_u32 m0, s27, 24576
 s_mov_b32 s24, 0x18000
 buffer_load_dwordx4 v25, s[72:75], s24 offen lds
 s_add_u32 m0, s27, 25600
 s_mov_b32 s24, 0x19000
 buffer_load_dwordx4 v25, s[72:75], s24 offen lds
 ds_read_b64_tr_b16 a[104:105], v26 offset:57344
 ds_read_b64_tr_b16 a[106:107], v26 offset:57856
 ds_read_b64_tr_b16 a[108:109], v26 offset:61440
 ds_read_b64_tr_b16 a[110:111], v26 offset:61952
 s_waitcnt lgkmcnt(0)
 s_waitcnt vmcnt(28)
 s_barrier
 s_add_u32 m0, s27, 57344
 s_mov_b32 s24, 0x10100
 buffer_load_dwordx4 v25, s[72:75], s24 offen lds
 s_add_u32 m0, s27, 58368
 s_mov_b32 s24, 0x11100
 buffer_load_dwordx4 v25, s[72:75], s24 offen lds
 ds_read_b64_tr_b16 a[112:113], v19 offset:24576
 ds_read_b64_tr_b16 a[114:115], v19 offset:25088
 ds_read_b64_tr_b16 a[116:117], v19 offset:28672
 ds_read_b64_tr_b16 a[118:119], v19 offset:29184
 s_waitcnt lgkmcnt(0)
 s_waitcnt vmcnt(28)
 s_barrier
 s_add_u32 m0, s27, 90112
 s_mov_b32 s24, 0x8200
 buffer_load_dwordx4 v25, s[72:75], s24 offen lds
 s_add_u32 m0, s27, 91136
 s_mov_b32 s24, 0x9200
 buffer_load_dwordx4 v25, s[72:75], s24 offen lds
 ds_read_b64_tr_b16 a[120:121], v19 offset:57344
 ds_read_b64_tr_b16 a[122:123], v19 offset:57856
 ds_read_b64_tr_b16 a[124:125], v19 offset:61440
 ds_read_b64_tr_b16 a[126:127], v19 offset:61952
 s_waitcnt lgkmcnt(0)
 s_barrier
 s_add_u32 m0, s27, 122880
 s_mov_b32 s24, 0x300
 buffer_load_dwordx4 v25, s[72:75], s24 offen lds
 s_add_u32 m0, s27, 123904
 s_mov_b32 s24, 0x1300
 buffer_load_dwordx4 v25, s[72:75], s24 offen lds
 s_waitcnt vmcnt(24)
 s_barrier
 ds_read_b64_tr_b16 v[64:65], v27 offset:0
 ds_read_b64_tr_b16 v[66:67], v27 offset:512
 ds_read_b64_tr_b16 v[68:69], v27 offset:2048
 ds_read_b64_tr_b16 v[70:71], v27 offset:2560
 ds_read_b64_tr_b16 v[72:73], v27 offset:64
 ds_read_b64_tr_b16 v[74:75], v27 offset:576
 ds_read_b64_tr_b16 v[76:77], v27 offset:2112
 ds_read_b64_tr_b16 v[78:79], v27 offset:2624
 s_waitcnt lgkmcnt(0)
 ds_read_b64_tr_b16 v[80:81], v27 offset:128
 ds_read_b64_tr_b16 v[82:83], v27 offset:640
 ds_read_b64_tr_b16 v[84:85], v27 offset:2176
 ds_read_b64_tr_b16 v[86:87], v27 offset:2688
 ds_read_b64_tr_b16 v[88:89], v27 offset:192
 ds_read_b64_tr_b16 v[90:91], v27 offset:704
 ds_read_b64_tr_b16 v[92:93], v27 offset:2240
 ds_read_b64_tr_b16 v[94:95], v27 offset:2752
 s_waitcnt lgkmcnt(0)
 ds_write_b128 v22, v[64:67] offset:0
 ds_write_b128 v22, v[68:71] offset:1024
 ds_write_b128 v22, v[72:75] offset:2048
 ds_write_b128 v22, v[76:79] offset:3072
 ds_write_b128 v22, v[80:83] offset:4096
 ds_write_b128 v22, v[84:87] offset:5120
 ds_write_b128 v22, v[88:91] offset:6144
 ds_write_b128 v22, v[92:95] offset:7168
 s_waitcnt lgkmcnt(0)
 s_waitcnt vmcnt(16)
 s_barrier
 buffer_load_dwordx3 v[104:106], off, s[12:15], 0 sc1
 buffer_load_dword v108, off, s[12:15], 0 offset:192 sc1
 ds_read_b64_tr_b16 v[64:65], v27 offset:8192
 ds_read_b64_tr_b16 v[66:67], v27 offset:8704
 ds_read_b64_tr_b16 v[68:69], v27 offset:10240
 ds_read_b64_tr_b16 v[70:71], v27 offset:10752
 ds_read_b64_tr_b16 v[72:73], v27 offset:8256
 ds_read_b64_tr_b16 v[74:75], v27 offset:8768
 ds_read_b64_tr_b16 v[76:77], v27 offset:10304
 ds_read_b64_tr_b16 v[78:79], v27 offset:10816
 s_waitcnt lgkmcnt(0)
 ds_read_b64_tr_b16 v[80:81], v27 offset:8320
 ds_read_b64_tr_b16 v[82:83], v27 offset:8832
 ds_read_b64_tr_b16 v[84:85], v27 offset:10368
 ds_read_b64_tr_b16 v[86:87], v27 offset:10880
 ds_read_b64_tr_b16 v[88:89], v27 offset:8384
 ds_read_b64_tr_b16 v[90:91], v27 offset:8896
 ds_read_b64_tr_b16 v[92:93], v27 offset:10432
 ds_read_b64_tr_b16 v[94:95], v27 offset:10944
 s_waitcnt lgkmcnt(0)
 ds_write_b128 v22, v[64:67] offset:8192
 ds_write_b128 v22, v[68:71] offset:9216
 ds_write_b128 v22, v[72:75] offset:10240
 ds_write_b128 v22, v[76:79] offset:11264
 ds_write_b128 v22, v[80:83] offset:12288
 ds_write_b128 v22, v[84:87] offset:13312
 ds_write_b128 v22, v[88:91] offset:14336
 ds_write_b128 v22, v[92:95] offset:15360
 s_waitcnt lgkmcnt(0)
 s_waitcnt vmcnt(8)
 s_barrier
 ds_read_b64_tr_b16 v[64:65], v27 offset:16384
 ds_read_b64_tr_b16 v[66:67], v27 offset:16896
 ds_read_b64_tr_b16 v[68:69], v27 offset:18432
 ds_read_b64_tr_b16 v[70:71], v27 offset:18944
 ds_read_b64_tr_b16 v[72:73], v27 offset:16448
 ds_read_b64_tr_b16 v[74:75], v27 offset:16960
 ds_read_b64_tr_b16 v[76:77], v27 offset:18496
 ds_read_b64_tr_b16 v[78:79], v27 offset:19008
 s_waitcnt lgkmcnt(0)
 ds_read_b64_tr_b16 v[80:81], v27 offset:16512
 ds_read_b64_tr_b16 v[82:83], v27 offset:17024
 ds_read_b64_tr_b16 v[84:85], v27 offset:18560
 ds_read_b64_tr_b16 v[86:87], v27 offset:19072
 ds_read_b64_tr_b16 v[88:89], v27 offset:16576
 ds_read_b64_tr_b16 v[90:91], v27 offset:17088
 ds_read_b64_tr_b16 v[92:93], v27 offset:18624
 ds_read_b64_tr_b16 v[94:95], v27 offset:19136
 s_waitcnt lgkmcnt(0)
 ds_write_b128 v22, v[64:67] offset:16384
 ds_write_b128 v22, v[68:71] offset:17408
 ds_write_b128 v22, v[72:75] offset:18432
 ds_write_b128 v22, v[76:79] offset:19456
 ds_write_b128 v22, v[80:83] offset:20480
 ds_write_b128 v22, v[84:87] offset:21504
 ds_write_b128 v22, v[88:91] offset:22528
 ds_write_b128 v22, v[92:95] offset:23552
 s_waitcnt lgkmcnt(0)
 s_waitcnt vmcnt(0)
 s_barrier
 s_waitcnt vmcnt(0)
 v_cmp_le_u32 vcc, 128, v106
 v_cmp_le_u32 s[48:49], 32, v104
 v_cmp_le_u32 s[50:51], 48, v108
 s_and_b64 vcc, vcc, s[48:49]
 s_and_b64 vcc, vcc, s[50:51]
 s_cbranch_scc0 L_ck1_55
 s_mov_b32 s90, 1
 buffer_load_dword v9, off, s[4:7], s36 sc1
 s_nop 0
 s_add_u32 s24, s37, s35
 buffer_load_dwordx4 v[104:107], v1, s[4:7], s24 offen offset:0 sc1
 buffer_load_dwordx4 v[108:111], v1, s[4:7], s24 offen offset:1024 sc1
 s_add_u32 s24, s24, 0x40000
 buffer_load_dwordx4 v[112:115], v1, s[4:7], s24 offen offset:0 sc1
 buffer_load_dwordx4 v[116:119], v1, s[4:7], s24 offen offset:1024 sc1
 s_add_u32 s24, s24, 0x40000
 s_lshl_b32 s24, s17, 13
 s_add_u32 s24, s24, 0x100000
 buffer_load_dwordx2 v[120:121], v7, s[4:7], s24 offen sc1
L_ck1_55:
 ds_read_b64_tr_b16 v[64:65], v27 offset:24576
 ds_read_b64_tr_b16 v[66:67], v27 offset:25088
 ds_read_b64_tr_b16 v[68:69], v27 offset:26624
 ds_read_b64_tr_b16 v[70:71], v27 offset:27136
 ds_read_b64_tr_b16 v[72:73], v27 offset:24640
 ds_read_b64_tr_b16 v[74:75], v27 offset:25152
 ds_read_b64_tr_b16 v[76:77], v27 offset:26688
 ds_read_b64_tr_b16 v[78:79], v27 offset:27200
 s_waitcnt lgkmcnt(0)
 ds_read_b64_tr_b16 v[80:81], v27 offset:24704
 ds_read_b64_tr_b16 v[82:83], v27 offset:25216
 ds_read_b64_tr_b16 v[84:85], v27 offset:26752
 ds_read_b64_tr_b16 v[86:87], v27 offset:27264
 ds_read_b64_tr_b16 v[88:89], v27 offset:24768
 ds_read_b64_tr_b16 v[90:91], v27 offset:25280
 ds_read_b64_tr_b16 v[92:93], v27 offset:26816
 ds_read_b64_tr_b16 v[94:95], v27 offset:27328
 s_waitcnt lgkmcnt(0)
 ds_write_b128 v22, v[64:67] offset:24576
 ds_write_b128 v22, v[68:71] offset:25600
 ds_write_b128 v22, v[72:75] offset:26624
 ds_write_b128 v22, v[76:79] offset:27648
 ds_write_b128 v22, v[80:83] offset:28672
 ds_write_b128 v22, v[84:87] offset:29696
 ds_write_b128 v22, v[88:91] offset:30720
 ds_write_b128 v22, v[92:95] offset:31744
 s_waitcnt lgkmcnt(0)
 s_mov_b32 s54, s33
 s_mov_b32 s55, s33
 s_mov_b32 s52, 0
 ds_write_b128 v3, v[96:99] offset:0
 ds_write_b128 v3, v[100:103] offset:1024
 s_cmp_eq_u32 s90, 1
 s_cbranch_scc1 L_pokf_57
 s_mov_b32 s23, 0
L_pw_58:
 buffer_load_dword v64, off, s[12:15], 0 offset:192 sc1
 s_add_u32 s23, s23, 1
 s_cmp_gt_u32 s23, 0x40000
 s_cbranch_scc1 L_bail
 s_waitcnt vmcnt(0)
 v_cmp_le_u32 vcc, 48, v64
 s_cbranch_vccz L_pw_58
 s_mov_b32 s23, 0
L_pw_59:
 buffer_load_dword v64, off, s[12:15], 0 offset:8 sc1
 s_add_u32 s23, s23, 1
 s_cmp_gt_u32 s23, 0x40000
 s_cbranch_scc1 L_bail
 s_waitcnt vmcnt(0)
 v_cmp_le_u32 vcc, 128, v64
 s_cbranch_vccz L_pw_59
 s_mov_b32 s23, 0
L_mode:
 buffer_load_dword v72, off, s[12:15], 0 sc1
 buffer_load_dwordx4 v[76:79], off, s[12:15], 0 offset:64 sc1
 buffer_load_dwordx4 v[80:83], off, s[12:15], 0 offset:128 sc1
 s_add_u32 s23, s23, 1
 s_cmp_gt_u32 s23, 262144
 s_cbranch_scc1 L_bail
 s_waitcnt vmcnt(0)
 s_mov_b32 s89, 0
 v_cmp_le_u32 vcc, 32, v72
 s_cbranch_vccnz L_mode_ok
 s_mov_b32 s89, 1
 v_add3_u32 v72, v72, v76, v77
 v_add3_u32 v72, v72, v78, v79
 v_add3_u32 v72, v72, v80, v81
 v_add3_u32 v72, v72, v82, v83
 v_cmp_le_u32 vcc, 256, v72
 s_cbranch_vccz L_mode
L_mode_ok:
 s_add_u32 s24, s37, s35
 buffer_load_dwordx4 v[104:107], v1, s[4:7], s24 offen offset:0 sc1
 buffer_load_dwordx4 v[108:111], v1, s[4:7], s24 offen offset:1024 sc1
 s_add_u32 s24, s24, 0x40000
 buffer_load_dwordx4 v[112:115], v1, s[4:7], s24 offen offset:0 sc1
 buffer_load_dwordx4 v[116:119], v1, s[4:7], s24 offen offset:1024 sc1
 s_add_u32 s24, s24, 0x40000
 s_lshl_b32 s24, s17, 13
 s_add_u32 s24, s24, 0x100000
 buffer_load_dwordx2 v[120:121], v7, s[4:7], s24 offen sc1
 s_branch L_pok1_56
L_pokf_57:
 s_waitcnt vmcnt(5)
 v_readfirstlane_b32 s52, v9
 s_nop 3
L_pok1_56:
 s_cmp_lg_u32 s52, 0
 s_cbranch_scc1 L_fok_60
 s_mov_b32 s23, 0
L_fspin_61:
 buffer_load_dword v9, off, s[4:7], s36 sc1
 s_add_u32 s23, s23, 1
 s_cmp_gt_u32 s23, 0x40000
 s_cbranch_scc1 L_bail
 s_waitcnt vmcnt(0)
 v_cmp_ne_u32 vcc, 0, v9
 s_cbranch_vccz L_fspin_61
L_fok_60:
 s_add_u32 m0, s35, 0
 s_add_u32 s24, s21, 0
 buffer_load_dwordx4 v1, s[4:7], s24 offen sc1 lds
 s_add_u32 m0, s35, 1024
 s_add_u32 s24, s21, 1024
 s_add_u32 s21, s21, 16384
 buffer_load_dwordx4 v1, s[4:7], s24 offen sc1 lds
 s_add_u32 m0, s34, 0
 s_add_u32 s24, s32, 0
 buffer_load_dwordx4 v1, s[4:7], s24 offen sc1 lds
 s_add_u32 m0, s34, 1024
 s_add_u32 s24, s32, 1024
 s_add_u32 s32, s32, 16384
 buffer_load_dwordx4 v1, s[4:7], s24 offen sc1 lds
 s_add_u32 s36, s36, 128
 buffer_load_dword v9, off, s[4:7], s36 sc1
 s_waitcnt vmcnt(0) lgkmcnt(0)
 v_readfirstlane_b32 s52, v9
 v_mov_b64 v[112:113], 0
 v_mov_b64 v[114:115], 0
 v_mov_b64 v[116:117], 0
 v_mov_b64 v[118:119], 0
 v_mov_b64 v[120:121], 0
 v_mov_b64 v[122:123], 0
 s_barrier
 ds_read_b128 v[80:83], v1 offset:0
 ds_read_b128 v[84:87], v1 offset:1024
 ds_read_b128 v[88:91], v1 offset:2048
 ds_read_b128 v[92:95], v1 offset:3072
 ds_read_b128 v[96:99], v1 offset:4096
 ds_read_b128 v[100:103], v1 offset:5120
 ds_read_b128 v[104:107], v1 offset:6144
 ds_read_b128 v[108:111], v1 offset:7168
 s_waitcnt lgkmcnt(0)
 s_barrier
 s_cmp_eq_u32 s89, 0
 s_cbranch_scc0 L_mixed
 s_mov_b32 s18, 0
.p2align 6
L_rloop_62:
 s_waitcnt lgkmcnt(0)
 s_barrier
 ds_read_b128 v[16:19], v2 offset:0
 ds_read_b128 v[20:23], v2 offset:512
 ds_read_b128 v[24:27], v2 offset:1024
 ds_read_b128 v[28:31], v2 offset:1536
 s_cmp_lg_u32 s52, 0
 s_cbranch_scc0 L_fspin_64_e
L_fok_63:
 s_waitcnt lgkmcnt(3)
 v_smfmac_f32_16x16x64_bf16 v[112:115], v[16:19], a[0:7], v0
 ds_read_b128 v[32:35], v2 offset:2048
 v_smfmac_f32_16x16x64_bf16 v[116:119], v[16:19], a[128:135], v0
 v_mov_b64 v[60:61], s[86:87]
 s_waitcnt lgkmcnt(3)
 v_smfmac_f32_16x16x64_bf16 v[112:115], v[20:23], a[8:15], v0
 ds_read_b128 v[36:39], v2 offset:2560
 v_smfmac_f32_16x16x64_bf16 v[116:119], v[20:23], a[136:143], v0
 v_mov_b64 v[62:63], s[86:87]
 s_add_u32 s26, s19, 0x40000
 s_and_b32 s26, s26, 0x40000
 s_waitcnt lgkmcnt(3)
 v_smfmac_f32_16x16x64_bf16 v[112:115], v[24:27], a[16:23], v0
 ds_read_b128 v[40:43], v2 offset:3072
 v_smfmac_f32_16x16x64_bf16 v[116:119], v[24:27], a[144:151], v0
 s_add_u32 s26, s26, s37
 s_add_u32 s26, s26, s35
 s_xor_b32 s27, s20, 0x4000
 s_waitcnt lgkmcnt(3)
 v_smfmac_f32_16x16x64_bf16 v[112:115], v[28:31], a[24:31], v0
 ds_read_b128 v[44:47], v2 offset:3584
 v_smfmac_f32_16x16x64_bf16 v[116:119], v[28:31], a[152:159], v0
 buffer_store_dwordx4 v[60:63], v1, s[4:7], s26 offen offset:0
 s_waitcnt lgkmcnt(3)
 v_smfmac_f32_16x16x64_bf16 v[112:115], v[32:35], a[32:39], v0
 ds_read_b128 v[48:51], v2 offset:4096
 v_smfmac_f32_16x16x64_bf16 v[116:119], v[32:35], a[160:167], v0
 buffer_store_dwordx4 v[60:63], v1, s[4:7], s26 offen offset:1024
 s_waitcnt lgkmcnt(3)
 v_smfmac_f32_16x16x64_bf16 v[112:115], v[36:39], a[40:47], v0
 ds_read_b128 v[52:55], v2 offset:4608
 v_smfmac_f32_16x16x64_bf16 v[116:119], v[36:39], a[168:175], v0
 buffer_store_dwordx2 v[60:61], v7, s[4:7], s27 offen
 s_waitcnt lgkmcnt(3)
 v_smfmac_f32_16x16x64_bf16 v[112:115], v[40:43], a[48:55], v0
 ds_read_b128 v[56:59], v2 offset:5120
 v_smfmac_f32_16x16x64_bf16 v[116:119], v[40:43], a[176:183], v0
 s_add_u32 m0, s35, 0
 s_add_u32 s24, s21, 0
 s_waitcnt lgkmcnt(3)
 v_smfmac_f32_16x16x64_bf16 v[112:115], v[44:47], a[56:63], v0
 ds_read_b128 v[60:63], v2 offset:5632
 v_smfmac_f32_16x16x64_bf16 v[116:119], v[44:47], a[184:191], v0
 buffer_load_dwordx4 v1, s[4:7], s24 offen sc1 lds
 s_waitcnt lgkmcnt(3)
 v_smfmac_f32_16x16x64_bf16 v[112:115], v[48:51], a[64:71], v0
 s_waitcnt vmcnt(4)
 ds_read_b128 v[64:67], v2 offset:6144
 v_smfmac_f32_16x16x64_bf16 v[116:119], v[48:51], a[192:199], v0
 s_add_u32 m0, s35, 1024
 s_add_u32 s24, s21, 1024
 s_add_u32 s21, s21, 16384
 s_waitcnt lgkmcnt(3)
 v_smfmac_f32_16x16x64_bf16 v[112:115], v[52:55], a[72:79], v0
 ds_read_b128 v[68:71], v2 offset:6656
 v_smfmac_f32_16x16x64_bf16 v[116:119], v[52:55], a[200:207], v0
 buffer_load_dwordx4 v1, s[4:7], s24 offen sc1 lds
 s_waitcnt lgkmcnt(3)
 v_smfmac_f32_16x16x64_bf16 v[112:115], v[56:59], a[80:87], v0
 ds_read_b128 v[72:75], v2 offset:7168
 v_smfmac_f32_16x16x64_bf16 v[116:119], v[56:59], a[208:215], v0
 s_add_u32 s36, s36, 128
 buffer_load_dword v9, off, s[4:7], s36 sc1
 s_waitcnt lgkmcnt(3)
 v_smfmac_f32_16x16x64_bf16 v[112:115], v[60:63], a[88:95], v0
 ds_read_b128 v[76:79], v2 offset:7680
 v_smfmac_f32_16x16x64_bf16 v[116:119], v[60:63], a[216:223], v0
 s_xor_b32 s34, s34, 0x6000
 s_waitcnt lgkmcnt(3)
 v_smfmac_f32_16x16x64_bf16 v[112:115], v[64:67], a[96:103], v0
 v_smfmac_f32_16x16x64_bf16 v[116:119], v[64:67], a[224:231], v0
 s_lshl_b32 s24, s17, 10
 s_add_u32 s24, s24, s22
 buffer_store_dwordx4 v[12:15], v1, s[4:7], s24 offen sc1
 s_add_u32 s22, s22, 4096
 s_waitcnt lgkmcnt(2)
 v_smfmac_f32_16x16x64_bf16 v[112:115], v[68:71], a[104:111], v0
 v_smfmac_f32_16x16x64_bf16 v[116:119], v[68:71], a[232:239], v0
 s_waitcnt lgkmcnt(1)
 v_smfmac_f32_16x16x64_bf16 v[112:115], v[72:75], a[112:119], v0
 v_smfmac_f32_16x16x64_bf16 v[116:119], v[72:75], a[240:247], v0
 s_waitcnt lgkmcnt(0)
 v_smfmac_f32_16x16x64_bf16 v[112:115], v[76:79], a[120:127], v0
 v_smfmac_f32_16x16x64_bf16 v[116:119], v[76:79], a[248:255], v0
 v_smfmac_f32_16x16x64_bf16 v[120:123], v[16:19], v[128:135], v0
 v_cvt_pk_bf16_f32 v14, v112, v113
 v_smfmac_f32_16x16x64_bf16 v[120:123], v[20:23], v[136:143], v0
 v_cvt_pk_bf16_f32 v15, v114, v115
 v_cvt_pk_bf16_f32 v12, v116, v117
 v_cvt_pk_bf16_f32 v13, v118, v119
 v_smfmac_f32_16x16x64_bf16 v[120:123], v[24:27], v[144:151], v0
 ds_write2st64_b64 v4, v[14:15], v[12:13] offset0:0 offset1:5
 v_smfmac_f32_16x16x64_bf16 v[120:123], v[28:31], v[152:159], v0
 v_smfmac_f32_16x16x64_bf16 v[120:123], v[32:35], v[160:167], v0
 v_smfmac_f32_16x16x64_bf16 v[120:123], v[36:39], v[168:175], v0
 v_smfmac_f32_16x16x64_bf16 v[120:123], v[40:43], v[176:183], v0
 v_smfmac_f32_16x16x64_bf16 v[120:123], v[44:47], v[184:191], v0
 s_waitcnt lgkmcnt(0)
 s_barrier
 ds_read_b64_tr_b16 v[16:17], v5 offset:0
 ds_read_b64_tr_b16 v[18:19], v5 offset:32
 v_smfmac_f32_16x16x64_bf16 v[120:123], v[48:51], v[192:199], v0
 ds_read_b64_tr_b16 v[20:21], v5 offset:256
 ds_read_b64_tr_b16 v[22:23], v5 offset:288
 v_smfmac_f32_16x16x64_bf16 v[120:123], v[52:55], v[200:207], v0
 ds_read_b64_tr_b16 v[24:25], v5 offset:512
 ds_read_b64_tr_b16 v[26:27], v5 offset:544
 v_smfmac_f32_16x16x64_bf16 v[120:123], v[56:59], v[208:215], v0
 ds_read_b64_tr_b16 v[28:29], v5 offset:768
 ds_read_b64_tr_b16 v[30:31], v5 offset:800
 v_smfmac_f32_16x16x64_bf16 v[120:123], v[60:63], v[216:223], v0
 ds_read_b64_tr_b16 v[32:33], v5 offset:2560
 ds_read_b64_tr_b16 v[34:35], v5 offset:2592
 s_waitcnt lgkmcnt(8)
 v_mfma_f32_16x16x32_bf16 v[116:119], v[80:83], v[16:19], 0
 ds_read_b64_tr_b16 v[36:37], v5 offset:2816
 ds_read_b64_tr_b16 v[38:39], v5 offset:2848
 v_mfma_f32_16x16x32_bf16 v[44:47], v[96:99], v[16:19], 0
 ds_read_b64_tr_b16 v[40:41], v5 offset:3072
 ds_read_b64_tr_b16 v[42:43], v5 offset:3104
 s_waitcnt lgkmcnt(10)
 v_mfma_f32_16x16x32_bf16 v[116:119], v[84:87], v[20:23], v[116:119]
 ds_read_b64_tr_b16 v[112:113], v5 offset:3328
 ds_read_b64_tr_b16 v[114:115], v5 offset:3360
 v_mfma_f32_16x16x32_bf16 v[44:47], v[100:103], v[20:23], v[44:47]
 s_add_u32 m0, s34, 0
 s_add_u32 s24, s32, 0
 ds_read_b128 v[80:83], v8 offset:0
 s_waitcnt lgkmcnt(9)
 v_mfma_f32_16x16x32_bf16 v[116:119], v[88:91], v[24:27], v[116:119]
 buffer_load_dwordx4 v1, s[4:7], s24 offen sc1 lds
 ds_read_b128 v[84:87], v8 offset:1024
 v_mfma_f32_16x16x32_bf16 v[44:47], v[104:107], v[24:27], v[44:47]
 s_add_u32 m0, s34, 1024
 s_add_u32 s24, s32, 1024
 s_add_u32 s32, s32, 16384
 ds_read_b128 v[96:99], v8 offset:4096
 v_mfma_f32_16x16x32_bf16 v[116:119], v[92:95], v[28:31], v[116:119]
 buffer_load_dwordx4 v1, s[4:7], s24 offen sc1 lds
 ds_read_b128 v[100:103], v8 offset:5120
 v_mfma_f32_16x16x32_bf16 v[44:47], v[108:111], v[28:31], v[44:47]
 ds_read_b128 v[88:91], v8 offset:2048
 s_waitcnt lgkmcnt(5)
 v_mfma_f32_16x16x32_bf16 v[48:51], v[32:35], v[16:19], 0
 ds_read_b128 v[92:95], v8 offset:3072
 v_mfma_f32_16x16x32_bf16 v[48:51], v[36:39], v[20:23], v[48:51]
 ds_read_b128 v[104:107], v8 offset:6144
 v_mfma_f32_16x16x32_bf16 v[48:51], v[40:43], v[24:27], v[48:51]
 ds_read_b128 v[108:111], v8 offset:7168
 v_max3_f32 v124, v116, v117, v118
 v_mfma_f32_16x16x32_bf16 v[48:51], v[112:115], v[28:31], v[48:51]
 ds_read_b128 v[52:55], v11 offset:0
 v_max3_f32 v125, v44, v45, v46
 v_smfmac_f32_16x16x64_bf16 v[120:123], v[64:67], v[224:231], v0
 ds_read_b128 v[16:19], v8 offset:8192
 v_max3_f32 v124, v124, v119, v47
 v_smfmac_f32_16x16x64_bf16 v[120:123], v[68:71], v[232:239], v0
 ds_read_b128 v[56:59], v11 offset:1024
 v_max3_f32 v125, v125, v48, v49
 v_max3_f32 v124, v124, v50, v51
 v_max_f32 v124, v124, v125
 v_mov_b32 v125, v124
 v_smfmac_f32_16x16x64_bf16 v[120:123], v[72:75], v[240:247], v0
 ds_read_b128 v[20:23], v8 offset:9216
 v_permlane16_swap_b32 v125, v124
 v_max_f32 v124, v124, v125
 v_mov_b32 v125, v124
 v_smfmac_f32_16x16x64_bf16 v[120:123], v[76:79], v[248:255], v0
 ds_read_b128 v[24:27], v8 offset:16384
 v_permlane32_swap_b32 v125, v124
 v_max_f32 v124, v124, v125
 v_mul_f32 v124, s33, v124
 v_pk_fma_f32 v[116:117], v[116:117], s[54:55], v[124:125] op_sel_hi:[1,1,0] neg_lo:[0,0,1] neg_hi:[0,0,1]
 v_pk_fma_f32 v[118:119], v[118:119], s[54:55], v[124:125] op_sel_hi:[1,1,0] neg_lo:[0,0,1] neg_hi:[0,0,1]
 v_pk_fma_f32 v[44:45], v[44:45], s[54:55], v[124:125] op_sel_hi:[1,1,0] neg_lo:[0,0,1] neg_hi:[0,0,1]
 v_pk_fma_f32 v[46:47], v[46:47], s[54:55], v[124:125] op_sel_hi:[1,1,0] neg_lo:[0,0,1] neg_hi:[0,0,1]
 v_pk_fma_f32 v[48:49], v[48:49], s[54:55], v[124:125] op_sel_hi:[1,1,0] neg_lo:[0,0,1] neg_hi:[0,0,1]
 v_pk_fma_f32 v[50:51], v[50:51], s[54:55], v[124:125] op_sel_hi:[1,1,0] neg_lo:[0,0,1] neg_hi:[0,0,1]
 v_exp_f32 v116, v116
 v_exp_f32 v117, v117
 v_exp_f32 v118, v118
 v_exp_f32 v119, v119
 v_exp_f32 v44, v44
 v_exp_f32 v45, v45
 v_exp_f32 v46, v46
 v_exp_f32 v47, v47
 v_exp_f32 v48, v48
 v_exp_f32 v49, v49
 v_exp_f32 v50, v50
 v_exp_f32 v51, v51
 v_cvt_pk_bf16_f32 v60, v116, v117
 v_cvt_pk_bf16_f32 v61, v118, v119
 v_cvt_pk_bf16_f32 v62, v44, v45
 v_cvt_pk_bf16_f32 v63, v46, v47
 v_cvt_pk_bf16_f32 v14, v120, v121
 v_cvt_pk_bf16_f32 v15, v122, v123
 s_waitcnt lgkmcnt(2)
 v_mfma_f32_16x16x32_bf16 v[72:75], v[52:55], v[60:63], 0
 ds_read_b128 v[28:31], v8 offset:17408
 v_cvt_pk_bf16_f32 v64, v48, v49
 v_cvt_pk_bf16_f32 v65, v50, v51
 v_mfma_f32_16x16x32_bf16 v[76:79], v[56:59], v[60:63], 0
 ds_read_b128 v[32:35], v8 offset:24576
 v_cndmask_b32 v66, 0, v14, s[28:29]
 v_cndmask_b32 v67, 0, v15, s[28:29]
 v_cndmask_b32 v68, 0, v14, s[30:31]
 v_cndmask_b32 v69, 0, v15, s[30:31]
 v_mfma_f32_16x16x16_bf16 v[72:75], v[66:67], v[64:65], v[72:75]
 ds_read_b128 v[36:39], v8 offset:25600
 v_mov_b64 v[40:41], s[56:57]
 v_mov_b64 v[42:43], s[56:57]
 v_mfma_f32_16x16x16_bf16 v[76:79], v[68:69], v[64:65], v[76:79]
 ds_read_b128 v[120:123], v8 offset:10240
 v_mov_b64 v[70:71], s[58:59]
 v_mfma_f32_16x16x32_bf16 v[112:115], v[60:63], v[40:43], 0
 ds_read_b128 v[124:127], v8 offset:11264
 v_mov_b64 v[44:45], 0
 v_mov_b64 v[46:47], 0
 v_mov_b64 v[48:49], 0
 v_mov_b64 v[50:51], 0
 v_cvt_pk_bf16_f32 v60, v72, v73
 v_cvt_pk_bf16_f32 v61, v74, v75
 v_cvt_pk_bf16_f32 v62, v76, v77
 v_cvt_pk_bf16_f32 v63, v78, v79
 ds_write_b128 v10, v[60:63]
 s_nop 0
 v_smfmac_f32_16x16x64_bf16 v[44:47], v[60:63], v[80:87], v0
 ds_read_b128 v[72:75], v8 offset:18432
 v_xor_b32 v66, 512, v10
 v_smfmac_f32_16x16x64_bf16 v[48:51], v[60:63], v[96:103], v0
 ds_read_b128 v[76:79], v8 offset:19456
 v_mov_b64 v[40:41], 0
 v_mov_b64 v[42:43], 0
 v_mov_b64 v[116:117], 0
 v_mov_b64 v[118:119], 0
 v_mfma_f32_16x16x16_bf16 v[112:115], v[64:65], v[70:71], v[112:115]
 v_xor_b32 v67, 1024, v10
 v_xor_b32 v68, 1536, v10
 v_smfmac_f32_16x16x64_bf16 v[40:43], v[60:63], v[88:95], v0
 ds_read_b128 v[80:83], v8 offset:26624
 ds_read_b128 v[84:87], v8 offset:27648
 v_smfmac_f32_16x16x64_bf16 v[116:119], v[60:63], v[104:111], v0
 s_waitcnt vmcnt(6)
 s_waitcnt lgkmcnt(4)
 s_barrier
 ds_read_b128 v[52:55], v66
 ds_read_b128 v[56:59], v67
 ds_read_b128 v[64:67], v68
 ds_read_b128 v[96:99], v8 offset:12288
 ds_read_b128 v[100:103], v8 offset:13312
 v_rcp_f32 v112, v112
 v_rcp_f32 v113, v113
 v_rcp_f32 v114, v114
 v_rcp_f32 v115, v115
 s_waitcnt lgkmcnt(4)
 v_smfmac_f32_16x16x64_bf16 v[44:47], v[52:55], v[16:23], v0
 ds_read_b128 v[88:91], v8 offset:20480
 s_waitcnt lgkmcnt(4)
 v_smfmac_f32_16x16x64_bf16 v[44:47], v[56:59], v[24:31], v0
 ds_read_b128 v[92:95], v8 offset:21504
 s_waitcnt lgkmcnt(4)
 v_smfmac_f32_16x16x64_bf16 v[44:47], v[64:67], v[32:39], v0
 ds_read_b128 v[104:107], v8 offset:28672
 v_smfmac_f32_16x16x64_bf16 v[40:43], v[52:55], v[120:127], v0
 ds_read_b128 v[108:111], v8 offset:29696
 s_mov_b32 s24, s19
 s_add_u32 s25, s19, 32768
 v_smfmac_f32_16x16x64_bf16 v[40:43], v[56:59], v[72:79], v0
 ds_read_b128 v[16:19], v8 offset:14336
 v_mul_f32 v44, v44, v112
 v_mul_f32 v45, v45, v113
 v_smfmac_f32_16x16x64_bf16 v[40:43], v[64:67], v[80:87], v0
 ds_read_b128 v[20:23], v8 offset:15360
 s_waitcnt lgkmcnt(6)
 v_mul_f32 v46, v46, v114
 v_mul_f32 v47, v47, v115
 v_smfmac_f32_16x16x64_bf16 v[48:51], v[52:55], v[96:103], v0
 ds_read_b128 v[24:27], v8 offset:22528
 s_waitcnt lgkmcnt(5)
 v_cvt_pk_bf16_f32 v120, v44, v45
 v_cvt_pk_bf16_f32 v121, v46, v47
 v_smfmac_f32_16x16x64_bf16 v[48:51], v[56:59], v[88:95], v0
 buffer_store_dwordx2 v[120:121], v6, s[4:7], s24 offen offset:0
 ds_read_b128 v[28:31], v8 offset:23552
 s_waitcnt lgkmcnt(4)
 v_mul_f32 v40, v40, v112
 v_mul_f32 v41, v41, v113
 v_smfmac_f32_16x16x64_bf16 v[48:51], v[64:67], v[104:111], v0
 ds_read_b128 v[32:35], v8 offset:30720
 s_waitcnt lgkmcnt(3)
 v_mul_f32 v42, v42, v114
 v_mul_f32 v43, v43, v115
 v_smfmac_f32_16x16x64_bf16 v[116:119], v[52:55], v[16:23], v0
 ds_read_b128 v[36:39], v8 offset:31744
 s_waitcnt lgkmcnt(2)
 v_cvt_pk_bf16_f32 v122, v40, v41
 v_cvt_pk_bf16_f32 v123, v42, v43
 v_smfmac_f32_16x16x64_bf16 v[116:119], v[56:59], v[24:31], v0
 buffer_store_dwordx2 v[122:123], v6, s[4:7], s24 offen offset:128
 s_waitcnt lgkmcnt(0)
 v_mul_f32 v48, v48, v112
 v_mul_f32 v49, v49, v113
 v_smfmac_f32_16x16x64_bf16 v[116:119], v[64:67], v[32:39], v0
 v_mul_f32 v50, v50, v114
 v_mul_f32 v51, v51, v115
 v_cvt_pk_bf16_f32 v124, v48, v49
 v_cvt_pk_bf16_f32 v125, v50, v51
 buffer_store_dwordx2 v[124:125], v6, s[4:7], s25 offen offset:0
 s_nop 2
 v_pk_mul_f32 v[116:117], v[116:117], v[112:113]
 v_pk_mul_f32 v[118:119], v[118:119], v[114:115]
 v_cvt_pk_bf16_f32 v126, v116, v117
 v_cvt_pk_bf16_f32 v127, v118, v119
 buffer_store_dwordx2 v[126:127], v6, s[4:7], s25 offen offset:128
 s_cmp_lt_u32 s17, 2
 s_cbranch_scc0 L_w123_66
 s_lshl_b32 s26, s17, 7
 s_add_u32 s24, s19, s37
 s_add_u32 s24, s24, s26
 s_add_u32 s25, s24, 4096
 s_lshl_b32 s26, s17, 9
 s_add_u32 s85, s20, s26
 s_mov_b32 s23, 0
 v_lshrrev_b32 v56, 7, v1
 v_and_b32 v57, 0x70, v1
 v_lshl_add_u32 v56, v56, 8, v57
 v_subrev_u32 v57, 508, v7
 v_cndmask_b32 v57, v7, v57, s[30:31]
 v_bfe_u32 v52, v1, 5, 2
 v_bfe_u32 v53, v1, 4, 1
 v_mov_b32 v54, 0x3f80
 v_lshlrev_b32 v53, 4, v53
 v_lshlrev_b32 v54, v53, v54
 v_cmp_eq_u32 s[76:77], 0, v52
 v_cmp_eq_u32 s[78:79], 1, v52
 v_cmp_eq_u32 s[80:81], 2, v52
 v_cmp_eq_u32 s[82:83], 3, v52
 v_cndmask_b32 v48, 0, v54, s[76:77]
 v_cndmask_b32 v49, 0, v54, s[78:79]
 v_cndmask_b32 v50, 0, v54, s[80:81]
 v_cndmask_b32 v51, 0, v54, s[82:83]
 s_waitcnt vmcnt(7)
 s_barrier
 s_cmp_eq_u32 s17, 0
 s_cbranch_scc0 L_h1w1_75
 ds_read_b128 v[80:83], v1 offset:0
 ds_read_b128 v[84:87], v1 offset:1024
 ds_read_b128 v[88:91], v1 offset:2048
 ds_read_b128 v[92:95], v1 offset:3072
 ds_read_b128 v[96:99], v1 offset:4096
 ds_read_b128 v[100:103], v1 offset:5120
 buffer_load_dwordx4 v[16:19], v56, s[4:7], s24 offen offset:0 sc1
 buffer_load_dwordx4 v[20:23], v56, s[4:7], s24 offen offset:2048 sc1
 buffer_load_dwordx4 v[24:27], v56, s[4:7], s25 offen offset:0 sc1
 buffer_load_dwordx4 v[28:31], v56, s[4:7], s25 offen offset:2048 sc1
 ds_read_b128 v[104:107], v1 offset:6144
 ds_read_b128 v[108:111], v1 offset:7168
 s_branch L_h1go_76
L_h1w1_75:
 ds_read_b128 v[80:83], v1 offset:0
 ds_read_b128 v[84:87], v1 offset:1024
 ds_read_b128 v[88:91], v1 offset:2048
 ds_read_b128 v[92:95], v1 offset:3072
 ds_read_b128 v[96:99], v1 offset:4096
 ds_read_b128 v[100:103], v1 offset:5120
 ds_read_b128 v[104:107], v1 offset:6144
 ds_read_b128 v[108:111], v1 offset:7168
 buffer_load_dwordx4 v[16:19], v56, s[4:7], s24 offen offset:0 sc1
 buffer_load_dwordx4 v[20:23], v56, s[4:7], s24 offen offset:2048 sc1
 buffer_load_dwordx4 v[24:27], v56, s[4:7], s25 offen offset:0 sc1
 buffer_load_dwordx4 v[28:31], v56, s[4:7], s25 offen offset:2048 sc1
 s_branch L_h1go_76b
L_h1ra_73:
 buffer_load_dwordx4 v[16:19], v56, s[4:7], s24 offen offset:0 sc1
 buffer_load_dwordx4 v[20:23], v56, s[4:7], s24 offen offset:2048 sc1
 buffer_load_dwordx4 v[24:27], v56, s[4:7], s25 offen offset:0 sc1
 buffer_load_dwordx4 v[28:31], v56, s[4:7], s25 offen offset:2048 sc1
 s_branch L_h1go_76b
L_h1go_76:
L_h1go_76b:
 s_waitcnt vmcnt(3)
 v_mfma_f32_16x16x32_bf16 v[52:55], v[16:19], v[48:51], 0
 s_waitcnt vmcnt(2)
 v_mfma_f32_16x16x32_bf16 v[52:55], v[20:23], v[48:51], v[52:55]
 s_waitcnt vmcnt(1)
 v_mfma_f32_16x16x32_bf16 v[52:55], v[24:27], v[48:51], v[52:55]
 s_waitcnt vmcnt(0)
 v_mfma_f32_16x16x32_bf16 v[52:55], v[28:31], v[48:51], v[52:55]
 s_nop 7
 v_cmp_u_f32 vcc, v52, v53
 v_cmp_u_f32 s[26:27], v54, v55
 v_permlane32_swap_b32 v52, v54
 v_permlane32_swap_b32 v53, v55
 s_or_b64 vcc, vcc, s[26:27]
 v_add_f32 v52, v52, v54
 v_add_f32 v53, v53, v55
 v_cvt_pk_bf16_f32 v52, v52, v53
 s_cbranch_vccnz L_h1na_71
L_h1ok_68:
 buffer_store_dword v52, v57, s[4:7], s85 offen
 s_branch L_bp_65
L_h1na_71:
 s_add_u32 s23, s23, 1
 s_andn2_b32 s26, 62, s23
 s_cbranch_scc1 L_h1ra_73
 s_cmp_gt_u32 s23, 0x40000
 s_cbranch_scc1 L_bail
 s_mov_b64 s[26:27], 0
 v_cmp_eq_u32 vcc, s39, v16
 s_or_b64 s[26:27], s[26:27], vcc
 v_cmp_eq_u32 vcc, s39, v17
 s_or_b64 s[26:27], s[26:27], vcc
 v_cmp_eq_u32 vcc, s39, v18
 s_or_b64 s[26:27], s[26:27], vcc
 v_cmp_eq_u32 vcc, s39, v19
 s_or_b64 s[26:27], s[26:27], vcc
 v_cmp_eq_u32 vcc, s39, v20
 s_or_b64 s[26:27], s[26:27], vcc
 v_cmp_eq_u32 vcc, s39, v21
 s_or_b64 s[26:27], s[26:27], vcc
 v_cmp_eq_u32 vcc, s39, v22
 s_or_b64 s[26:27], s[26:27], vcc
 v_cmp_eq_u32 vcc, s39, v23
 s_or_b64 s[26:27], s[26:27], vcc
 v_cmp_eq_u32 vcc, s39, v24
 s_or_b64 s[26:27], s[26:27], vcc
 v_cmp_eq_u32 vcc, s39, v25
 s_or_b64 s[26:27], s[26:27], vcc
 v_cmp_eq_u32 vcc, s39, v26
 s_or_b64 s[26:27], s[26:27], vcc
 v_cmp_eq_u32 vcc, s39, v27
 s_or_b64 s[26:27], s[26:27], vcc
 v_cmp_eq_u32 vcc, s39, v28
 s_or_b64 s[26:27], s[26:27], vcc
 v_cmp_eq_u32 vcc, s39, v29
 s_or_b64 s[26:27], s[26:27], vcc
 v_cmp_eq_u32 vcc, s39, v30
 s_or_b64 s[26:27], s[26:27], vcc
 v_cmp_eq_u32 vcc, s39, v31
 s_or_b64 s[26:27], s[26:27], vcc
 s_cmp_lg_u64 s[26:27], 0
 s_cbranch_scc1 L_h1ra_73
 s_branch L_h1ok_68
L_w123_66:
 s_waitcnt vmcnt(7)
 s_barrier
 ds_read_b128 v[80:83], v1 offset:0
 ds_read_b128 v[84:87], v1 offset:1024
 ds_read_b128 v[88:91], v1 offset:2048
 ds_read_b128 v[92:95], v1 offset:3072
 ds_read_b128 v[96:99], v1 offset:4096
 ds_read_b128 v[100:103], v1 offset:5120
 ds_read_b128 v[104:107], v1 offset:6144
 ds_read_b128 v[108:111], v1 offset:7168
L_bp_65:
 s_add_u32 s25, s20, s35
 s_mov_b32 s23, 0
 s_barrier
 s_add_u32 s19, s19, 0x40000
 s_and_b32 s19, s19, 0x40000
 s_add_u32 s20, s20, 0x2000
 s_and_b32 s20, s20, 0x106000
 s_add_u32 s18, s18, 1
 v_readfirstlane_b32 s52, v9
 buffer_load_dwordx4 v[64:67], v1, s[4:7], s25 offen offset:0 sc1
 buffer_load_dwordx4 v[68:71], v1, s[4:7], s25 offen offset:1024 sc1
 v_xor_b32 v2, 0x6000, v2
 v_xor_b32 v3, 0x6000, v3
 v_xor_b32 v11, 0x6000, v11
 v_mov_b64 v[112:113], 0
 v_mov_b64 v[114:115], 0
 v_mov_b64 v[116:117], 0
 v_mov_b64 v[118:119], 0
 v_mov_b64 v[120:121], 0
 v_mov_b64 v[122:123], 0
 buffer_load_dwordx4 v[72:75], v1, s[4:7], s25 offen offset:0 sc1
 buffer_load_dwordx4 v[76:79], v1, s[4:7], s25 offen offset:1024 sc1
L_h2b_79:
 s_waitcnt vmcnt(3)
 ds_write_b128 v3, v[64:67] offset:0
 v_fma_f32 v58, v64, v65, v66
 v_cmp_u_f32 s[48:49], v58, v67
 s_waitcnt vmcnt(2)
 ds_write_b128 v3, v[68:71] offset:1024
 v_fma_f32 v59, v68, v69, v70
 v_cmp_u_f32 vcc, v59, v71
 s_or_b64 s[50:51], s[48:49], vcc
 s_cbranch_scc0 L_fin_78
 s_cmp_lg_u64 s[48:49], 0
 s_cbranch_scc0 L_h2r_87
 s_cbranch_vccz L_h2r_85
 s_add_u32 s23, s23, 1
 s_andn2_b32 s26, 62, s23
 s_cbranch_scc1 L_h2rb_89
 s_cmp_gt_u32 s23, 0x40000
 s_cbranch_scc1 L_bail
 s_mov_b64 s[26:27], 0
 v_cmp_eq_u32 vcc, s39, v64
 s_or_b64 s[26:27], s[26:27], vcc
 v_cmp_eq_u32 vcc, s39, v65
 s_or_b64 s[26:27], s[26:27], vcc
 v_cmp_eq_u32 vcc, s39, v66
 s_or_b64 s[26:27], s[26:27], vcc
 v_cmp_eq_u32 vcc, s39, v67
 s_or_b64 s[26:27], s[26:27], vcc
 v_cmp_eq_u32 vcc, s39, v68
 s_or_b64 s[26:27], s[26:27], vcc
 v_cmp_eq_u32 vcc, s39, v69
 s_or_b64 s[26:27], s[26:27], vcc
 v_cmp_eq_u32 vcc, s39, v70
 s_or_b64 s[26:27], s[26:27], vcc
 v_cmp_eq_u32 vcc, s39, v71
 s_or_b64 s[26:27], s[26:27], vcc
 s_cmp_lg_u64 s[26:27], 0
 s_cbranch_scc1 L_h2rb_89
 s_branch L_fin_78
L_h2rb_89:
 buffer_load_dwordx4 v[64:67], v1, s[4:7], s25 offen offset:0 sc1
 buffer_load_dwordx4 v[68:71], v1, s[4:7], s25 offen offset:1024 sc1
 s_branch L_h2b_80
L_h2b_80:
 s_waitcnt vmcnt(3)
 ds_write_b128 v3, v[72:75] offset:0
 v_fma_f32 v58, v72, v73, v74
 v_cmp_u_f32 s[48:49], v58, v75
 s_waitcnt vmcnt(2)
 ds_write_b128 v3, v[76:79] offset:1024
 v_fma_f32 v59, v76, v77, v78
 v_cmp_u_f32 vcc, v59, v79
 s_or_b64 s[50:51], s[48:49], vcc
 s_cbranch_scc0 L_fin_78
 s_cmp_lg_u64 s[48:49], 0
 s_cbranch_scc0 L_h2r_88
 s_cbranch_vccz L_h2r_86
 s_add_u32 s23, s23, 1
 s_andn2_b32 s26, 62, s23
 s_cbranch_scc1 L_h2rb_91
 s_cmp_gt_u32 s23, 0x40000
 s_cbranch_scc1 L_bail
 s_mov_b64 s[26:27], 0
 v_cmp_eq_u32 vcc, s39, v72
 s_or_b64 s[26:27], s[26:27], vcc
 v_cmp_eq_u32 vcc, s39, v73
 s_or_b64 s[26:27], s[26:27], vcc
 v_cmp_eq_u32 vcc, s39, v74
 s_or_b64 s[26:27], s[26:27], vcc
 v_cmp_eq_u32 vcc, s39, v75
 s_or_b64 s[26:27], s[26:27], vcc
 v_cmp_eq_u32 vcc, s39, v76
 s_or_b64 s[26:27], s[26:27], vcc
 v_cmp_eq_u32 vcc, s39, v77
 s_or_b64 s[26:27], s[26:27], vcc
 v_cmp_eq_u32 vcc, s39, v78
 s_or_b64 s[26:27], s[26:27], vcc
 v_cmp_eq_u32 vcc, s39, v79
 s_or_b64 s[26:27], s[26:27], vcc
 s_cmp_lg_u64 s[26:27], 0
 s_cbranch_scc1 L_h2rb_91
 s_branch L_fin_78
L_h2rb_91:
 buffer_load_dwordx4 v[72:75], v1, s[4:7], s25 offen offset:0 sc1
 buffer_load_dwordx4 v[76:79], v1, s[4:7], s25 offen offset:1024 sc1
 s_branch L_h2b_79
L_h2o_81:
 s_waitcnt vmcnt(1)
 ds_write_b128 v3, v[64:67] offset:0
 v_fma_f32 v58, v64, v65, v66
 v_cmp_u_f32 vcc, v58, v67
 s_cbranch_vccz L_fin_78
 s_add_u32 s23, s23, 1
 s_andn2_b32 s26, 62, s23
 s_cbranch_scc1 L_h2r_85
 s_cmp_gt_u32 s23, 0x40000
 s_cbranch_scc1 L_bail
 s_mov_b64 s[26:27], 0
 v_cmp_eq_u32 vcc, s39, v64
 s_or_b64 s[26:27], s[26:27], vcc
 v_cmp_eq_u32 vcc, s39, v65
 s_or_b64 s[26:27], s[26:27], vcc
 v_cmp_eq_u32 vcc, s39, v66
 s_or_b64 s[26:27], s[26:27], vcc
 v_cmp_eq_u32 vcc, s39, v67
 s_or_b64 s[26:27], s[26:27], vcc
 s_cmp_lg_u64 s[26:27], 0
 s_cbranch_scc1 L_h2r_85
 s_branch L_fin_78
L_h2r_85:
 buffer_load_dwordx4 v[64:67], v1, s[4:7], s25 offen offset:0 sc1
 s_branch L_h2o_82
L_h2o_82:
 s_waitcnt vmcnt(1)
 ds_write_b128 v3, v[72:75] offset:0
 v_fma_f32 v58, v72, v73, v74
 v_cmp_u_f32 vcc, v58, v75
 s_cbranch_vccz L_fin_78
 s_add_u32 s23, s23, 1
 s_andn2_b32 s26, 62, s23
 s_cbranch_scc1 L_h2r_86
 s_cmp_gt_u32 s23, 0x40000
 s_cbranch_scc1 L_bail
 s_mov_b64 s[26:27], 0
 v_cmp_eq_u32 vcc, s39, v72
 s_or_b64 s[26:27], s[26:27], vcc
 v_cmp_eq_u32 vcc, s39, v73
 s_or_b64 s[26:27], s[26:27], vcc
 v_cmp_eq_u32 vcc, s39, v74
 s_or_b64 s[26:27], s[26:27], vcc
 v_cmp_eq_u32 vcc, s39, v75
 s_or_b64 s[26:27], s[26:27], vcc
 s_cmp_lg_u64 s[26:27], 0
 s_cbranch_scc1 L_h2r_86
 s_branch L_fin_78
L_h2r_86:
 buffer_load_dwordx4 v[72:75], v1, s[4:7], s25 offen offset:0 sc1
 s_branch L_h2o_81
L_h2o_83:
 s_waitcnt vmcnt(1)
 ds_write_b128 v3, v[68:71] offset:1024
 v_fma_f32 v59, v68, v69, v70
 v_cmp_u_f32 vcc, v59, v71
 s_cbranch_vccz L_fin_78
 s_add_u32 s23, s23, 1
 s_andn2_b32 s26, 62, s23
 s_cbranch_scc1 L_h2r_87
 s_cmp_gt_u32 s23, 0x40000
 s_cbranch_scc1 L_bail
 s_mov_b64 s[26:27], 0
 v_cmp_eq_u32 vcc, s39, v68
 s_or_b64 s[26:27], s[26:27], vcc
 v_cmp_eq_u32 vcc, s39, v69
 s_or_b64 s[26:27], s[26:27], vcc
 v_cmp_eq_u32 vcc, s39, v70
 s_or_b64 s[26:27], s[26:27], vcc
 v_cmp_eq_u32 vcc, s39, v71
 s_or_b64 s[26:27], s[26:27], vcc
 s_cmp_lg_u64 s[26:27], 0
 s_cbranch_scc1 L_h2r_87
 s_branch L_fin_78
L_h2r_87:
 buffer_load_dwordx4 v[68:71], v1, s[4:7], s25 offen offset:1024 sc1
 s_branch L_h2o_84
L_h2o_84:
 s_waitcnt vmcnt(1)
 ds_write_b128 v3, v[76:79] offset:1024
 v_fma_f32 v59, v76, v77, v78
 v_cmp_u_f32 vcc, v59, v79
 s_cbranch_vccz L_fin_78
 s_add_u32 s23, s23, 1
 s_andn2_b32 s26, 62, s23
 s_cbranch_scc1 L_h2r_88
 s_cmp_gt_u32 s23, 0x40000
 s_cbranch_scc1 L_bail
 s_mov_b64 s[26:27], 0
 v_cmp_eq_u32 vcc, s39, v76
 s_or_b64 s[26:27], s[26:27], vcc
 v_cmp_eq_u32 vcc, s39, v77
 s_or_b64 s[26:27], s[26:27], vcc
 v_cmp_eq_u32 vcc, s39, v78
 s_or_b64 s[26:27], s[26:27], vcc
 v_cmp_eq_u32 vcc, s39, v79
 s_or_b64 s[26:27], s[26:27], vcc
 s_cmp_lg_u64 s[26:27], 0
 s_cbranch_scc1 L_h2r_88
 s_branch L_fin_78
L_h2r_88:
 buffer_load_dwordx4 v[76:79], v1, s[4:7], s25 offen offset:1024 sc1
 s_branch L_h2o_83
L_fin_78:
 s_cmp_lt_u32 s18, 63
 s_cbranch_scc1 L_rloop_62
 s_waitcnt lgkmcnt(0)
 s_barrier
 ds_read_b128 v[16:19], v2 offset:0
 ds_read_b128 v[20:23], v2 offset:512
 ds_read_b128 v[24:27], v2 offset:1024
 ds_read_b128 v[28:31], v2 offset:1536
 s_lshl_b32 s24, s17, 10
 s_add_u32 s24, s24, s22
 buffer_store_dwordx4 v[12:15], v1, s[4:7], s24 offen sc1
 s_add_u32 s22, s22, 4096
 s_waitcnt vmcnt(0)
 ds_read_b128 v[32:35], v2 offset:2048
 ds_read_b128 v[36:39], v2 offset:2560
 ds_read_b128 v[40:43], v2 offset:3072
 ds_read_b128 v[44:47], v2 offset:3584
 ds_read_b128 v[48:51], v2 offset:4096
 ds_read_b128 v[52:55], v2 offset:4608
 ds_read_b128 v[56:59], v2 offset:5120
 ds_read_b128 v[60:63], v2 offset:5632
 ds_read_b128 v[64:67], v2 offset:6144
 ds_read_b128 v[68:71], v2 offset:6656
 ds_read_b128 v[72:75], v2 offset:7168
 ds_read_b128 v[76:79], v2 offset:7680
 s_waitcnt lgkmcnt(15)
 v_smfmac_f32_16x16x64_bf16 v[116:119], v[16:19], a[128:135], v0
 v_smfmac_f32_16x16x64_bf16 v[120:123], v[16:19], v[128:135], v0
 s_waitcnt lgkmcnt(14)
 v_smfmac_f32_16x16x64_bf16 v[116:119], v[20:23], a[136:143], v0
 v_smfmac_f32_16x16x64_bf16 v[120:123], v[20:23], v[136:143], v0
 s_waitcnt lgkmcnt(13)
 v_smfmac_f32_16x16x64_bf16 v[116:119], v[24:27], a[144:151], v0
 v_smfmac_f32_16x16x64_bf16 v[120:123], v[24:27], v[144:151], v0
 s_waitcnt lgkmcnt(12)
 v_smfmac_f32_16x16x64_bf16 v[116:119], v[28:31], a[152:159], v0
 v_smfmac_f32_16x16x64_bf16 v[120:123], v[28:31], v[152:159], v0
 s_waitcnt lgkmcnt(11)
 v_smfmac_f32_16x16x64_bf16 v[116:119], v[32:35], a[160:167], v0
 v_smfmac_f32_16x16x64_bf16 v[120:123], v[32:35], v[160:167], v0
 s_waitcnt lgkmcnt(10)
 v_smfmac_f32_16x16x64_bf16 v[116:119], v[36:39], a[168:175], v0
 v_smfmac_f32_16x16x64_bf16 v[120:123], v[36:39], v[168:175], v0
 s_waitcnt lgkmcnt(9)
 v_smfmac_f32_16x16x64_bf16 v[116:119], v[40:43], a[176:183], v0
 v_smfmac_f32_16x16x64_bf16 v[120:123], v[40:43], v[176:183], v0
 s_waitcnt lgkmcnt(8)
 v_smfmac_f32_16x16x64_bf16 v[116:119], v[44:47], a[184:191], v0
 v_smfmac_f32_16x16x64_bf16 v[120:123], v[44:47], v[184:191], v0
 s_waitcnt lgkmcnt(7)
 v_smfmac_f32_16x16x64_bf16 v[116:119], v[48:51], a[192:199], v0
 v_smfmac_f32_16x16x64_bf16 v[120:123], v[48:51], v[192:199], v0
 s_waitcnt lgkmcnt(6)
 v_smfmac_f32_16x16x64_bf16 v[116:119], v[52:55], a[200:207], v0
 v_smfmac_f32_16x16x64_bf16 v[120:123], v[52:55], v[200:207], v0
 s_waitcnt lgkmcnt(5)
 v_smfmac_f32_16x16x64_bf16 v[116:119], v[56:59], a[208:215], v0
 v_smfmac_f32_16x16x64_bf16 v[120:123], v[56:59], v[208:215], v0
 s_waitcnt lgkmcnt(4)
 v_smfmac_f32_16x16x64_bf16 v[116:119], v[60:63], a[216:223], v0
 v_smfmac_f32_16x16x64_bf16 v[120:123], v[60:63], v[216:223], v0
 s_waitcnt lgkmcnt(3)
 v_smfmac_f32_16x16x64_bf16 v[116:119], v[64:67], a[224:231], v0
 v_smfmac_f32_16x16x64_bf16 v[120:123], v[64:67], v[224:231], v0
 s_waitcnt lgkmcnt(2)
 v_smfmac_f32_16x16x64_bf16 v[116:119], v[68:71], a[232:239], v0
 v_smfmac_f32_16x16x64_bf16 v[120:123], v[68:71], v[232:239], v0
 s_waitcnt lgkmcnt(1)
 v_smfmac_f32_16x16x64_bf16 v[116:119], v[72:75], a[240:247], v0
 v_smfmac_f32_16x16x64_bf16 v[120:123], v[72:75], v[240:247], v0
 s_waitcnt lgkmcnt(0)
 v_smfmac_f32_16x16x64_bf16 v[116:119], v[76:79], a[248:255], v0
 v_smfmac_f32_16x16x64_bf16 v[120:123], v[76:79], v[248:255], v0
 s_nop 7
 v_cvt_pk_bf16_f32 v12, v116, v117
 v_cvt_pk_bf16_f32 v13, v118, v119
 v_cvt_pk_bf16_f32 v14, v120, v121
 v_cvt_pk_bf16_f32 v15, v122, v123
 s_lshl_b32 s24, s17, 10
 s_add_u32 s24, s24, s22
 buffer_store_dwordx4 v[12:15], v1, s[4:7], s24 offen sc1
 s_branch L_rdone_93
L_fspin_64_e:
 s_mov_b32 s23, 0
L_fspin_64:
 buffer_load_dword v9, off, s[4:7], s36 sc1
 s_add_u32 s23, s23, 1
 s_cmp_gt_u32 s23, 0x40000
 s_cbranch_scc1 L_bail
 s_waitcnt vmcnt(0)
 v_cmp_ne_u32 vcc, 0, v9
 s_cbranch_vccz L_fspin_64
 s_branch L_fok_63

L_rdone_93:
 s_waitcnt vmcnt(0)
 s_endpgm
L_mixed:
 s_mov_b32 s18, 0
.p2align 6
L_rloop_94:
 s_waitcnt lgkmcnt(0)
 s_barrier
 ds_read_b128 v[16:19], v2 offset:0
 ds_read_b128 v[20:23], v2 offset:512
 ds_read_b128 v[24:27], v2 offset:1024
 ds_read_b128 v[28:31], v2 offset:1536
 s_cmp_lg_u32 s52, 0
 s_cbranch_scc0 L_fspin_96_e
L_fok_95:
 s_waitcnt lgkmcnt(3)
 v_smfmac_f32_16x16x64_bf16 v[112:115], v[16:19], a[0:7], v0
 ds_read_b128 v[32:35], v2 offset:2048
 v_smfmac_f32_16x16x64_bf16 v[116:119], v[16:19], a[128:135], v0
 v_mov_b64 v[60:61], s[86:87]
 s_waitcnt lgkmcnt(3)
 v_smfmac_f32_16x16x64_bf16 v[112:115], v[20:23], a[8:15], v0
 ds_read_b128 v[36:39], v2 offset:2560
 v_smfmac_f32_16x16x64_bf16 v[116:119], v[20:23], a[136:143], v0
 v_mov_b64 v[62:63], s[86:87]
 s_add_u32 s26, s19, 0x40000
 s_and_b32 s26, s26, 0x40000
 s_waitcnt lgkmcnt(3)
 v_smfmac_f32_16x16x64_bf16 v[112:115], v[24:27], a[16:23], v0
 ds_read_b128 v[40:43], v2 offset:3072
 v_smfmac_f32_16x16x64_bf16 v[116:119], v[24:27], a[144:151], v0
 s_add_u32 s26, s26, s37
 s_add_u32 s26, s26, s35
 s_xor_b32 s27, s20, 0x4000
 s_waitcnt lgkmcnt(3)
 v_smfmac_f32_16x16x64_bf16 v[112:115], v[28:31], a[24:31], v0
 ds_read_b128 v[44:47], v2 offset:3584
 v_smfmac_f32_16x16x64_bf16 v[116:119], v[28:31], a[152:159], v0
 buffer_store_dwordx4 v[60:63], v1, s[4:7], s26 offen offset:0 sc1
 s_waitcnt lgkmcnt(3)
 v_smfmac_f32_16x16x64_bf16 v[112:115], v[32:35], a[32:39], v0
 ds_read_b128 v[48:51], v2 offset:4096
 v_smfmac_f32_16x16x64_bf16 v[116:119], v[32:35], a[160:167], v0
 buffer_store_dwordx4 v[60:63], v1, s[4:7], s26 offen offset:1024 sc1
 s_waitcnt lgkmcnt(3)
 v_smfmac_f32_16x16x64_bf16 v[112:115], v[36:39], a[40:47], v0
 ds_read_b128 v[52:55], v2 offset:4608
 v_smfmac_f32_16x16x64_bf16 v[116:119], v[36:39], a[168:175], v0
 buffer_store_dwordx2 v[60:61], v7, s[4:7], s27 offen sc1
 s_waitcnt lgkmcnt(3)
 v_smfmac_f32_16x16x64_bf16 v[112:115], v[40:43], a[48:55], v0
 ds_read_b128 v[56:59], v2 offset:5120
 v_smfmac_f32_16x16x64_bf16 v[116:119], v[40:43], a[176:183], v0
 s_add_u32 m0, s35, 0
 s_add_u32 s24, s21, 0
 s_waitcnt lgkmcnt(3)
 v_smfmac_f32_16x16x64_bf16 v[112:115], v[44:47], a[56:63], v0
 ds_read_b128 v[60:63], v2 offset:5632
 v_smfmac_f32_16x16x64_bf16 v[116:119], v[44:47], a[184:191], v0
 buffer_load_dwordx4 v1, s[4:7], s24 offen sc1 lds
 s_waitcnt lgkmcnt(3)
 v_smfmac_f32_16x16x64_bf16 v[112:115], v[48:51], a[64:71], v0
 s_waitcnt vmcnt(4)
 ds_read_b128 v[64:67], v2 offset:6144
 v_smfmac_f32_16x16x64_bf16 v[116:119], v[48:51], a[192:199], v0
 s_add_u32 m0, s35, 1024
 s_add_u32 s24, s21, 1024
 s_add_u32 s21, s21, 16384
 s_waitcnt lgkmcnt(3)
 v_smfmac_f32_16x16x64_bf16 v[112:115], v[52:55], a[72:79], v0
 ds_read_b128 v[68:71], v2 offset:6656
 v_smfmac_f32_16x16x64_bf16 v[116:119], v[52:55], a[200:207], v0
 buffer_load_dwordx4 v1, s[4:7], s24 offen sc1 lds
 s_waitcnt lgkmcnt(3)
 v_smfmac_f32_16x16x64_bf16 v[112:115], v[56:59], a[80:87], v0
 ds_read_b128 v[72:75], v2 offset:7168
 v_smfmac_f32_16x16x64_bf16 v[116:119], v[56:59], a[208:215], v0
 s_add_u32 s36, s36, 128
 buffer_load_dword v9, off, s[4:7], s36 sc1
 s_waitcnt lgkmcnt(3)
 v_smfmac_f32_16x16x64_bf16 v[112:115], v[60:63], a[88:95], v0
 ds_read_b128 v[76:79], v2 offset:7680
 v_smfmac_f32_16x16x64_bf16 v[116:119], v[60:63], a[216:223], v0
 s_xor_b32 s34, s34, 0x6000
 s_waitcnt lgkmcnt(3)
 v_smfmac_f32_16x16x64_bf16 v[112:115], v[64:67], a[96:103], v0
 v_smfmac_f32_16x16x64_bf16 v[116:119], v[64:67], a[224:231], v0
 s_lshl_b32 s24, s17, 10
 s_add_u32 s24, s24, s22
 buffer_store_dwordx4 v[12:15], v1, s[4:7], s24 offen sc1
 s_add_u32 s22, s22, 4096
 s_waitcnt lgkmcnt(2)
 v_smfmac_f32_16x16x64_bf16 v[112:115], v[68:71], a[104:111], v0
 v_smfmac_f32_16x16x64_bf16 v[116:119], v[68:71], a[232:239], v0
 s_waitcnt lgkmcnt(1)
 v_smfmac_f32_16x16x64_bf16 v[112:115], v[72:75], a[112:119], v0
 v_smfmac_f32_16x16x64_bf16 v[116:119], v[72:75], a[240:247], v0
 s_waitcnt lgkmcnt(0)
 v_smfmac_f32_16x16x64_bf16 v[112:115], v[76:79], a[120:127], v0
 v_smfmac_f32_16x16x64_bf16 v[116:119], v[76:79], a[248:255], v0
 v_smfmac_f32_16x16x64_bf16 v[120:123], v[16:19], v[128:135], v0
 v_cvt_pk_bf16_f32 v14, v112, v113
 v_smfmac_f32_16x16x64_bf16 v[120:123], v[20:23], v[136:143], v0
 v_cvt_pk_bf16_f32 v15, v114, v115
 v_cvt_pk_bf16_f32 v12, v116, v117
 v_cvt_pk_bf16_f32 v13, v118, v119
 v_smfmac_f32_16x16x64_bf16 v[120:123], v[24:27], v[144:151], v0
 ds_write2st64_b64 v4, v[14:15], v[12:13] offset0:0 offset1:5
 v_smfmac_f32_16x16x64_bf16 v[120:123], v[28:31], v[152:159], v0
 v_smfmac_f32_16x16x64_bf16 v[120:123], v[32:35], v[160:167], v0
 v_smfmac_f32_16x16x64_bf16 v[120:123], v[36:39], v[168:175], v0
 v_smfmac_f32_16x16x64_bf16 v[120:123], v[40:43], v[176:183], v0
 v_smfmac_f32_16x16x64_bf16 v[120:123], v[44:47], v[184:191], v0
 s_waitcnt lgkmcnt(0)
 s_barrier
 ds_read_b64_tr_b16 v[16:17], v5 offset:0
 ds_read_b64_tr_b16 v[18:19], v5 offset:32
 v_smfmac_f32_16x16x64_bf16 v[120:123], v[48:51], v[192:199], v0
 ds_read_b64_tr_b16 v[20:21], v5 offset:256
 ds_read_b64_tr_b16 v[22:23], v5 offset:288
 v_smfmac_f32_16x16x64_bf16 v[120:123], v[52:55], v[200:207], v0
 ds_read_b64_tr_b16 v[24:25], v5 offset:512
 ds_read_b64_tr_b16 v[26:27], v5 offset:544
 v_smfmac_f32_16x16x64_bf16 v[120:123], v[56:59], v[208:215], v0
 ds_read_b64_tr_b16 v[28:29], v5 offset:768
 ds_read_b64_tr_b16 v[30:31], v5 offset:800
 v_smfmac_f32_16x16x64_bf16 v[120:123], v[60:63], v[216:223], v0
 ds_read_b64_tr_b16 v[32:33], v5 offset:2560
 ds_read_b64_tr_b16 v[34:35], v5 offset:2592
 s_waitcnt lgkmcnt(8)
 v_mfma_f32_16x16x32_bf16 v[116:119], v[80:83], v[16:19], 0
 ds_read_b64_tr_b16 v[36:37], v5 offset:2816
 ds_read_b64_tr_b16 v[38:39], v5 offset:2848
 v_mfma_f32_16x16x32_bf16 v[44:47], v[96:99], v[16:19], 0
 ds_read_b64_tr_b16 v[40:41], v5 offset:3072
 ds_read_b64_tr_b16 v[42:43], v5 offset:3104
 s_waitcnt lgkmcnt(10)
 v_mfma_f32_16x16x32_bf16 v[116:119], v[84:87], v[20:23], v[116:119]
 ds_read_b64_tr_b16 v[112:113], v5 offset:3328
 ds_read_b64_tr_b16 v[114:115], v5 offset:3360
 v_mfma_f32_16x16x32_bf16 v[44:47], v[100:103], v[20:23], v[44:47]
 s_add_u32 m0, s34, 0
 s_add_u32 s24, s32, 0
 ds_read_b128 v[80:83], v8 offset:0
 s_waitcnt lgkmcnt(9)
 v_mfma_f32_16x16x32_bf16 v[116:119], v[88:91], v[24:27], v[116:119]
 buffer_load_dwordx4 v1, s[4:7], s24 offen sc1 lds
 ds_read_b128 v[84:87], v8 offset:1024
 v_mfma_f32_16x16x32_bf16 v[44:47], v[104:107], v[24:27], v[44:47]
 s_add_u32 m0, s34, 1024
 s_add_u32 s24, s32, 1024
 s_add_u32 s32, s32, 16384
 ds_read_b128 v[96:99], v8 offset:4096
 v_mfma_f32_16x16x32_bf16 v[116:119], v[92:95], v[28:31], v[116:119]
 buffer_load_dwordx4 v1, s[4:7], s24 offen sc1 lds
 ds_read_b128 v[100:103], v8 offset:5120
 v_mfma_f32_16x16x32_bf16 v[44:47], v[108:111], v[28:31], v[44:47]
 ds_read_b128 v[88:91], v8 offset:2048
 s_waitcnt lgkmcnt(5)
 v_mfma_f32_16x16x32_bf16 v[48:51], v[32:35], v[16:19], 0
 ds_read_b128 v[92:95], v8 offset:3072
 v_mfma_f32_16x16x32_bf16 v[48:51], v[36:39], v[20:23], v[48:51]
 ds_read_b128 v[104:107], v8 offset:6144
 v_mfma_f32_16x16x32_bf16 v[48:51], v[40:43], v[24:27], v[48:51]
 ds_read_b128 v[108:111], v8 offset:7168
 v_max3_f32 v124, v116, v117, v118
 v_mfma_f32_16x16x32_bf16 v[48:51], v[112:115], v[28:31], v[48:51]
 ds_read_b128 v[52:55], v11 offset:0
 v_max3_f32 v125, v44, v45, v46
 v_smfmac_f32_16x16x64_bf16 v[120:123], v[64:67], v[224:231], v0
 ds_read_b128 v[16:19], v8 offset:8192
 v_max3_f32 v124, v124, v119, v47
 v_smfmac_f32_16x16x64_bf16 v[120:123], v[68:71], v[232:239], v0
 ds_read_b128 v[56:59], v11 offset:1024
 v_max3_f32 v125, v125, v48, v49
 v_max3_f32 v124, v124, v50, v51
 v_max_f32 v124, v124, v125
 v_mov_b32 v125, v124
 v_smfmac_f32_16x16x64_bf16 v[120:123], v[72:75], v[240:247], v0
 ds_read_b128 v[20:23], v8 offset:9216
 v_permlane16_swap_b32 v125, v124
 v_max_f32 v124, v124, v125
 v_mov_b32 v125, v124
 v_smfmac_f32_16x16x64_bf16 v[120:123], v[76:79], v[248:255], v0
 ds_read_b128 v[24:27], v8 offset:16384
 v_permlane32_swap_b32 v125, v124
 v_max_f32 v124, v124, v125
 v_mul_f32 v124, s33, v124
 v_pk_fma_f32 v[116:117], v[116:117], s[54:55], v[124:125] op_sel_hi:[1,1,0] neg_lo:[0,0,1] neg_hi:[0,0,1]
 v_pk_fma_f32 v[118:119], v[118:119], s[54:55], v[124:125] op_sel_hi:[1,1,0] neg_lo:[0,0,1] neg_hi:[0,0,1]
 v_pk_fma_f32 v[44:45], v[44:45], s[54:55], v[124:125] op_sel_hi:[1,1,0] neg_lo:[0,0,1] neg_hi:[0,0,1]
 v_pk_fma_f32 v[46:47], v[46:47], s[54:55], v[124:125] op_sel_hi:[1,1,0] neg_lo:[0,0,1] neg_hi:[0,0,1]
 v_pk_fma_f32 v[48:49], v[48:49], s[54:55], v[124:125] op_sel_hi:[1,1,0] neg_lo:[0,0,1] neg_hi:[0,0,1]
 v_pk_fma_f32 v[50:51], v[50:51], s[54:55], v[124:125] op_sel_hi:[1,1,0] neg_lo:[0,0,1] neg_hi:[0,0,1]
 v_exp_f32 v116, v116
 v_exp_f32 v117, v117
 v_exp_f32 v118, v118
 v_exp_f32 v119, v119
 v_exp_f32 v44, v44
 v_exp_f32 v45, v45
 v_exp_f32 v46, v46
 v_exp_f32 v47, v47
 v_exp_f32 v48, v48
 v_exp_f32 v49, v49
 v_exp_f32 v50, v50
 v_exp_f32 v51, v51
 v_cvt_pk_bf16_f32 v60, v116, v117
 v_cvt_pk_bf16_f32 v61, v118, v119
 v_cvt_pk_bf16_f32 v62, v44, v45
 v_cvt_pk_bf16_f32 v63, v46, v47
 v_cvt_pk_bf16_f32 v14, v120, v121
 v_cvt_pk_bf16_f32 v15, v122, v123
 s_waitcnt lgkmcnt(2)
 v_mfma_f32_16x16x32_bf16 v[72:75], v[52:55], v[60:63], 0
 ds_read_b128 v[28:31], v8 offset:17408
 v_cvt_pk_bf16_f32 v64, v48, v49
 v_cvt_pk_bf16_f32 v65, v50, v51
 v_mfma_f32_16x16x32_bf16 v[76:79], v[56:59], v[60:63], 0
 ds_read_b128 v[32:35], v8 offset:24576
 v_cndmask_b32 v66, 0, v14, s[28:29]
 v_cndmask_b32 v67, 0, v15, s[28:29]
 v_cndmask_b32 v68, 0, v14, s[30:31]
 v_cndmask_b32 v69, 0, v15, s[30:31]
 v_mfma_f32_16x16x16_bf16 v[72:75], v[66:67], v[64:65], v[72:75]
 ds_read_b128 v[36:39], v8 offset:25600
 v_mov_b64 v[40:41], s[56:57]
 v_mov_b64 v[42:43], s[56:57]
 v_mfma_f32_16x16x16_bf16 v[76:79], v[68:69], v[64:65], v[76:79]
 ds_read_b128 v[120:123], v8 offset:10240
 v_mov_b64 v[70:71], s[58:59]
 v_mfma_f32_16x16x32_bf16 v[112:115], v[60:63], v[40:43], 0
 ds_read_b128 v[124:127], v8 offset:11264
 v_mov_b64 v[44:45], 0
 v_mov_b64 v[46:47], 0
 v_mov_b64 v[48:49], 0
 v_mov_b64 v[50:51], 0
 v_cvt_pk_bf16_f32 v60, v72, v73
 v_cvt_pk_bf16_f32 v61, v74, v75
 v_cvt_pk_bf16_f32 v62, v76, v77
 v_cvt_pk_bf16_f32 v63, v78, v79
 ds_write_b128 v10, v[60:63]
 s_nop 0
 v_smfmac_f32_16x16x64_bf16 v[44:47], v[60:63], v[80:87], v0
 ds_read_b128 v[72:75], v8 offset:18432
 v_xor_b32 v66, 512, v10
 v_smfmac_f32_16x16x64_bf16 v[48:51], v[60:63], v[96:103], v0
 ds_read_b128 v[76:79], v8 offset:19456
 v_mov_b64 v[40:41], 0
 v_mov_b64 v[42:43], 0
 v_mov_b64 v[116:117], 0
 v_mov_b64 v[118:119], 0
 v_mfma_f32_16x16x16_bf16 v[112:115], v[64:65], v[70:71], v[112:115]
 v_xor_b32 v67, 1024, v10
 v_xor_b32 v68, 1536, v10
 v_smfmac_f32_16x16x64_bf16 v[40:43], v[60:63], v[88:95], v0
 ds_read_b128 v[80:83], v8 offset:26624
 ds_read_b128 v[84:87], v8 offset:27648
 v_smfmac_f32_16x16x64_bf16 v[116:119], v[60:63], v[104:111], v0
 s_waitcnt vmcnt(6)
 s_waitcnt lgkmcnt(4)
 s_barrier
 ds_read_b128 v[52:55], v66
 ds_read_b128 v[56:59], v67
 ds_read_b128 v[64:67], v68
 ds_read_b128 v[96:99], v8 offset:12288
 ds_read_b128 v[100:103], v8 offset:13312
 v_rcp_f32 v112, v112
 v_rcp_f32 v113, v113
 v_rcp_f32 v114, v114
 v_rcp_f32 v115, v115
 s_waitcnt lgkmcnt(4)
 v_smfmac_f32_16x16x64_bf16 v[44:47], v[52:55], v[16:23], v0
 ds_read_b128 v[88:91], v8 offset:20480
 s_waitcnt lgkmcnt(4)
 v_smfmac_f32_16x16x64_bf16 v[44:47], v[56:59], v[24:31], v0
 ds_read_b128 v[92:95], v8 offset:21504
 s_waitcnt lgkmcnt(4)
 v_smfmac_f32_16x16x64_bf16 v[44:47], v[64:67], v[32:39], v0
 ds_read_b128 v[104:107], v8 offset:28672
 v_smfmac_f32_16x16x64_bf16 v[40:43], v[52:55], v[120:127], v0
 ds_read_b128 v[108:111], v8 offset:29696
 s_mov_b32 s24, s19
 s_add_u32 s25, s19, 32768
 v_smfmac_f32_16x16x64_bf16 v[40:43], v[56:59], v[72:79], v0
 ds_read_b128 v[16:19], v8 offset:14336
 v_mul_f32 v44, v44, v112
 v_mul_f32 v45, v45, v113
 v_smfmac_f32_16x16x64_bf16 v[40:43], v[64:67], v[80:87], v0
 ds_read_b128 v[20:23], v8 offset:15360
 s_waitcnt lgkmcnt(6)
 v_mul_f32 v46, v46, v114
 v_mul_f32 v47, v47, v115
 v_smfmac_f32_16x16x64_bf16 v[48:51], v[52:55], v[96:103], v0
 ds_read_b128 v[24:27], v8 offset:22528
 s_waitcnt lgkmcnt(5)
 v_cvt_pk_bf16_f32 v120, v44, v45
 v_cvt_pk_bf16_f32 v121, v46, v47
 v_smfmac_f32_16x16x64_bf16 v[48:51], v[56:59], v[88:95], v0
 buffer_store_dwordx2 v[120:121], v6, s[4:7], s24 offen offset:0 sc1
 ds_read_b128 v[28:31], v8 offset:23552
 s_waitcnt lgkmcnt(4)
 v_mul_f32 v40, v40, v112
 v_mul_f32 v41, v41, v113
 v_smfmac_f32_16x16x64_bf16 v[48:51], v[64:67], v[104:111], v0
 ds_read_b128 v[32:35], v8 offset:30720
 s_waitcnt lgkmcnt(3)
 v_mul_f32 v42, v42, v114
 v_mul_f32 v43, v43, v115
 v_smfmac_f32_16x16x64_bf16 v[116:119], v[52:55], v[16:23], v0
 ds_read_b128 v[36:39], v8 offset:31744
 s_waitcnt lgkmcnt(2)
 v_cvt_pk_bf16_f32 v122, v40, v41
 v_cvt_pk_bf16_f32 v123, v42, v43
 v_smfmac_f32_16x16x64_bf16 v[116:119], v[56:59], v[24:31], v0
 buffer_store_dwordx2 v[122:123], v6, s[4:7], s24 offen offset:128 sc1
 s_waitcnt lgkmcnt(0)
 v_mul_f32 v48, v48, v112
 v_mul_f32 v49, v49, v113
 v_smfmac_f32_16x16x64_bf16 v[116:119], v[64:67], v[32:39], v0
 v_mul_f32 v50, v50, v114
 v_mul_f32 v51, v51, v115
 v_cvt_pk_bf16_f32 v124, v48, v49
 v_cvt_pk_bf16_f32 v125, v50, v51
 buffer_store_dwordx2 v[124:125], v6, s[4:7], s25 offen offset:0 sc1
 s_nop 2
 v_pk_mul_f32 v[116:117], v[116:117], v[112:113]
 v_pk_mul_f32 v[118:119], v[118:119], v[114:115]
 v_cvt_pk_bf16_f32 v126, v116, v117
 v_cvt_pk_bf16_f32 v127, v118, v119
 buffer_store_dwordx2 v[126:127], v6, s[4:7], s25 offen offset:128 sc1
 s_cmp_lt_u32 s17, 2
 s_cbranch_scc0 L_w123_98
 s_lshl_b32 s26, s17, 7
 s_add_u32 s24, s19, s37
 s_add_u32 s24, s24, s26
 s_add_u32 s25, s24, 4096
 s_lshl_b32 s26, s17, 9
 s_add_u32 s85, s20, s26
 s_mov_b32 s23, 0
 v_lshrrev_b32 v56, 7, v1
 v_and_b32 v57, 0x70, v1
 v_lshl_add_u32 v56, v56, 8, v57
 v_subrev_u32 v57, 508, v7
 v_cndmask_b32 v57, v7, v57, s[30:31]
 v_bfe_u32 v52, v1, 5, 2
 v_bfe_u32 v53, v1, 4, 1
 v_mov_b32 v54, 0x3f80
 v_lshlrev_b32 v53, 4, v53
 v_lshlrev_b32 v54, v53, v54
 v_cmp_eq_u32 s[76:77], 0, v52
 v_cmp_eq_u32 s[78:79], 1, v52
 v_cmp_eq_u32 s[80:81], 2, v52
 v_cmp_eq_u32 s[82:83], 3, v52
 v_cndmask_b32 v48, 0, v54, s[76:77]
 v_cndmask_b32 v49, 0, v54, s[78:79]
 v_cndmask_b32 v50, 0, v54, s[80:81]
 v_cndmask_b32 v51, 0, v54, s[82:83]
 s_waitcnt vmcnt(7)
 s_barrier
 s_cmp_eq_u32 s17, 0
 s_cbranch_scc0 L_h1w1_107
 ds_read_b128 v[80:83], v1 offset:0
 ds_read_b128 v[84:87], v1 offset:1024
 ds_read_b128 v[88:91], v1 offset:2048
 ds_read_b128 v[92:95], v1 offset:3072
 ds_read_b128 v[96:99], v1 offset:4096
 ds_read_b128 v[100:103], v1 offset:5120
 buffer_load_dwordx4 v[16:19], v56, s[4:7], s24 offen offset:0 sc1
 buffer_load_dwordx4 v[20:23], v56, s[4:7], s24 offen offset:2048 sc1
 buffer_load_dwordx4 v[24:27], v56, s[4:7], s25 offen offset:0 sc1
 buffer_load_dwordx4 v[28:31], v56, s[4:7], s25 offen offset:2048 sc1
 ds_read_b128 v[104:107], v1 offset:6144
 ds_read_b128 v[108:111], v1 offset:7168
 s_branch L_h1go_108
L_h1w1_107:
 ds_read_b128 v[80:83], v1 offset:0
 ds_read_b128 v[84:87], v1 offset:1024
 ds_read_b128 v[88:91], v1 offset:2048
 ds_read_b128 v[92:95], v1 offset:3072
 ds_read_b128 v[96:99], v1 offset:4096
 ds_read_b128 v[100:103], v1 offset:5120
 ds_read_b128 v[104:107], v1 offset:6144
 ds_read_b128 v[108:111], v1 offset:7168
 buffer_load_dwordx4 v[16:19], v56, s[4:7], s24 offen offset:0 sc1
 buffer_load_dwordx4 v[20:23], v56, s[4:7], s24 offen offset:2048 sc1
 buffer_load_dwordx4 v[24:27], v56, s[4:7], s25 offen offset:0 sc1
 buffer_load_dwordx4 v[28:31], v56, s[4:7], s25 offen offset:2048 sc1
 s_branch L_h1go_108b
L_h1ra_105:
 buffer_load_dwordx4 v[16:19], v56, s[4:7], s24 offen offset:0 sc1
 buffer_load_dwordx4 v[20:23], v56, s[4:7], s24 offen offset:2048 sc1
 buffer_load_dwordx4 v[24:27], v56, s[4:7], s25 offen offset:0 sc1
 buffer_load_dwordx4 v[28:31], v56, s[4:7], s25 offen offset:2048 sc1
 s_branch L_h1go_108b
L_h1go_108:
L_h1go_108b:
 s_waitcnt vmcnt(3)
 v_mfma_f32_16x16x32_bf16 v[52:55], v[16:19], v[48:51], 0
 s_waitcnt vmcnt(2)
 v_mfma_f32_16x16x32_bf16 v[52:55], v[20:23], v[48:51], v[52:55]
 s_waitcnt vmcnt(1)
 v_mfma_f32_16x16x32_bf16 v[52:55], v[24:27], v[48:51], v[52:55]
 s_waitcnt vmcnt(0)
 v_mfma_f32_16x16x32_bf16 v[52:55], v[28:31], v[48:51], v[52:55]
 s_nop 7
 v_cmp_u_f32 vcc, v52, v53
 v_cmp_u_f32 s[26:27], v54, v55
 v_permlane32_swap_b32 v52, v54
 v_permlane32_swap_b32 v53, v55
 s_or_b64 vcc, vcc, s[26:27]
 v_add_f32 v52, v52, v54
 v_add_f32 v53, v53, v55
 v_cvt_pk_bf16_f32 v52, v52, v53
 s_cbranch_vccnz L_h1na_103
L_h1ok_100:
 buffer_store_dword v52, v57, s[4:7], s85 offen sc1
 s_branch L_bp_97
L_h1na_103:
 s_add_u32 s23, s23, 1
 s_andn2_b32 s26, 62, s23
 s_cbranch_scc1 L_h1ra_105
 s_cmp_gt_u32 s23, 0x40000
 s_cbranch_scc1 L_bail
 s_mov_b64 s[26:27], 0
 v_cmp_eq_u32 vcc, s39, v16
 s_or_b64 s[26:27], s[26:27], vcc
 v_cmp_eq_u32 vcc, s39, v17
 s_or_b64 s[26:27], s[26:27], vcc
 v_cmp_eq_u32 vcc, s39, v18
 s_or_b64 s[26:27], s[26:27], vcc
 v_cmp_eq_u32 vcc, s39, v19
 s_or_b64 s[26:27], s[26:27], vcc
 v_cmp_eq_u32 vcc, s39, v20
 s_or_b64 s[26:27], s[26:27], vcc
 v_cmp_eq_u32 vcc, s39, v21
 s_or_b64 s[26:27], s[26:27], vcc
 v_cmp_eq_u32 vcc, s39, v22
 s_or_b64 s[26:27], s[26:27], vcc
 v_cmp_eq_u32 vcc, s39, v23
 s_or_b64 s[26:27], s[26:27], vcc
 v_cmp_eq_u32 vcc, s39, v24
 s_or_b64 s[26:27], s[26:27], vcc
 v_cmp_eq_u32 vcc, s39, v25
 s_or_b64 s[26:27], s[26:27], vcc
 v_cmp_eq_u32 vcc, s39, v26
 s_or_b64 s[26:27], s[26:27], vcc
 v_cmp_eq_u32 vcc, s39, v27
 s_or_b64 s[26:27], s[26:27], vcc
 v_cmp_eq_u32 vcc, s39, v28
 s_or_b64 s[26:27], s[26:27], vcc
 v_cmp_eq_u32 vcc, s39, v29
 s_or_b64 s[26:27], s[26:27], vcc
 v_cmp_eq_u32 vcc, s39, v30
 s_or_b64 s[26:27], s[26:27], vcc
 v_cmp_eq_u32 vcc, s39, v31
 s_or_b64 s[26:27], s[26:27], vcc
 s_cmp_lg_u64 s[26:27], 0
 s_cbranch_scc1 L_h1ra_105
 s_branch L_h1ok_100
L_w123_98:
 s_waitcnt vmcnt(7)
 s_barrier
 ds_read_b128 v[80:83], v1 offset:0
 ds_read_b128 v[84:87], v1 offset:1024
 ds_read_b128 v[88:91], v1 offset:2048
 ds_read_b128 v[92:95], v1 offset:3072
 ds_read_b128 v[96:99], v1 offset:4096
 ds_read_b128 v[100:103], v1 offset:5120
 ds_read_b128 v[104:107], v1 offset:6144
 ds_read_b128 v[108:111], v1 offset:7168
L_bp_97:
 s_add_u32 s25, s20, s35
 s_mov_b32 s23, 0
 s_barrier
 s_add_u32 s19, s19, 0x40000
 s_and_b32 s19, s19, 0x40000
 s_add_u32 s20, s20, 0x2000
 s_and_b32 s20, s20, 0x106000
 s_add_u32 s18, s18, 1
 v_readfirstlane_b32 s52, v9
 buffer_load_dwordx4 v[64:67], v1, s[4:7], s25 offen offset:0 sc1
 buffer_load_dwordx4 v[68:71], v1, s[4:7], s25 offen offset:1024 sc1
 v_xor_b32 v2, 0x6000, v2
 v_xor_b32 v3, 0x6000, v3
 v_xor_b32 v11, 0x6000, v11
 v_mov_b64 v[112:113], 0
 v_mov_b64 v[114:115], 0
 v_mov_b64 v[116:117], 0
 v_mov_b64 v[118:119], 0
 v_mov_b64 v[120:121], 0
 v_mov_b64 v[122:123], 0
 buffer_load_dwordx4 v[72:75], v1, s[4:7], s25 offen offset:0 sc1
 buffer_load_dwordx4 v[76:79], v1, s[4:7], s25 offen offset:1024 sc1
L_h2b_111:
 s_waitcnt vmcnt(3)
 ds_write_b128 v3, v[64:67] offset:0
 v_fma_f32 v58, v64, v65, v66
 v_cmp_u_f32 s[48:49], v58, v67
 s_waitcnt vmcnt(2)
 ds_write_b128 v3, v[68:71] offset:1024
 v_fma_f32 v59, v68, v69, v70
 v_cmp_u_f32 vcc, v59, v71
 s_or_b64 s[50:51], s[48:49], vcc
 s_cbranch_scc0 L_fin_110
 s_cmp_lg_u64 s[48:49], 0
 s_cbranch_scc0 L_h2r_119
 s_cbranch_vccz L_h2r_117
 s_add_u32 s23, s23, 1
 s_andn2_b32 s26, 62, s23
 s_cbranch_scc1 L_h2rb_121
 s_cmp_gt_u32 s23, 0x40000
 s_cbranch_scc1 L_bail
 s_mov_b64 s[26:27], 0
 v_cmp_eq_u32 vcc, s39, v64
 s_or_b64 s[26:27], s[26:27], vcc
 v_cmp_eq_u32 vcc, s39, v65
 s_or_b64 s[26:27], s[26:27], vcc
 v_cmp_eq_u32 vcc, s39, v66
 s_or_b64 s[26:27], s[26:27], vcc
 v_cmp_eq_u32 vcc, s39, v67
 s_or_b64 s[26:27], s[26:27], vcc
 v_cmp_eq_u32 vcc, s39, v68
 s_or_b64 s[26:27], s[26:27], vcc
 v_cmp_eq_u32 vcc, s39, v69
 s_or_b64 s[26:27], s[26:27], vcc
 v_cmp_eq_u32 vcc, s39, v70
 s_or_b64 s[26:27], s[26:27], vcc
 v_cmp_eq_u32 vcc, s39, v71
 s_or_b64 s[26:27], s[26:27], vcc
 s_cmp_lg_u64 s[26:27], 0
 s_cbranch_scc1 L_h2rb_121
 s_branch L_fin_110
L_h2rb_121:
 buffer_load_dwordx4 v[64:67], v1, s[4:7], s25 offen offset:0 sc1
 buffer_load_dwordx4 v[68:71], v1, s[4:7], s25 offen offset:1024 sc1
 s_branch L_h2b_112
L_h2b_112:
 s_waitcnt vmcnt(3)
 ds_write_b128 v3, v[72:75] offset:0
 v_fma_f32 v58, v72, v73, v74
 v_cmp_u_f32 s[48:49], v58, v75
 s_waitcnt vmcnt(2)
 ds_write_b128 v3, v[76:79] offset:1024
 v_fma_f32 v59, v76, v77, v78
 v_cmp_u_f32 vcc, v59, v79
 s_or_b64 s[50:51], s[48:49], vcc
 s_cbranch_scc0 L_fin_110
 s_cmp_lg_u64 s[48:49], 0
 s_cbranch_scc0 L_h2r_120
 s_cbranch_vccz L_h2r_118
 s_add_u32 s23, s23, 1
 s_andn2_b32 s26, 62, s23
 s_cbranch_scc1 L_h2rb_123
 s_cmp_gt_u32 s23, 0x40000
 s_cbranch_scc1 L_bail
 s_mov_b64 s[26:27], 0
 v_cmp_eq_u32 vcc, s39, v72
 s_or_b64 s[26:27], s[26:27], vcc
 v_cmp_eq_u32 vcc, s39, v73
 s_or_b64 s[26:27], s[26:27], vcc
 v_cmp_eq_u32 vcc, s39, v74
 s_or_b64 s[26:27], s[26:27], vcc
 v_cmp_eq_u32 vcc, s39, v75
 s_or_b64 s[26:27], s[26:27], vcc
 v_cmp_eq_u32 vcc, s39, v76
 s_or_b64 s[26:27], s[26:27], vcc
 v_cmp_eq_u32 vcc, s39, v77
 s_or_b64 s[26:27], s[26:27], vcc
 v_cmp_eq_u32 vcc, s39, v78
 s_or_b64 s[26:27], s[26:27], vcc
 v_cmp_eq_u32 vcc, s39, v79
 s_or_b64 s[26:27], s[26:27], vcc
 s_cmp_lg_u64 s[26:27], 0
 s_cbranch_scc1 L_h2rb_123
 s_branch L_fin_110
L_h2rb_123:
 buffer_load_dwordx4 v[72:75], v1, s[4:7], s25 offen offset:0 sc1
 buffer_load_dwordx4 v[76:79], v1, s[4:7], s25 offen offset:1024 sc1
 s_branch L_h2b_111
L_h2o_113:
 s_waitcnt vmcnt(1)
 ds_write_b128 v3, v[64:67] offset:0
 v_fma_f32 v58, v64, v65, v66
 v_cmp_u_f32 vcc, v58, v67
 s_cbranch_vccz L_fin_110
 s_add_u32 s23, s23, 1
 s_andn2_b32 s26, 62, s23
 s_cbranch_scc1 L_h2r_117
 s_cmp_gt_u32 s23, 0x40000
 s_cbranch_scc1 L_bail
 s_mov_b64 s[26:27], 0
 v_cmp_eq_u32 vcc, s39, v64
 s_or_b64 s[26:27], s[26:27], vcc
 v_cmp_eq_u32 vcc, s39, v65
 s_or_b64 s[26:27], s[26:27], vcc
 v_cmp_eq_u32 vcc, s39, v66
 s_or_b64 s[26:27], s[26:27], vcc
 v_cmp_eq_u32 vcc, s39, v67
 s_or_b64 s[26:27], s[26:27], vcc
 s_cmp_lg_u64 s[26:27], 0
 s_cbranch_scc1 L_h2r_117
 s_branch L_fin_110
L_h2r_117:
 buffer_load_dwordx4 v[64:67], v1, s[4:7], s25 offen offset:0 sc1
 s_branch L_h2o_114
L_h2o_114:
 s_waitcnt vmcnt(1)
 ds_write_b128 v3, v[72:75] offset:0
 v_fma_f32 v58, v72, v73, v74
 v_cmp_u_f32 vcc, v58, v75
 s_cbranch_vccz L_fin_110
 s_add_u32 s23, s23, 1
 s_andn2_b32 s26, 62, s23
 s_cbranch_scc1 L_h2r_118
 s_cmp_gt_u32 s23, 0x40000
 s_cbranch_scc1 L_bail
 s_mov_b64 s[26:27], 0
 v_cmp_eq_u32 vcc, s39, v72
 s_or_b64 s[26:27], s[26:27], vcc
 v_cmp_eq_u32 vcc, s39, v73
 s_or_b64 s[26:27], s[26:27], vcc
 v_cmp_eq_u32 vcc, s39, v74
 s_or_b64 s[26:27], s[26:27], vcc
 v_cmp_eq_u32 vcc, s39, v75
 s_or_b64 s[26:27], s[26:27], vcc
 s_cmp_lg_u64 s[26:27], 0
 s_cbranch_scc1 L_h2r_118
 s_branch L_fin_110
L_h2r_118:
 buffer_load_dwordx4 v[72:75], v1, s[4:7], s25 offen offset:0 sc1
 s_branch L_h2o_113
L_h2o_115:
 s_waitcnt vmcnt(1)
 ds_write_b128 v3, v[68:71] offset:1024
 v_fma_f32 v59, v68, v69, v70
 v_cmp_u_f32 vcc, v59, v71
 s_cbranch_vccz L_fin_110
 s_add_u32 s23, s23, 1
 s_andn2_b32 s26, 62, s23
 s_cbranch_scc1 L_h2r_119
 s_cmp_gt_u32 s23, 0x40000
 s_cbranch_scc1 L_bail
 s_mov_b64 s[26:27], 0
 v_cmp_eq_u32 vcc, s39, v68
 s_or_b64 s[26:27], s[26:27], vcc
 v_cmp_eq_u32 vcc, s39, v69
 s_or_b64 s[26:27], s[26:27], vcc
 v_cmp_eq_u32 vcc, s39, v70
 s_or_b64 s[26:27], s[26:27], vcc
 v_cmp_eq_u32 vcc, s39, v71
 s_or_b64 s[26:27], s[26:27], vcc
 s_cmp_lg_u64 s[26:27], 0
 s_cbranch_scc1 L_h2r_119
 s_branch L_fin_110
L_h2r_119:
 buffer_load_dwordx4 v[68:71], v1, s[4:7], s25 offen offset:1024 sc1
 s_branch L_h2o_116
L_h2o_116:
 s_waitcnt vmcnt(1)
 ds_write_b128 v3, v[76:79] offset:1024
 v_fma_f32 v59, v76, v77, v78
 v_cmp_u_f32 vcc, v59, v79
 s_cbranch_vccz L_fin_110
 s_add_u32 s23, s23, 1
 s_andn2_b32 s26, 62, s23
 s_cbranch_scc1 L_h2r_120
 s_cmp_gt_u32 s23, 0x40000
 s_cbranch_scc1 L_bail
 s_mov_b64 s[26:27], 0
 v_cmp_eq_u32 vcc, s39, v76
 s_or_b64 s[26:27], s[26:27], vcc
 v_cmp_eq_u32 vcc, s39, v77
 s_or_b64 s[26:27], s[26:27], vcc
 v_cmp_eq_u32 vcc, s39, v78
 s_or_b64 s[26:27], s[26:27], vcc
 v_cmp_eq_u32 vcc, s39, v79
 s_or_b64 s[26:27], s[26:27], vcc
 s_cmp_lg_u64 s[26:27], 0
 s_cbranch_scc1 L_h2r_120
 s_branch L_fin_110
L_h2r_120:
 buffer_load_dwordx4 v[76:79], v1, s[4:7], s25 offen offset:1024 sc1
 s_branch L_h2o_115
L_fin_110:
 s_cmp_lt_u32 s18, 63
 s_cbranch_scc1 L_rloop_94
 s_waitcnt lgkmcnt(0)
 s_barrier
 ds_read_b128 v[16:19], v2 offset:0
 ds_read_b128 v[20:23], v2 offset:512
 ds_read_b128 v[24:27], v2 offset:1024
 ds_read_b128 v[28:31], v2 offset:1536
 s_lshl_b32 s24, s17, 10
 s_add_u32 s24, s24, s22
 buffer_store_dwordx4 v[12:15], v1, s[4:7], s24 offen sc1
 s_add_u32 s22, s22, 4096
 s_waitcnt vmcnt(0)
 ds_read_b128 v[32:35], v2 offset:2048
 ds_read_b128 v[36:39], v2 offset:2560
 ds_read_b128 v[40:43], v2 offset:3072
 ds_read_b128 v[44:47], v2 offset:3584
 ds_read_b128 v[48:51], v2 offset:4096
 ds_read_b128 v[52:55], v2 offset:4608
 ds_read_b128 v[56:59], v2 offset:5120
 ds_read_b128 v[60:63], v2 offset:5632
 ds_read_b128 v[64:67], v2 offset:6144
 ds_read_b128 v[68:71], v2 offset:6656
 ds_read_b128 v[72:75], v2 offset:7168
 ds_read_b128 v[76:79], v2 offset:7680
 s_waitcnt lgkmcnt(15)
 v_smfmac_f32_16x16x64_bf16 v[116:119], v[16:19], a[128:135], v0
 v_smfmac_f32_16x16x64_bf16 v[120:123], v[16:19], v[128:135], v0
 s_waitcnt lgkmcnt(14)
 v_smfmac_f32_16x16x64_bf16 v[116:119], v[20:23], a[136:143], v0
 v_smfmac_f32_16x16x64_bf16 v[120:123], v[20:23], v[136:143], v0
 s_waitcnt lgkmcnt(13)
 v_smfmac_f32_16x16x64_bf16 v[116:119], v[24:27], a[144:151], v0
 v_smfmac_f32_16x16x64_bf16 v[120:123], v[24:27], v[144:151], v0
 s_waitcnt lgkmcnt(12)
 v_smfmac_f32_16x16x64_bf16 v[116:119], v[28:31], a[152:159], v0
 v_smfmac_f32_16x16x64_bf16 v[120:123], v[28:31], v[152:159], v0
 s_waitcnt lgkmcnt(11)
 v_smfmac_f32_16x16x64_bf16 v[116:119], v[32:35], a[160:167], v0
 v_smfmac_f32_16x16x64_bf16 v[120:123], v[32:35], v[160:167], v0
 s_waitcnt lgkmcnt(10)
 v_smfmac_f32_16x16x64_bf16 v[116:119], v[36:39], a[168:175], v0
 v_smfmac_f32_16x16x64_bf16 v[120:123], v[36:39], v[168:175], v0
 s_waitcnt lgkmcnt(9)
 v_smfmac_f32_16x16x64_bf16 v[116:119], v[40:43], a[176:183], v0
 v_smfmac_f32_16x16x64_bf16 v[120:123], v[40:43], v[176:183], v0
 s_waitcnt lgkmcnt(8)
 v_smfmac_f32_16x16x64_bf16 v[116:119], v[44:47], a[184:191], v0
 v_smfmac_f32_16x16x64_bf16 v[120:123], v[44:47], v[184:191], v0
 s_waitcnt lgkmcnt(7)
 v_smfmac_f32_16x16x64_bf16 v[116:119], v[48:51], a[192:199], v0
 v_smfmac_f32_16x16x64_bf16 v[120:123], v[48:51], v[192:199], v0
 s_waitcnt lgkmcnt(6)
 v_smfmac_f32_16x16x64_bf16 v[116:119], v[52:55], a[200:207], v0
 v_smfmac_f32_16x16x64_bf16 v[120:123], v[52:55], v[200:207], v0
 s_waitcnt lgkmcnt(5)
 v_smfmac_f32_16x16x64_bf16 v[116:119], v[56:59], a[208:215], v0
 v_smfmac_f32_16x16x64_bf16 v[120:123], v[56:59], v[208:215], v0
 s_waitcnt lgkmcnt(4)
 v_smfmac_f32_16x16x64_bf16 v[116:119], v[60:63], a[216:223], v0
 v_smfmac_f32_16x16x64_bf16 v[120:123], v[60:63], v[216:223], v0
 s_waitcnt lgkmcnt(3)
 v_smfmac_f32_16x16x64_bf16 v[116:119], v[64:67], a[224:231], v0
 v_smfmac_f32_16x16x64_bf16 v[120:123], v[64:67], v[224:231], v0
 s_waitcnt lgkmcnt(2)
 v_smfmac_f32_16x16x64_bf16 v[116:119], v[68:71], a[232:239], v0
 v_smfmac_f32_16x16x64_bf16 v[120:123], v[68:71], v[232:239], v0
 s_waitcnt lgkmcnt(1)
 v_smfmac_f32_16x16x64_bf16 v[116:119], v[72:75], a[240:247], v0
 v_smfmac_f32_16x16x64_bf16 v[120:123], v[72:75], v[240:247], v0
 s_waitcnt lgkmcnt(0)
 v_smfmac_f32_16x16x64_bf16 v[116:119], v[76:79], a[248:255], v0
 v_smfmac_f32_16x16x64_bf16 v[120:123], v[76:79], v[248:255], v0
 s_nop 7
 v_cvt_pk_bf16_f32 v12, v116, v117
 v_cvt_pk_bf16_f32 v13, v118, v119
 v_cvt_pk_bf16_f32 v14, v120, v121
 v_cvt_pk_bf16_f32 v15, v122, v123
 s_lshl_b32 s24, s17, 10
 s_add_u32 s24, s24, s22
 buffer_store_dwordx4 v[12:15], v1, s[4:7], s24 offen sc1
 s_branch L_rdone_125
L_fspin_96_e:
 s_mov_b32 s23, 0
L_fspin_96:
 buffer_load_dword v9, off, s[4:7], s36 sc1
 s_add_u32 s23, s23, 1
 s_cmp_gt_u32 s23, 0x40000
 s_cbranch_scc1 L_bail
 s_waitcnt vmcnt(0)
 v_cmp_ne_u32 vcc, 0, v9
 s_cbranch_vccz L_fspin_96
 s_branch L_fok_95

L_rdone_125:
 s_waitcnt vmcnt(0)
 s_endpgm
L_bail:
 s_mov_b64 exec, -1
 v_mov_b32 v20, s45
 v_or_b32 v20, 0xdead0000, v20
 buffer_store_dword v20, off, s[12:15], 0 offset:196
 s_waitcnt vmcnt(0)
L_exit:
 s_endpgm
.section .rodata,"a"
.p2align 6
.amdhsa_kernel adaLN_cond__memory_aug_recurrent_mem_tr__dense_activation_silu__prompt_kernel
  .amdhsa_next_free_vgpr 512
  .amdhsa_next_free_sgpr 102
  .amdhsa_accum_offset 256
  .amdhsa_group_segment_fixed_size 0
  .amdhsa_kernarg_size 120
  .amdhsa_user_sgpr_count 2
  .amdhsa_user_sgpr_kernarg_segment_ptr 1
  .amdhsa_system_sgpr_workgroup_id_x 1
.end_amdhsa_kernel
.text
```
